```python
import torch

def _softmax(x, axis=-1):
    return torch.softmax(x, dim=axis)
def _gelu(x):
    return torch.nn.functional.gelu(x, approximate="tanh")
def _silu(x):
    return torch.nn.functional.silu(x)
def _sigmoid(x):
    return torch.sigmoid(x)
def _layernorm(x, axis=-1, eps=1e-5):
    m = x.mean(dim=axis, keepdim=True)
    v = x.var(dim=axis, keepdim=True, unbiased=False)
    return (x - m) / torch.sqrt(v + eps)
def _scatter_add(tgt, idx, src, axis=0):
    return tgt.clone().index_add_(axis, idx, src)
def _segment_sum(src, seg, n):
    out = torch.zeros((n,) + src.shape[1:], dtype=src.dtype)
    return out.index_add_(0, seg, src)
def _pad(x, pw):
    flat = tuple(v for pair in reversed(pw) for v in pair)
    return torch.nn.functional.pad(x, flat)

kernel_name = 'sequential_preLN__mha_block__glu_gated_geglu__prompt'

def setup_inputs():

    _w = (lambda a: (lambda t: t.to(torch.bfloat16) if t.is_floating_point() else t)(torch.as_tensor(a)))
    def _A_setup():
        B, S, D, H = 1, 2048, 640, 32
        return {
            "x": _w((lambda *s: torch.randn(*s, dtype=torch.bfloat16) * 0.05)(B, S, D)),
            "wqkv": _w((lambda *s: torch.randn(*s, dtype=torch.bfloat16) * 0.05)(D, 3 * D)),
            "wo": _w((lambda *s: torch.randn(*s, dtype=torch.bfloat16) * 0.05)(D, D)),
        }
    _A_in = _A_setup()

    def _B_setup():
        B, S, Dm, Df = 1, 2048, 640, 1536
        return {
            "x": _w((lambda *s: torch.randn(*s, dtype=torch.bfloat16) * 0.05)(B, S, Dm)),
            "w_gate": _w((lambda *s: torch.randn(*s, dtype=torch.bfloat16) * 0.8)(Dm, Df) * (Dm ** -0.5)),
            "w_up": _w((lambda *s: torch.randn(*s, dtype=torch.bfloat16) * 0.8)(Dm, Df) * (Dm ** -0.5)),
            "w_down": _w((lambda *s: torch.randn(*s, dtype=torch.bfloat16) * 0.8)(Df, Dm) * (Df ** -0.5)),
        }
    _B_in = _B_setup()

    return {
        "A_x": _A_in["x"],
        "A_wqkv": _A_in["wqkv"],
        "A_wo": _A_in["wo"],
        "B_x": _B_in["x"],
        "B_w_gate": _B_in["w_gate"],
        "B_w_up": _B_in["w_up"],
        "B_w_down": _B_in["w_down"],
    }

def reference(A_x, A_wqkv, A_wo, B_x, B_w_gate, B_w_up, B_w_down):
    def _A_ref(x, wqkv, wo):
        B, S, D = x.shape
        H = 32
        Dh = D // H
        qkv = (lambda x, *d: x.permute(*d))((x @ wqkv).reshape(B, S, 3, H, Dh), 2, 0, 3, 1, 4)
        q, k, v = qkv[0], qkv[1], qkv[2]
        scores = torch.einsum("bhqd,bhkd->bhqk", q, k) * (Dh ** -0.5)
        p = _softmax(scores, axis=-1)
        o = torch.einsum("bhqk,bhkd->bhqd", p, v)
        return (lambda x, *d: x.permute(*d))(o, 0, 2, 1, 3).reshape(B, S, D) @ wo

    def _B_ref(x, w_gate, w_up, w_down):
        g = torch.einsum("bsd,df->bsf", x, w_gate)
        u = torch.einsum("bsd,df->bsf", x, w_up)
        h = _gelu(g) * u
        return torch.einsum("bsf,fd->bsd", h, w_down)

    x = A_x
    h = x + _A_ref(_layernorm(x, axis=-1), A_wqkv, A_wo)
    h2 = h + _B_ref(_layernorm(h, axis=-1), B_w_gate, B_w_up, B_w_down)
    return h2
```

```asm
; @launch grid=(256,1,1) block=(512,1,1) lds=163840
.amdgcn_target "amdgcn-amd-amdhsa--gfx950"
.text
.globl sequential_preLN__mha_block__glu_gated_geglu__prompt_kernel
.p2align 8
.type sequential_preLN__mha_block__glu_gated_geglu__prompt_kernel,@function
sequential_preLN__mha_block__glu_gated_geglu__prompt_kernel:
    s_cmp_ge_u32 s2, 256
    s_cbranch_scc1 L_end
    s_load_dwordx16 s[56:71], s[0:1], 0
    s_load_dwordx4 s[72:75], s[0:1], 64
    v_lshrrev_b32 v1, 6, v0
    v_and_b32 v0, 63, v0
    s_nop 0
    v_readfirstlane_b32 s3, v1
    s_nop 1
    s_cmp_lg_u32 s3, 3
    s_cbranch_scc1 L_nopf
    s_getpc_b64 s[4:5]
L_pc0:
    s_sub_u32 s4, s4, L_pc0-sequential_preLN__mha_block__glu_gated_geglu__prompt_kernel
    s_subb_u32 s5, s5, 0
    s_mov_b32 s6, qk_table-sequential_preLN__mha_block__glu_gated_geglu__prompt_kernel
    s_mov_b32 s7, 0x20000
    s_lshr_b32 s8, s2, 3
    s_lshl_b32 s8, s8, 11
    v_lshlrev_b32 v2, 7, v0
    s_mov_b64 exec, 0xffff
    buffer_load_dword v255, v2, s[4:7], s8 offen
    s_mov_b64 exec, -1
L_nopf:
    s_lshr_b32 s20, s2, 3
    s_and_b32 s21, s2, 7
    s_and_b32 s22, s3, 3
    s_cmp_ge_u32 s20, 30
    s_cbranch_scc1 L1_help
    s_lshr_b32 s32, s21, 1
    s_and_b32 s33, s21, 1
    s_lshl_b32 s32, s32, 2
    s_and_b32 s34, s20, 3
    s_lshr_b32 s35, s20, 2
    s_lshl_b32 s36, s33, 3
    s_add_u32 s35, s35, s36
    s_lshl_b32 s33, s33, 1
    s_sub_u32 s36, s20, 28
    s_add_u32 s33, s33, s36
    s_cmp_lt_u32 s20, 28
    s_cselect_b32 s34, s34, s33
    s_cselect_b32 s21, s35, 7
    s_add_u32 s20, s32, s34
    s_lshr_b32 s23, s22, 1
    s_and_b32 s24, s22, 1
    s_cmp_lt_u32 s3, 4
    s_cbranch_scc1 L1_comp
    s_lshl_b32 s25, s22, 10
    s_add_u32 s26, s25, 65536
    v_lshrrev_b32 v1, 3, v0
    v_lshrrev_b32 v2, 4, v0
    s_lshl_b32 s32, s20, 7
    s_lshl_b32 s33, s22, 3
    s_add_u32 s32, s32, s33
    v_add_u32 v1, s32, v1
    v_mul_u32_u24 v1, 1280, v1
    s_lshl_b32 s33, s24, 2
    v_add_u32 v3, s33, v2
    v_and_b32 v4, 7, v0
    v_xor_b32 v3, v3, v4
    v_lshl_add_u32 v10, v3, 4, v1
    s_lshl_b32 s33, s22, 2
    v_add_u32 v1, s33, v2
    v_mul_u32_u24 v1, 3840, v1
    v_bfe_u32 v3, v0, 2, 2
    v_xor_b32 v3, v3, v2
    v_lshl_add_u32 v1, v3, 6, v1
    v_and_b32 v3, 3, v0
    v_lshl_add_u32 v1, v3, 4, v1
    s_lshl_b32 s33, s21, 8
    v_add_u32 v11, s33, v1
    s_waitcnt lgkmcnt(0)
    s_mov_b32 s8, s56
    s_mov_b32 s9, s57
    s_mov_b32 s10, 2621440
    s_mov_b32 s11, 0x20000
    s_mov_b32 s12, s58
    s_mov_b32 s13, s59
    s_mov_b32 s14, 2457600
    s_mov_b32 s15, 0x20000
    s_add_u32 m0, s25, 0
    s_mov_b32 s30, 0
    buffer_load_dwordx4 v10, s[8:11], s30 offen  lds
    s_add_u32 m0, s26, 0
    s_mov_b32 s31, 0
    buffer_load_dwordx4 v11, s[12:15], s31 offen  lds
    s_add_u32 m0, s25, 4096
    s_mov_b32 s30, 40960
    buffer_load_dwordx4 v10, s[8:11], s30 offen  lds
    s_add_u32 m0, s26, 4096
    s_mov_b32 s31, 61440
    buffer_load_dwordx4 v11, s[12:15], s31 offen  lds
    s_add_u32 m0, s25, 8192
    s_mov_b32 s30, 81920
    buffer_load_dwordx4 v10, s[8:11], s30 offen  lds
    s_add_u32 m0, s26, 8192
    s_mov_b32 s31, 122880
    buffer_load_dwordx4 v11, s[12:15], s31 offen  lds
    s_add_u32 m0, s25, 12288
    s_mov_b32 s30, 122880
    buffer_load_dwordx4 v10, s[8:11], s30 offen  lds
    s_add_u32 m0, s26, 12288
    s_mov_b32 s31, 184320
    buffer_load_dwordx4 v11, s[12:15], s31 offen  lds
    s_add_u32 m0, s25, 16384
    s_mov_b32 s30, 128
    buffer_load_dwordx4 v10, s[8:11], s30 offen  lds
    s_add_u32 m0, s26, 16384
    s_mov_b32 s31, 245760
    buffer_load_dwordx4 v11, s[12:15], s31 offen  lds
    s_add_u32 m0, s25, 20480
    s_mov_b32 s30, 41088
    buffer_load_dwordx4 v10, s[8:11], s30 offen  lds
    s_add_u32 m0, s26, 20480
    s_mov_b32 s31, 307200
    buffer_load_dwordx4 v11, s[12:15], s31 offen  lds
    s_add_u32 m0, s25, 24576
    s_mov_b32 s30, 82048
    buffer_load_dwordx4 v10, s[8:11], s30 offen  lds
    s_add_u32 m0, s26, 24576
    s_mov_b32 s31, 368640
    buffer_load_dwordx4 v11, s[12:15], s31 offen  lds
    s_add_u32 m0, s25, 28672
    s_mov_b32 s30, 123008
    buffer_load_dwordx4 v10, s[8:11], s30 offen  lds
    s_add_u32 m0, s26, 28672
    s_mov_b32 s31, 430080
    buffer_load_dwordx4 v11, s[12:15], s31 offen  lds
    s_mov_b32 s76, s74
    s_mov_b32 s77, s75
    s_mov_b32 s78, 26411008
    s_mov_b32 s79, 0x20000
    v_mov_b32 v60, 132608
    v_mov_b32 v61, 0
    ds_write_b32 v60, v61
    s_waitcnt lgkmcnt(0)
    s_waitcnt vmcnt(8)
    s_barrier
    s_add_u32 m0, s25, 32768
    s_mov_b32 s30, 256
    buffer_load_dwordx4 v10, s[8:11], s30 offen  lds
    s_add_u32 m0, s26, 32768
    s_mov_b32 s31, 491520
    buffer_load_dwordx4 v11, s[12:15], s31 offen  lds
    s_add_u32 m0, s25, 36864
    s_mov_b32 s30, 41216
    buffer_load_dwordx4 v10, s[8:11], s30 offen  lds
    s_add_u32 m0, s26, 36864
    s_mov_b32 s31, 552960
    buffer_load_dwordx4 v11, s[12:15], s31 offen  lds
    s_add_u32 m0, s25, 40960
    s_mov_b32 s30, 82176
    buffer_load_dwordx4 v10, s[8:11], s30 offen  lds
    s_add_u32 m0, s26, 40960
    s_mov_b32 s31, 614400
    buffer_load_dwordx4 v11, s[12:15], s31 offen  lds
    s_add_u32 m0, s25, 45056
    s_mov_b32 s30, 123136
    buffer_load_dwordx4 v10, s[8:11], s30 offen  lds
    s_add_u32 m0, s26, 45056
    s_mov_b32 s31, 675840
    buffer_load_dwordx4 v11, s[12:15], s31 offen  lds
    s_waitcnt vmcnt(8)
    s_barrier
    s_add_u32 m0, s25, 49152
    s_mov_b32 s30, 384
    buffer_load_dwordx4 v10, s[8:11], s30 offen  lds
    s_add_u32 m0, s26, 49152
    s_mov_b32 s31, 737280
    buffer_load_dwordx4 v11, s[12:15], s31 offen  lds
    s_add_u32 m0, s25, 53248
    s_mov_b32 s30, 41344
    buffer_load_dwordx4 v10, s[8:11], s30 offen  lds
    s_add_u32 m0, s26, 53248
    s_mov_b32 s31, 798720
    buffer_load_dwordx4 v11, s[12:15], s31 offen  lds
    s_add_u32 m0, s25, 57344
    s_mov_b32 s30, 82304
    buffer_load_dwordx4 v10, s[8:11], s30 offen  lds
    s_add_u32 m0, s26, 57344
    s_mov_b32 s31, 860160
    buffer_load_dwordx4 v11, s[12:15], s31 offen  lds
    s_add_u32 m0, s25, 61440
    s_mov_b32 s30, 123264
    buffer_load_dwordx4 v10, s[8:11], s30 offen  lds
    s_add_u32 m0, s26, 61440
    s_mov_b32 s31, 921600
    buffer_load_dwordx4 v11, s[12:15], s31 offen  lds
    s_waitcnt vmcnt(8)
    s_barrier
    s_add_u32 m0, s25, 0
    s_mov_b32 s30, 512
    buffer_load_dwordx4 v10, s[8:11], s30 offen  lds
    s_add_u32 m0, s26, 0
    s_mov_b32 s31, 983040
    buffer_load_dwordx4 v11, s[12:15], s31 offen  lds
    s_add_u32 m0, s25, 4096
    s_mov_b32 s30, 41472
    buffer_load_dwordx4 v10, s[8:11], s30 offen  lds
    s_add_u32 m0, s26, 4096
    s_mov_b32 s31, 1044480
    buffer_load_dwordx4 v11, s[12:15], s31 offen  lds
    s_add_u32 m0, s25, 8192
    s_mov_b32 s30, 82432
    buffer_load_dwordx4 v10, s[8:11], s30 offen  lds
    s_add_u32 m0, s26, 8192
    s_mov_b32 s31, 1105920
    buffer_load_dwordx4 v11, s[12:15], s31 offen  lds
    s_add_u32 m0, s25, 12288
    s_mov_b32 s30, 123392
    buffer_load_dwordx4 v10, s[8:11], s30 offen  lds
    s_add_u32 m0, s26, 12288
    s_mov_b32 s31, 1167360
    buffer_load_dwordx4 v11, s[12:15], s31 offen  lds
    s_waitcnt vmcnt(8)
    s_barrier
    s_add_u32 m0, s25, 16384
    s_mov_b32 s30, 640
    buffer_load_dwordx4 v10, s[8:11], s30 offen  lds
    s_add_u32 m0, s26, 16384
    s_mov_b32 s31, 1228800
    buffer_load_dwordx4 v11, s[12:15], s31 offen  lds
    s_add_u32 m0, s25, 20480
    s_mov_b32 s30, 41600
    buffer_load_dwordx4 v10, s[8:11], s30 offen  lds
    s_add_u32 m0, s26, 20480
    s_mov_b32 s31, 1290240
    buffer_load_dwordx4 v11, s[12:15], s31 offen  lds
    s_add_u32 m0, s25, 24576
    s_mov_b32 s30, 82560
    buffer_load_dwordx4 v10, s[8:11], s30 offen  lds
    s_add_u32 m0, s26, 24576
    s_mov_b32 s31, 1351680
    buffer_load_dwordx4 v11, s[12:15], s31 offen  lds
    s_add_u32 m0, s25, 28672
    s_mov_b32 s30, 123520
    buffer_load_dwordx4 v10, s[8:11], s30 offen  lds
    s_add_u32 m0, s26, 28672
    s_mov_b32 s31, 1413120
    buffer_load_dwordx4 v11, s[12:15], s31 offen  lds
    s_waitcnt vmcnt(8)
    s_barrier
    s_add_u32 m0, s25, 32768
    s_mov_b32 s30, 768
    buffer_load_dwordx4 v10, s[8:11], s30 offen  lds
    s_add_u32 m0, s26, 32768
    s_mov_b32 s31, 1474560
    buffer_load_dwordx4 v11, s[12:15], s31 offen  lds
    s_add_u32 m0, s25, 36864
    s_mov_b32 s30, 41728
    buffer_load_dwordx4 v10, s[8:11], s30 offen  lds
    s_add_u32 m0, s26, 36864
    s_mov_b32 s31, 1536000
    buffer_load_dwordx4 v11, s[12:15], s31 offen  lds
    s_add_u32 m0, s25, 40960
    s_mov_b32 s30, 82688
    buffer_load_dwordx4 v10, s[8:11], s30 offen  lds
    s_add_u32 m0, s26, 40960
    s_mov_b32 s31, 1597440
    buffer_load_dwordx4 v11, s[12:15], s31 offen  lds
    s_add_u32 m0, s25, 45056
    s_mov_b32 s30, 123648
    buffer_load_dwordx4 v10, s[8:11], s30 offen  lds
    s_add_u32 m0, s26, 45056
    s_mov_b32 s31, 1658880
    buffer_load_dwordx4 v11, s[12:15], s31 offen  lds
    s_waitcnt vmcnt(8)
    s_barrier
    s_add_u32 m0, s25, 49152
    s_mov_b32 s30, 896
    buffer_load_dwordx4 v10, s[8:11], s30 offen  lds
    s_add_u32 m0, s26, 49152
    s_mov_b32 s31, 1720320
    buffer_load_dwordx4 v11, s[12:15], s31 offen  lds
    s_add_u32 m0, s25, 53248
    s_mov_b32 s30, 41856
    buffer_load_dwordx4 v10, s[8:11], s30 offen  lds
    s_add_u32 m0, s26, 53248
    s_mov_b32 s31, 1781760
    buffer_load_dwordx4 v11, s[12:15], s31 offen  lds
    s_add_u32 m0, s25, 57344
    s_mov_b32 s30, 82816
    buffer_load_dwordx4 v10, s[8:11], s30 offen  lds
    s_add_u32 m0, s26, 57344
    s_mov_b32 s31, 1843200
    buffer_load_dwordx4 v11, s[12:15], s31 offen  lds
    s_add_u32 m0, s25, 61440
    s_mov_b32 s30, 123776
    buffer_load_dwordx4 v10, s[8:11], s30 offen  lds
    s_add_u32 m0, s26, 61440
    s_mov_b32 s31, 1904640
    buffer_load_dwordx4 v11, s[12:15], s31 offen  lds
    s_waitcnt vmcnt(8)
    s_barrier
    s_add_u32 m0, s25, 0
    s_mov_b32 s30, 1024
    buffer_load_dwordx4 v10, s[8:11], s30 offen  lds
    s_add_u32 m0, s26, 0
    s_mov_b32 s31, 1966080
    buffer_load_dwordx4 v11, s[12:15], s31 offen  lds
    s_add_u32 m0, s25, 4096
    s_mov_b32 s30, 41984
    buffer_load_dwordx4 v10, s[8:11], s30 offen  lds
    s_add_u32 m0, s26, 4096
    s_mov_b32 s31, 2027520
    buffer_load_dwordx4 v11, s[12:15], s31 offen  lds
    s_add_u32 m0, s25, 8192
    s_mov_b32 s30, 82944
    buffer_load_dwordx4 v10, s[8:11], s30 offen  lds
    s_add_u32 m0, s26, 8192
    s_mov_b32 s31, 2088960
    buffer_load_dwordx4 v11, s[12:15], s31 offen  lds
    s_add_u32 m0, s25, 12288
    s_mov_b32 s30, 123904
    buffer_load_dwordx4 v10, s[8:11], s30 offen  lds
    s_add_u32 m0, s26, 12288
    s_mov_b32 s31, 2150400
    buffer_load_dwordx4 v11, s[12:15], s31 offen  lds
    s_waitcnt vmcnt(8)
    s_barrier
    s_add_u32 m0, s25, 16384
    s_mov_b32 s30, 1152
    buffer_load_dwordx4 v10, s[8:11], s30 offen  lds
    s_add_u32 m0, s26, 16384
    s_mov_b32 s31, 2211840
    buffer_load_dwordx4 v11, s[12:15], s31 offen  lds
    s_add_u32 m0, s25, 20480
    s_mov_b32 s30, 42112
    buffer_load_dwordx4 v10, s[8:11], s30 offen  lds
    s_add_u32 m0, s26, 20480
    s_mov_b32 s31, 2273280
    buffer_load_dwordx4 v11, s[12:15], s31 offen  lds
    s_add_u32 m0, s25, 24576
    s_mov_b32 s30, 83072
    buffer_load_dwordx4 v10, s[8:11], s30 offen  lds
    s_add_u32 m0, s26, 24576
    s_mov_b32 s31, 2334720
    buffer_load_dwordx4 v11, s[12:15], s31 offen  lds
    s_add_u32 m0, s25, 28672
    s_mov_b32 s30, 124032
    buffer_load_dwordx4 v10, s[8:11], s30 offen  lds
    s_add_u32 m0, s26, 28672
    s_mov_b32 s31, 2396160
    buffer_load_dwordx4 v11, s[12:15], s31 offen  lds
    s_waitcnt vmcnt(8)
    s_barrier
    s_mov_b32 s48, s72
    s_mov_b32 s49, s73
    s_mov_b32 s50, 256
    s_mov_b32 s51, 0x20000
    v_mov_b32 v60, 0
    buffer_load_dword v61, v60, s[48:51], 0 offen sc1
    s_lshl_b32 s44, s22, 8
    s_add_u32 s44, s44, s2
    s_mul_i32 s46, s22, 10240
    s_cmp_lt_u32 s22, 2
    s_cselect_b32 s36, 0, 45056
    s_add_u32 s46, s46, s36
    s_add_u32 s46, s46, 32768
    v_lshrrev_b32 v16, 4, v0
    v_bfe_u32 v17, v0, 2, 2
    v_and_b32 v18, 3, v0
    s_mov_b32 s19, 0x20000
    s_cmp_lt_u32 s44, 640
    s_cbranch_scc0 Lod_1
    s_lshr_b32 s40, s44, 1
    s_and_b32 s41, s44, 1
    s_mul_hi_u32 s36, s40, 214748365
    s_mul_i32 s37, s36, 20
    s_sub_u32 s37, s40, s37
    s_mul_i32 s45, s40, 12288
    s_lshl_b32 s39, s41, 10
    s_add_u32 s45, s45, s39
    s_add_u32 s45, s45, 22315008
    s_mul_i32 s38, s37, 98304
    s_mul_i32 s39, s36, 192
    s_add_u32 s38, s38, s39
    s_cmp_eq_u32 s41, 0
    s_cselect_b32 s16, s64, s66
    s_cselect_b32 s17, s65, s67
    s_mov_b32 s18, 1966080
    v_lshrrev_b32 v19, 1, v0
    v_mul_u32_u24 v19, 3072, v19
    v_and_b32 v21, 1, v0
    v_lshl_add_u32 v19, v21, 4, v19
    s_add_u32 m0, s46, 0
    s_add_u32 s39, s38, 0
    buffer_load_dwordx4 v19, s[16:19], s39 offen  lds
    s_add_u32 m0, s46, 1024
    s_add_u32 s39, s38, 32
    buffer_load_dwordx4 v19, s[16:19], s39 offen  lds
    s_add_u32 m0, s46, 2048
    s_add_u32 s39, s38, 64
    buffer_load_dwordx4 v19, s[16:19], s39 offen  lds
    s_add_u32 m0, s46, 3072
    s_add_u32 s39, s38, 96
    buffer_load_dwordx4 v19, s[16:19], s39 offen  lds
    s_add_u32 m0, s46, 4096
    s_add_u32 s39, s38, 128
    buffer_load_dwordx4 v19, s[16:19], s39 offen  lds
    s_add_u32 m0, s46, 5120
    s_add_u32 s39, s38, 160
    buffer_load_dwordx4 v19, s[16:19], s39 offen  lds
    s_add_u32 m0, s46, 8192
    v_mov_b32 v19, 0x7ffffff0
    buffer_load_dwordx4 v19, s[76:79], 0 offen lds
    buffer_load_dwordx4 v19, s[76:79], 0 offen lds
    buffer_load_dwordx4 v19, s[76:79], 0 offen lds
    buffer_load_dwordx4 v19, s[76:79], 0 offen lds
    s_branch Ljd_2
Lnojob_4:
    s_add_u32 m0, s46, 8192
    v_mov_b32 v19, 0x7ffffff0
    buffer_load_dwordx4 v19, s[76:79], 0 offen lds
    buffer_load_dwordx4 v19, s[76:79], 0 offen lds
    buffer_load_dwordx4 v19, s[76:79], 0 offen lds
    buffer_load_dwordx4 v19, s[76:79], 0 offen lds
    buffer_load_dwordx4 v19, s[76:79], 0 offen lds
    buffer_load_dwordx4 v19, s[76:79], 0 offen lds
    buffer_load_dwordx4 v19, s[76:79], 0 offen lds
    buffer_load_dwordx4 v19, s[76:79], 0 offen lds
    buffer_load_dwordx4 v19, s[76:79], 0 offen lds
    buffer_load_dwordx4 v19, s[76:79], 0 offen lds
    s_branch Ljd_2
Lod_1:
    s_mov_b32 s45, 0
    s_mov_b32 s52, 0
    s_cmp_lt_u32 s44, 912
    s_cbranch_scc0 Lnojob_4
    s_sub_u32 s36, s44, 640
    s_sub_u32 s37, s44, 720
    s_cmp_lt_u32 s44, 720
    s_cselect_b32 s36, s36, s37
    s_cselect_b32 s37, 429496730, 0
    s_cselect_b32 s38, 0, 178956971
    s_or_b32 s37, s37, s38
    s_cmp_lt_u32 s44, 720
    s_cselect_b32 s38, 10, 24
    s_cselect_b32 s39, 19529728, 0
    s_cselect_b32 s40, 0, 20348928
    s_cselect_b32 s16, s60, s68
    s_cselect_b32 s17, s61, s69
    s_cselect_b32 s18, 819200, 0
    s_cselect_b32 s41, 0, 1966080
    s_cselect_b64 s[42:43], -1, 0
    s_or_b32 s39, s39, s40
    s_or_b32 s18, s18, s41
    s_mul_i32 s45, s36, 10240
    s_add_u32 s45, s45, s39
    s_mul_hi_u32 s37, s36, s37
    s_mul_i32 s38, s37, s38
    s_sub_u32 s38, s36, s38
    s_add_u32 s52, s45, 5120
    s_cmp_lt_u32 s44, 720
    s_cbranch_scc1 Lwo_3
    s_mul_i32 s39, s37, 245760
    s_add_u32 s39, s39, 20348928
    s_lshl_b32 s40, s38, 1
    s_add_u32 s40, s40, 0
    s_mul_hi_u32 s41, s40, 1431655766
    s_mul_i32 s45, s41, 3
    s_sub_u32 s40, s40, s45
    s_lshl_b32 s40, s40, 4
    s_add_u32 s40, s40, s41
    s_mul_i32 s40, s40, 5120
    s_add_u32 s45, s40, s39
    s_lshl_b32 s40, s38, 1
    s_add_u32 s40, s40, 1
    s_mul_hi_u32 s41, s40, 1431655766
    s_mul_i32 s52, s41, 3
    s_sub_u32 s40, s40, s52
    s_lshl_b32 s40, s40, 4
    s_add_u32 s40, s40, s41
    s_mul_i32 s40, s40, 5120
    s_add_u32 s52, s40, s39
Lwo_3:
    s_mul_i32 s37, s37, 160
    s_lshl_b32 s39, s38, 3
    s_lshl_b32 s40, s38, 6
    v_lshrrev_b32 v19, 1, v0
    v_and_b32 v21, 1, v0
    v_bfe_u32 v25, v0, 3, 1
    v_bfe_u32 v27, v0, 1, 2
    v_add3_u32 v22, v16, s39, 0
    v_cmp_le_u32 vcc, 64, v22
    v_lshrrev_b32 v23, 1, v22
    v_subrev_u32 v24, 64, v22
    v_lshl_add_u32 v24, v24, 1, v25
    v_cndmask_b32 v26, v23, v24, vcc
    v_mul_u32_u24 v26, 20, v26
    v_and_b32 v24, 1, v22
    v_lshlrev_b32 v24, 2, v24
    v_lshl_add_u32 v24, v25, 3, v24
    v_cndmask_b32 v24, v24, 16, vcc
    v_add3_u32 v26, v26, v24, v27
    v_add3_u32 v20, v19, s40, 0
    v_cndmask_b32 v20, v20, v26, s[42:43]
    v_mul_u32_u24 v20, 1280, v20
    v_lshl_add_u32 v20, v21, 4, v20
    s_add_u32 m0, s46, 0
    s_add_u32 s41, s37, 0
    buffer_load_dwordx4 v20, s[16:19], s41 offen  lds
    s_add_u32 m0, s46, 1024
    s_add_u32 s41, s37, 32
    buffer_load_dwordx4 v20, s[16:19], s41 offen  lds
    s_add_u32 m0, s46, 2048
    s_add_u32 s41, s37, 64
    buffer_load_dwordx4 v20, s[16:19], s41 offen  lds
    s_add_u32 m0, s46, 3072
    s_add_u32 s41, s37, 96
    buffer_load_dwordx4 v20, s[16:19], s41 offen  lds
    s_add_u32 m0, s46, 4096
    s_add_u32 s41, s37, 128
    buffer_load_dwordx4 v20, s[16:19], s41 offen  lds
    v_add3_u32 v22, v16, s39, 4
    v_cmp_le_u32 vcc, 64, v22
    v_lshrrev_b32 v23, 1, v22
    v_subrev_u32 v24, 64, v22
    v_lshl_add_u32 v24, v24, 1, v25
    v_cndmask_b32 v26, v23, v24, vcc
    v_mul_u32_u24 v26, 20, v26
    v_and_b32 v24, 1, v22
    v_lshlrev_b32 v24, 2, v24
    v_lshl_add_u32 v24, v25, 3, v24
    v_cndmask_b32 v24, v24, 16, vcc
    v_add3_u32 v26, v26, v24, v27
    v_add3_u32 v20, v19, s40, 32
    v_cndmask_b32 v20, v20, v26, s[42:43]
    v_mul_u32_u24 v20, 1280, v20
    v_lshl_add_u32 v20, v21, 4, v20
    s_add_u32 m0, s46, 5120
    s_add_u32 s41, s37, 0
    buffer_load_dwordx4 v20, s[16:19], s41 offen  lds
    s_add_u32 m0, s46, 6144
    s_add_u32 s41, s37, 32
    buffer_load_dwordx4 v20, s[16:19], s41 offen  lds
    s_add_u32 m0, s46, 7168
    s_add_u32 s41, s37, 64
    buffer_load_dwordx4 v20, s[16:19], s41 offen  lds
    s_add_u32 m0, s46, 8192
    s_add_u32 s41, s37, 96
    buffer_load_dwordx4 v20, s[16:19], s41 offen  lds
    s_add_u32 m0, s46, 9216
    s_add_u32 s41, s37, 128
    buffer_load_dwordx4 v20, s[16:19], s41 offen  lds
Ljd_2:
    v_lshl_add_u32 v19, v16, 3, v17
    v_lshlrev_b32 v19, 5, v19
    v_add_u32 v19, s46, v19
    v_lshl_add_u32 v13, v18, 3, v19
    v_and_b32 v20, 1, v18
    v_lshl_add_u32 v19, v20, 4, v19
    v_lshrrev_b32 v20, 1, v18
    v_lshl_add_u32 v12, v20, 10, v19
    s_waitcnt vmcnt(10)
    v_cmp_le_u32 vcc, 16, v61
    s_nop 1
    s_cmp_eq_u64 vcc, exec
    s_cbranch_scc1 Liok_5
    s_mov_b64 exec, 0x1
    s_mov_b32 s54, 262144
Lpoll_6:
    buffer_load_dword v61, v60, s[48:51], 0 offen sc1
    s_waitcnt vmcnt(0)
    v_cmp_le_u32 vcc, 16, v61
    s_sub_u32 s54, s54, 1
    s_cbranch_scc1 Lpdone_7
    s_cmp_eq_u64 vcc, exec
    s_cbranch_scc0 Lpoll_6
Lpdone_7:
    s_mov_b64 exec, -1
Liok_5:
    s_barrier
    s_barrier
    s_waitcnt vmcnt(0)
    s_cmp_lt_u32 s44, 640
    s_cbranch_scc0 Lfod_9
    ds_read_b64_tr_b16 v[176:177], v12 offset:0
    ds_read_b64_tr_b16 v[178:179], v12 offset:128
    ds_read_b64_tr_b16 v[180:181], v12 offset:8
    ds_read_b64_tr_b16 v[182:183], v12 offset:136
    ds_read_b64_tr_b16 v[184:185], v12 offset:2048
    ds_read_b64_tr_b16 v[186:187], v12 offset:2176
    ds_read_b64_tr_b16 v[188:189], v12 offset:2056
    ds_read_b64_tr_b16 v[190:191], v12 offset:2184
    ds_read_b64_tr_b16 v[192:193], v12 offset:4096
    ds_read_b64_tr_b16 v[194:195], v12 offset:4224
    ds_read_b64_tr_b16 v[196:197], v12 offset:4104
    ds_read_b64_tr_b16 v[198:199], v12 offset:4232
    s_branch Lfd_10
Lfod_9:
    ds_read_b64_tr_b16 v[176:177], v12 offset:0
    ds_read_b64_tr_b16 v[178:179], v12 offset:128
    ds_read_b64_tr_b16 v[180:181], v12 offset:8
    ds_read_b64_tr_b16 v[182:183], v12 offset:136
    ds_read_b64_tr_b16 v[184:185], v12 offset:2048
    ds_read_b64_tr_b16 v[186:187], v12 offset:2176
    ds_read_b64_tr_b16 v[188:189], v12 offset:2056
    ds_read_b64_tr_b16 v[190:191], v12 offset:2184
    ds_read_b64_tr_b16 v[192:193], v13 offset:4096
    ds_read_b64_tr_b16 v[194:195], v13 offset:4224
    s_waitcnt lgkmcnt(0)
    ds_read_b64_tr_b16 v[196:197], v12 offset:5120
    ds_read_b64_tr_b16 v[198:199], v12 offset:5248
    ds_read_b64_tr_b16 v[200:201], v12 offset:5128
    ds_read_b64_tr_b16 v[202:203], v12 offset:5256
    ds_read_b64_tr_b16 v[204:205], v12 offset:7168
    ds_read_b64_tr_b16 v[206:207], v12 offset:7296
    ds_read_b64_tr_b16 v[208:209], v12 offset:7176
    ds_read_b64_tr_b16 v[210:211], v12 offset:7304
    ds_read_b64_tr_b16 v[212:213], v13 offset:9216
    ds_read_b64_tr_b16 v[214:215], v13 offset:9344
Lfd_10:
    s_waitcnt lgkmcnt(0)
    s_branch L1_join
L1_comp:
    v_and_b32 v1, 31, v0
    v_lshrrev_b32 v2, 5, v0
    v_bfe_u32 v3, v0, 1, 3
    s_lshl_b32 s32, s23, 13
    s_lshl_b32 s33, s24, 12
    s_add_u32 s34, s32, s33
    v_lshlrev_b32 v4, 7, v1
    v_add_u32 v4, s34, v4
    v_add_u32 v5, 0, v2
    v_xor_b32 v5, v5, v3
    v_lshl_add_u32 v12, v5, 4, v4
    v_xor_b32 v16, 4096, v12
    v_add_u32 v5, 2, v2
    v_xor_b32 v5, v5, v3
    v_lshl_add_u32 v13, v5, 4, v4
    v_xor_b32 v17, 4096, v13
    v_add_u32 v5, 4, v2
    v_xor_b32 v5, v5, v3
    v_lshl_add_u32 v14, v5, 4, v4
    v_xor_b32 v18, 4096, v14
    v_add_u32 v5, 6, v2
    v_xor_b32 v5, v5, v3
    v_lshl_add_u32 v15, v5, 4, v4
    v_xor_b32 v19, 4096, v15
    v_and_b32 v3, 31, v0
    v_cmp_eq_u32 vcc, 0, v3
    v_cmp_eq_u32 s[32:33], 20, v3
    v_mov_b32 v4, 0x3f803f80
    s_or_b64 vcc, vcc, s[32:33]
    v_cndmask_b32 v144, 0, v4, vcc
    v_cndmask_b32 v145, 0, v4, vcc
    v_cndmask_b32 v146, 0, v4, vcc
    v_cndmask_b32 v147, 0, v4, vcc
    s_mov_b32 s36, 0x3acccccd
    v_bfe_u32 v30, v0, 2, 2
    v_lshlrev_b32 v31, 11, v2
    v_lshl_add_u32 v31, v30, 8, v31
    v_add_u32 v31, 65536, v31
    s_cmp_ge_u32 s21, 10
    s_cbranch_scc1 L1_v
    s_cmp_lt_u32 s21, 5
    s_cselect_b32 s37, 0x3ea52b5c, 1.0
    s_cselect_b32 s40, 5, 10
    s_cselect_b32 s42, 0, 2621440
    s_cselect_b32 s43, 0, 5
    s_sub_u32 s43, s21, s43
    s_lshl_b32 s43, s43, 2
    s_lshl_b32 s32, s24, 1
    s_add_u32 s43, s43, s32
    s_add_u32 s43, s43, s23
    s_lshl_b32 s32, s43, 5
    s_xor_b32 s33, s32, 32
    s_getpc_b64 s[34:35]
L1_pc:
    s_add_u32 s34, s34, qk_table-L1_pc
    s_addc_u32 s35, s35, 0
    s_load_dwordx8 s[4:11], s[34:35], s32
    s_load_dwordx8 s[12:19], s[34:35], s33
    v_and_b32 v3, 3, v0
    v_lshlrev_b32 v3, 3, v3
    v_bfe_u32 v4, v0, 4, 1
    v_cmp_eq_u32 s[32:33], 1, v4
    v_cmp_eq_u32 s[34:35], 1, v2
    s_waitcnt lgkmcnt(0)
    v_mov_b32 v4, s4
    v_mov_b32 v5, s5
    v_cndmask_b32 v4, v4, v5, s[32:33]
    v_bfe_u32 v4, v4, v3, 8
    v_lshrrev_b32 v5, 3, v4
    v_xor_b32 v5, v5, v30
    v_lshl_add_u32 v5, v5, 6, v31
    v_and_b32 v4, 7, v4
    v_lshl_add_u32 v20, v4, 3, v5
    v_mov_b32 v4, s12
    v_mov_b32 v5, s13
    v_cndmask_b32 v4, v4, v5, s[32:33]
    v_bfe_u32 v4, v4, v3, 8
    v_lshrrev_b32 v5, 3, v4
    v_xor_b32 v5, v5, v30
    v_lshl_add_u32 v5, v5, 6, v31
    v_and_b32 v4, 7, v4
    v_lshl_add_u32 v21, v4, 3, v5
    s_barrier
    ds_read_b128 v[32:35], v12 offset:0
    ds_read_b128 v[36:39], v16 offset:0
    ds_read_b64_tr_b16 v[48:49], v20 offset:0
    ds_read_b64_tr_b16 v[50:51], v20 offset:1024
    ds_read_b64_tr_b16 v[52:53], v21 offset:0
    ds_read_b64_tr_b16 v[54:55], v21 offset:1024
    ds_read_b128 v[40:43], v13 offset:0
    ds_read_b128 v[44:47], v17 offset:0
    ds_read_b64_tr_b16 v[56:57], v20 offset:4096
    ds_read_b64_tr_b16 v[58:59], v20 offset:5120
    ds_read_b64_tr_b16 v[60:61], v21 offset:4096
    ds_read_b64_tr_b16 v[62:63], v21 offset:5120
    s_waitcnt lgkmcnt(6)
    v_mfma_f32_32x32x16_bf16 v[64:79], v[48:51], v[32:35], 0
    ds_read_b128 v[148:151], v14 offset:0
    ds_read_b128 v[152:155], v18 offset:0
    s_lshl_b32 s41, s40, 14
    s_lshl_b32 s40, s40, 8
    s_mul_i32 s38, s24, s40
    s_sub_u32 s39, s40, s38
    v_mfma_f32_32x32x16_bf16 v[80:95], v[48:51], v[36:39], 0
    ds_read_b64_tr_b16 v[156:157], v20 offset:8192
    ds_read_b64_tr_b16 v[158:159], v20 offset:9216
    s_lshl_b32 s26, s20, 2
    s_lshl_b32 s27, s23, 1
    s_add_u32 s26, s26, s27
    s_mul_i32 s26, s26, s40
    v_mfma_f32_32x32x16_bf16 v[96:111], v[52:55], v[32:35], 0
    ds_read_b64_tr_b16 v[160:161], v21 offset:8192
    ds_read_b64_tr_b16 v[162:163], v21 offset:9216
    s_add_u32 s42, s42, s26
    v_and_b32 v7, 0x13, v0
    v_bfe_u32 v4, v0, 2, 1
    v_lshl_or_b32 v7, v4, 3, v7
    v_mfma_f32_32x32x16_bf16 v[112:127], v[52:55], v[36:39], 0
    v_bfe_u32 v4, v0, 3, 1
    v_lshl_or_b32 v7, v4, 2, v7
    v_lshlrev_b32 v8, 3, v7
    v_add_u32 v8, 1024, v8
    v_mfma_f32_4x4x4_16b_bf16 v[128:131], v[32:33], v[32:33], 0
    v_mfma_f32_16x16x32_bf16 v[136:139], v[144:147], v[32:35], 0
    v_mfma_f32_4x4x4_16b_bf16 v[132:135], v[34:35], v[34:35], 0
    v_mfma_f32_16x16x32_bf16 v[140:143], v[144:147], v[48:51], 0
    s_waitcnt lgkmcnt(6)
    v_mfma_f32_32x32x16_bf16 v[64:79], v[56:59], v[40:43], v[64:79]
    ds_read_b128 v[32:35], v15 offset:0
    ds_read_b128 v[36:39], v19 offset:0
    v_lshlrev_b32 v9, 4, v7
    s_mov_b32 s76, s74
    s_mov_b32 s77, s75
    s_mov_b32 s78, 26411008
    v_mfma_f32_32x32x16_bf16 v[80:95], v[56:59], v[44:47], v[80:95]
    ds_read_b64_tr_b16 v[48:49], v20 offset:12288
    ds_read_b64_tr_b16 v[50:51], v20 offset:13312
    s_mov_b32 s79, 0x20000
    v_mov_b32 v4, s6
    v_mov_b32 v5, s7
    v_cndmask_b32 v4, v4, v5, s[34:35]
    v_mfma_f32_32x32x16_bf16 v[96:111], v[60:63], v[40:43], v[96:111]
    ds_read_b64_tr_b16 v[52:53], v21 offset:12288
    ds_read_b64_tr_b16 v[54:55], v21 offset:13312
    v_bfe_u32 v5, v4, 8, 2
    v_cmp_eq_u32 vcc, 2, v5
    v_lshl_add_u32 v5, v5, 9, v9
    v_and_b32 v6, 31, v4
    v_mfma_f32_32x32x16_bf16 v[112:127], v[60:63], v[44:47], v[112:127]
    v_cndmask_b32 v5, v5, v8, vcc
    v_mul_lo_u32 v6, v6, s41
    v_add3_u32 v22, v6, v5, s42
    v_lshrrev_b32 v6, 16, v4
    v_mfma_f32_4x4x4_16b_bf16 v[128:131], v[40:41], v[40:41], v[128:131]
    v_mfma_f32_16x16x32_bf16 v[136:139], v[144:147], v[40:43], v[136:139]
    v_mfma_f32_4x4x4_16b_bf16 v[132:135], v[42:43], v[42:43], v[132:135]
    v_mfma_f32_16x16x32_bf16 v[140:143], v[144:147], v[56:59], v[140:143]
    s_waitcnt lgkmcnt(0)
    s_barrier
    v_mfma_f32_32x32x16_bf16 v[64:79], v[156:159], v[148:151], v[64:79]
    ds_read_b128 v[40:43], v12 offset:16384
    ds_read_b128 v[44:47], v16 offset:16384
    v_mul_lo_u32 v6, v6, s41
    v_add3_u32 v23, v6, v8, s42
    s_mov_b64 s[50:51], vcc
    v_mov_b32 v4, s8
    v_mfma_f32_32x32x16_bf16 v[80:95], v[156:159], v[152:155], v[80:95]
    ds_read_b64_tr_b16 v[56:57], v20 offset:16384
    ds_read_b64_tr_b16 v[58:59], v20 offset:17408
    v_mov_b32 v5, s9
    v_cndmask_b32 v4, v4, v5, s[34:35]
    v_bfe_u32 v5, v4, 8, 2
    v_cmp_eq_u32 vcc, 2, v5
    v_mfma_f32_32x32x16_bf16 v[96:111], v[160:163], v[148:151], v[96:111]
    ds_read_b64_tr_b16 v[60:61], v21 offset:16384
    ds_read_b64_tr_b16 v[62:63], v21 offset:17408
    v_lshl_add_u32 v5, v5, 9, v9
    v_and_b32 v6, 31, v4
    v_cndmask_b32 v5, v5, v8, vcc
    v_mul_lo_u32 v6, v6, s41
    v_mfma_f32_32x32x16_bf16 v[112:127], v[160:163], v[152:155], v[112:127]
    v_add3_u32 v24, v6, v5, s42
    v_lshrrev_b32 v6, 16, v4
    v_mul_lo_u32 v6, v6, s41
    v_add3_u32 v25, v6, v8, s42
    v_mfma_f32_4x4x4_16b_bf16 v[128:131], v[148:149], v[148:149], v[128:131]
    v_mfma_f32_16x16x32_bf16 v[136:139], v[144:147], v[148:151], v[136:139]
    v_mfma_f32_4x4x4_16b_bf16 v[132:135], v[150:151], v[150:151], v[132:135]
    v_mfma_f32_16x16x32_bf16 v[140:143], v[144:147], v[156:159], v[140:143]
    v_mfma_f32_32x32x16_bf16 v[64:79], v[48:51], v[32:35], v[64:79]
    ds_read_b128 v[148:151], v13 offset:16384
    ds_read_b128 v[152:155], v17 offset:16384
    v_mov_b32 v4, s14
    v_mov_b32 v5, s15
    v_cndmask_b32 v4, v4, v5, s[34:35]
    v_bfe_u32 v5, v4, 8, 2
    v_mfma_f32_32x32x16_bf16 v[80:95], v[48:51], v[36:39], v[80:95]
    ds_read_b64_tr_b16 v[156:157], v20 offset:20480
    ds_read_b64_tr_b16 v[158:159], v20 offset:21504
    v_cmp_eq_u32 vcc, 2, v5
    v_lshl_add_u32 v5, v5, 9, v9
    v_and_b32 v6, 31, v4
    v_cndmask_b32 v5, v5, v8, vcc
    v_mfma_f32_32x32x16_bf16 v[96:111], v[52:55], v[32:35], v[96:111]
    ds_read_b64_tr_b16 v[160:161], v21 offset:20480
    ds_read_b64_tr_b16 v[162:163], v21 offset:21504
    v_mul_lo_u32 v6, v6, s41
    v_add3_u32 v26, v6, v5, s42
    v_lshrrev_b32 v6, 16, v4
    v_mul_lo_u32 v6, v6, s41
    v_mfma_f32_32x32x16_bf16 v[112:127], v[52:55], v[36:39], v[112:127]
    v_add3_u32 v27, v6, v8, s42
    s_mov_b64 s[52:53], vcc
    v_mov_b32 v4, s16
    v_mov_b32 v5, s17
    v_mfma_f32_4x4x4_16b_bf16 v[128:131], v[32:33], v[32:33], v[128:131]
    v_mfma_f32_16x16x32_bf16 v[136:139], v[144:147], v[32:35], v[136:139]
    v_mfma_f32_4x4x4_16b_bf16 v[132:135], v[34:35], v[34:35], v[132:135]
    v_mfma_f32_16x16x32_bf16 v[140:143], v[144:147], v[48:51], v[140:143]
    s_waitcnt lgkmcnt(6)
    v_mfma_f32_32x32x16_bf16 v[64:79], v[56:59], v[40:43], v[64:79]
    ds_read_b128 v[32:35], v14 offset:16384
    ds_read_b128 v[36:39], v18 offset:16384
    v_cndmask_b32 v4, v4, v5, s[34:35]
    v_bfe_u32 v5, v4, 8, 2
    v_cmp_eq_u32 vcc, 2, v5
    v_lshl_add_u32 v5, v5, 9, v9
    v_mfma_f32_32x32x16_bf16 v[80:95], v[56:59], v[44:47], v[80:95]
    ds_read_b64_tr_b16 v[48:49], v20 offset:24576
    ds_read_b64_tr_b16 v[50:51], v20 offset:25600
    v_and_b32 v6, 31, v4
    v_cndmask_b32 v5, v5, v8, vcc
    v_mul_lo_u32 v6, v6, s41
    v_add3_u32 v28, v6, v5, s42
    v_mfma_f32_32x32x16_bf16 v[96:111], v[60:63], v[40:43], v[96:111]
    ds_read_b64_tr_b16 v[52:53], v21 offset:24576
    ds_read_b64_tr_b16 v[54:55], v21 offset:25600
    v_lshrrev_b32 v6, 16, v4
    v_mul_lo_u32 v6, v6, s41
    v_add3_u32 v29, v6, v8, s42
    s_lshl_b32 s32, s23, 6
    v_mfma_f32_32x32x16_bf16 v[112:127], v[60:63], v[44:47], v[112:127]
    s_lshl_b32 s33, s24, 5
    s_add_u32 s32, s32, s33
    s_lshl_b32 s33, s24, 6
    s_lshl_b32 s34, s23, 5
    v_mfma_f32_4x4x4_16b_bf16 v[128:131], v[40:41], v[40:41], v[128:131]
    v_mfma_f32_16x16x32_bf16 v[136:139], v[144:147], v[40:43], v[136:139]
    v_mfma_f32_4x4x4_16b_bf16 v[132:135], v[42:43], v[42:43], v[132:135]
    v_mfma_f32_16x16x32_bf16 v[140:143], v[144:147], v[56:59], v[140:143]
    s_waitcnt lgkmcnt(6)
    v_mfma_f32_32x32x16_bf16 v[64:79], v[156:159], v[148:151], v[64:79]
    ds_read_b128 v[40:43], v15 offset:16384
    ds_read_b128 v[44:47], v19 offset:16384
    s_add_u32 s33, s33, s34
    v_add_lshl_u32 v240, v1, s32, 2
    v_add_lshl_u32 v241, v1, s33, 2
    v_add_u32 v240, 131072, v240
    v_mfma_f32_32x32x16_bf16 v[80:95], v[156:159], v[152:155], v[80:95]
    ds_read_b64_tr_b16 v[56:57], v20 offset:28672
    ds_read_b64_tr_b16 v[58:59], v20 offset:29696
    v_add_u32 v241, 132096, v241
    v_mov_b32 v242, v240
    v_xor_b32 v243, 128, v242
    s_lshl_b32 s32, s24, 8
    v_mfma_f32_32x32x16_bf16 v[96:111], v[160:163], v[148:151], v[96:111]
    ds_read_b64_tr_b16 v[60:61], v21 offset:28672
    ds_read_b64_tr_b16 v[62:63], v21 offset:29696
    s_lshl_b32 s33, s23, 7
    s_add_u32 s32, s32, s33
    s_add_u32 s32, s32, 132096
    v_lshlrev_b32 v244, 4, v2
    v_mfma_f32_32x32x16_bf16 v[112:127], v[160:163], v[152:155], v[112:127]
    v_add_u32 v244, s32, v244
    v_xor_b32 v245, 128, v244
    v_and_b32 v3, 3, v0
    v_cmp_eq_u32 s[28:29], 1, v3
    v_mfma_f32_4x4x4_16b_bf16 v[128:131], v[148:149], v[148:149], v[128:131]
    v_mfma_f32_16x16x32_bf16 v[136:139], v[144:147], v[148:151], v[136:139]
    v_mfma_f32_4x4x4_16b_bf16 v[132:135], v[150:151], v[150:151], v[132:135]
    v_mfma_f32_16x16x32_bf16 v[140:143], v[144:147], v[156:159], v[140:143]
    s_waitcnt lgkmcnt(0)
    s_barrier
    v_mfma_f32_32x32x16_bf16 v[64:79], v[48:51], v[32:35], v[64:79]
    ds_read_b128 v[148:151], v12 offset:32768
    ds_read_b128 v[152:155], v16 offset:32768
    v_cmp_eq_u32 s[30:31], 2, v3
    v_cmp_eq_u32 s[44:45], 3, v3
    v_mfma_f32_32x32x16_bf16 v[80:95], v[48:51], v[36:39], v[80:95]
    ds_read_b64_tr_b16 v[156:157], v20 offset:32768
    ds_read_b64_tr_b16 v[158:159], v20 offset:33792
    v_mfma_f32_32x32x16_bf16 v[96:111], v[52:55], v[32:35], v[96:111]
    ds_read_b64_tr_b16 v[160:161], v21 offset:32768
    ds_read_b64_tr_b16 v[162:163], v21 offset:33792
    v_mfma_f32_32x32x16_bf16 v[112:127], v[52:55], v[36:39], v[112:127]
    v_mfma_f32_4x4x4_16b_bf16 v[128:131], v[32:33], v[32:33], v[128:131]
    v_mfma_f32_16x16x32_bf16 v[136:139], v[144:147], v[32:35], v[136:139]
    v_mfma_f32_4x4x4_16b_bf16 v[132:135], v[34:35], v[34:35], v[132:135]
    v_mfma_f32_16x16x32_bf16 v[140:143], v[144:147], v[48:51], v[140:143]
    v_mfma_f32_32x32x16_bf16 v[64:79], v[56:59], v[40:43], v[64:79]
    ds_read_b128 v[32:35], v13 offset:32768
    ds_read_b128 v[36:39], v17 offset:32768
    v_mfma_f32_32x32x16_bf16 v[80:95], v[56:59], v[44:47], v[80:95]
    ds_read_b64_tr_b16 v[48:49], v20 offset:36864
    ds_read_b64_tr_b16 v[50:51], v20 offset:37888
    v_mfma_f32_32x32x16_bf16 v[96:111], v[60:63], v[40:43], v[96:111]
    ds_read_b64_tr_b16 v[52:53], v21 offset:36864
    ds_read_b64_tr_b16 v[54:55], v21 offset:37888
    v_mfma_f32_32x32x16_bf16 v[112:127], v[60:63], v[44:47], v[112:127]
    v_mfma_f32_4x4x4_16b_bf16 v[128:131], v[40:41], v[40:41], v[128:131]
    v_mfma_f32_16x16x32_bf16 v[136:139], v[144:147], v[40:43], v[136:139]
    v_mfma_f32_4x4x4_16b_bf16 v[132:135], v[42:43], v[42:43], v[132:135]
    v_mfma_f32_16x16x32_bf16 v[140:143], v[144:147], v[56:59], v[140:143]
    s_waitcnt lgkmcnt(6)
    v_mfma_f32_32x32x16_bf16 v[64:79], v[156:159], v[148:151], v[64:79]
    ds_read_b128 v[40:43], v14 offset:32768
    ds_read_b128 v[44:47], v18 offset:32768
    v_mfma_f32_32x32x16_bf16 v[80:95], v[156:159], v[152:155], v[80:95]
    ds_read_b64_tr_b16 v[56:57], v20 offset:40960
    ds_read_b64_tr_b16 v[58:59], v20 offset:41984
    v_mfma_f32_32x32x16_bf16 v[96:111], v[160:163], v[148:151], v[96:111]
    ds_read_b64_tr_b16 v[60:61], v21 offset:40960
    ds_read_b64_tr_b16 v[62:63], v21 offset:41984
    v_mfma_f32_32x32x16_bf16 v[112:127], v[160:163], v[152:155], v[112:127]
    v_mfma_f32_4x4x4_16b_bf16 v[128:131], v[148:149], v[148:149], v[128:131]
    v_mfma_f32_16x16x32_bf16 v[136:139], v[144:147], v[148:151], v[136:139]
    v_mfma_f32_4x4x4_16b_bf16 v[132:135], v[150:151], v[150:151], v[132:135]
    v_mfma_f32_16x16x32_bf16 v[140:143], v[144:147], v[156:159], v[140:143]
    s_waitcnt lgkmcnt(6)
    v_mfma_f32_32x32x16_bf16 v[64:79], v[48:51], v[32:35], v[64:79]
    ds_read_b128 v[148:151], v15 offset:32768
    ds_read_b128 v[152:155], v19 offset:32768
    v_mfma_f32_32x32x16_bf16 v[80:95], v[48:51], v[36:39], v[80:95]
    ds_read_b64_tr_b16 v[156:157], v20 offset:45056
    ds_read_b64_tr_b16 v[158:159], v20 offset:46080
    v_mfma_f32_32x32x16_bf16 v[96:111], v[52:55], v[32:35], v[96:111]
    ds_read_b64_tr_b16 v[160:161], v21 offset:45056
    ds_read_b64_tr_b16 v[162:163], v21 offset:46080
    v_mfma_f32_32x32x16_bf16 v[112:127], v[52:55], v[36:39], v[112:127]
    v_mfma_f32_4x4x4_16b_bf16 v[128:131], v[32:33], v[32:33], v[128:131]
    v_mfma_f32_16x16x32_bf16 v[136:139], v[144:147], v[32:35], v[136:139]
    v_mfma_f32_4x4x4_16b_bf16 v[132:135], v[34:35], v[34:35], v[132:135]
    v_mfma_f32_16x16x32_bf16 v[140:143], v[144:147], v[48:51], v[140:143]
    s_waitcnt lgkmcnt(0)
    s_barrier
    v_mfma_f32_32x32x16_bf16 v[64:79], v[56:59], v[40:43], v[64:79]
    ds_read_b128 v[32:35], v12 offset:49152
    ds_read_b128 v[36:39], v16 offset:49152
    v_mfma_f32_32x32x16_bf16 v[80:95], v[56:59], v[44:47], v[80:95]
    ds_read_b64_tr_b16 v[48:49], v20 offset:49152
    ds_read_b64_tr_b16 v[50:51], v20 offset:50176
    v_mfma_f32_32x32x16_bf16 v[96:111], v[60:63], v[40:43], v[96:111]
    ds_read_b64_tr_b16 v[52:53], v21 offset:49152
    ds_read_b64_tr_b16 v[54:55], v21 offset:50176
    v_mfma_f32_32x32x16_bf16 v[112:127], v[60:63], v[44:47], v[112:127]
    v_mfma_f32_4x4x4_16b_bf16 v[128:131], v[40:41], v[40:41], v[128:131]
    v_mfma_f32_16x16x32_bf16 v[136:139], v[144:147], v[40:43], v[136:139]
    v_mfma_f32_4x4x4_16b_bf16 v[132:135], v[42:43], v[42:43], v[132:135]
    v_mfma_f32_16x16x32_bf16 v[140:143], v[144:147], v[56:59], v[140:143]
    v_mfma_f32_32x32x16_bf16 v[64:79], v[156:159], v[148:151], v[64:79]
    ds_read_b128 v[40:43], v13 offset:49152
    ds_read_b128 v[44:47], v17 offset:49152
    v_mfma_f32_32x32x16_bf16 v[80:95], v[156:159], v[152:155], v[80:95]
    ds_read_b64_tr_b16 v[56:57], v20 offset:53248
    ds_read_b64_tr_b16 v[58:59], v20 offset:54272
    v_mfma_f32_32x32x16_bf16 v[96:111], v[160:163], v[148:151], v[96:111]
    ds_read_b64_tr_b16 v[60:61], v21 offset:53248
    ds_read_b64_tr_b16 v[62:63], v21 offset:54272
    v_mfma_f32_32x32x16_bf16 v[112:127], v[160:163], v[152:155], v[112:127]
    v_mfma_f32_4x4x4_16b_bf16 v[128:131], v[148:149], v[148:149], v[128:131]
    v_mfma_f32_16x16x32_bf16 v[136:139], v[144:147], v[148:151], v[136:139]
    v_mfma_f32_4x4x4_16b_bf16 v[132:135], v[150:151], v[150:151], v[132:135]
    v_mfma_f32_16x16x32_bf16 v[140:143], v[144:147], v[156:159], v[140:143]
    s_waitcnt lgkmcnt(6)
    v_mfma_f32_32x32x16_bf16 v[64:79], v[48:51], v[32:35], v[64:79]
    ds_read_b128 v[148:151], v14 offset:49152
    ds_read_b128 v[152:155], v18 offset:49152
    v_mfma_f32_32x32x16_bf16 v[80:95], v[48:51], v[36:39], v[80:95]
    ds_read_b64_tr_b16 v[156:157], v20 offset:57344
    ds_read_b64_tr_b16 v[158:159], v20 offset:58368
    v_mfma_f32_32x32x16_bf16 v[96:111], v[52:55], v[32:35], v[96:111]
    ds_read_b64_tr_b16 v[160:161], v21 offset:57344
    ds_read_b64_tr_b16 v[162:163], v21 offset:58368
    v_mfma_f32_32x32x16_bf16 v[112:127], v[52:55], v[36:39], v[112:127]
    v_mfma_f32_4x4x4_16b_bf16 v[128:131], v[32:33], v[32:33], v[128:131]
    v_mfma_f32_16x16x32_bf16 v[136:139], v[144:147], v[32:35], v[136:139]
    v_mfma_f32_4x4x4_16b_bf16 v[132:135], v[34:35], v[34:35], v[132:135]
    v_mfma_f32_16x16x32_bf16 v[140:143], v[144:147], v[48:51], v[140:143]
    s_waitcnt lgkmcnt(6)
    v_mfma_f32_32x32x16_bf16 v[64:79], v[56:59], v[40:43], v[64:79]
    ds_read_b128 v[32:35], v15 offset:49152
    ds_read_b128 v[36:39], v19 offset:49152
    v_mfma_f32_32x32x16_bf16 v[80:95], v[56:59], v[44:47], v[80:95]
    ds_read_b64_tr_b16 v[48:49], v20 offset:61440
    ds_read_b64_tr_b16 v[50:51], v20 offset:62464
    v_mfma_f32_32x32x16_bf16 v[96:111], v[60:63], v[40:43], v[96:111]
    ds_read_b64_tr_b16 v[52:53], v21 offset:61440
    ds_read_b64_tr_b16 v[54:55], v21 offset:62464
    v_mfma_f32_32x32x16_bf16 v[112:127], v[60:63], v[44:47], v[112:127]
    v_mfma_f32_4x4x4_16b_bf16 v[128:131], v[40:41], v[40:41], v[128:131]
    v_mfma_f32_16x16x32_bf16 v[136:139], v[144:147], v[40:43], v[136:139]
    v_mfma_f32_4x4x4_16b_bf16 v[132:135], v[42:43], v[42:43], v[132:135]
    v_mfma_f32_16x16x32_bf16 v[140:143], v[144:147], v[56:59], v[140:143]
    s_waitcnt lgkmcnt(0)
    s_barrier
    v_mfma_f32_32x32x16_bf16 v[64:79], v[156:159], v[148:151], v[64:79]
    ds_read_b128 v[40:43], v12 offset:0
    ds_read_b128 v[44:47], v16 offset:0
    v_mfma_f32_32x32x16_bf16 v[80:95], v[156:159], v[152:155], v[80:95]
    ds_read_b64_tr_b16 v[56:57], v20 offset:0
    ds_read_b64_tr_b16 v[58:59], v20 offset:1024
    v_mfma_f32_32x32x16_bf16 v[96:111], v[160:163], v[148:151], v[96:111]
    ds_read_b64_tr_b16 v[60:61], v21 offset:0
    ds_read_b64_tr_b16 v[62:63], v21 offset:1024
    v_mfma_f32_32x32x16_bf16 v[112:127], v[160:163], v[152:155], v[112:127]
    v_mfma_f32_4x4x4_16b_bf16 v[128:131], v[148:149], v[148:149], v[128:131]
    v_mfma_f32_16x16x32_bf16 v[136:139], v[144:147], v[148:151], v[136:139]
    v_mfma_f32_4x4x4_16b_bf16 v[132:135], v[150:151], v[150:151], v[132:135]
    v_mfma_f32_16x16x32_bf16 v[140:143], v[144:147], v[156:159], v[140:143]
    v_mfma_f32_32x32x16_bf16 v[64:79], v[48:51], v[32:35], v[64:79]
    ds_read_b128 v[148:151], v13 offset:0
    ds_read_b128 v[152:155], v17 offset:0
    v_mfma_f32_32x32x16_bf16 v[80:95], v[48:51], v[36:39], v[80:95]
    ds_read_b64_tr_b16 v[156:157], v20 offset:4096
    ds_read_b64_tr_b16 v[158:159], v20 offset:5120
    v_mfma_f32_32x32x16_bf16 v[96:111], v[52:55], v[32:35], v[96:111]
    ds_read_b64_tr_b16 v[160:161], v21 offset:4096
    ds_read_b64_tr_b16 v[162:163], v21 offset:5120
    v_mfma_f32_32x32x16_bf16 v[112:127], v[52:55], v[36:39], v[112:127]
    v_mfma_f32_4x4x4_16b_bf16 v[128:131], v[32:33], v[32:33], v[128:131]
    v_mfma_f32_16x16x32_bf16 v[136:139], v[144:147], v[32:35], v[136:139]
    v_mfma_f32_4x4x4_16b_bf16 v[132:135], v[34:35], v[34:35], v[132:135]
    v_mfma_f32_16x16x32_bf16 v[140:143], v[144:147], v[48:51], v[140:143]
    s_waitcnt lgkmcnt(6)
    v_mfma_f32_32x32x16_bf16 v[64:79], v[56:59], v[40:43], v[64:79]
    ds_read_b128 v[32:35], v14 offset:0
    ds_read_b128 v[36:39], v18 offset:0
    v_mfma_f32_32x32x16_bf16 v[80:95], v[56:59], v[44:47], v[80:95]
    ds_read_b64_tr_b16 v[48:49], v20 offset:8192
    ds_read_b64_tr_b16 v[50:51], v20 offset:9216
    v_mfma_f32_32x32x16_bf16 v[96:111], v[60:63], v[40:43], v[96:111]
    ds_read_b64_tr_b16 v[52:53], v21 offset:8192
    ds_read_b64_tr_b16 v[54:55], v21 offset:9216
    v_mfma_f32_32x32x16_bf16 v[112:127], v[60:63], v[44:47], v[112:127]
    v_mfma_f32_4x4x4_16b_bf16 v[128:131], v[40:41], v[40:41], v[128:131]
    v_mfma_f32_16x16x32_bf16 v[136:139], v[144:147], v[40:43], v[136:139]
    v_mfma_f32_4x4x4_16b_bf16 v[132:135], v[42:43], v[42:43], v[132:135]
    v_mfma_f32_16x16x32_bf16 v[140:143], v[144:147], v[56:59], v[140:143]
    s_waitcnt lgkmcnt(6)
    v_mfma_f32_32x32x16_bf16 v[64:79], v[156:159], v[148:151], v[64:79]
    ds_read_b128 v[40:43], v15 offset:0
    ds_read_b128 v[44:47], v19 offset:0
    v_mfma_f32_32x32x16_bf16 v[80:95], v[156:159], v[152:155], v[80:95]
    ds_read_b64_tr_b16 v[56:57], v20 offset:12288
    ds_read_b64_tr_b16 v[58:59], v20 offset:13312
    v_mfma_f32_32x32x16_bf16 v[96:111], v[160:163], v[148:151], v[96:111]
    ds_read_b64_tr_b16 v[60:61], v21 offset:12288
    ds_read_b64_tr_b16 v[62:63], v21 offset:13312
    v_mfma_f32_32x32x16_bf16 v[112:127], v[160:163], v[152:155], v[112:127]
    v_mfma_f32_4x4x4_16b_bf16 v[128:131], v[148:149], v[148:149], v[128:131]
    v_mfma_f32_16x16x32_bf16 v[136:139], v[144:147], v[148:151], v[136:139]
    v_mfma_f32_4x4x4_16b_bf16 v[132:135], v[150:151], v[150:151], v[132:135]
    v_mfma_f32_16x16x32_bf16 v[140:143], v[144:147], v[156:159], v[140:143]
    s_waitcnt lgkmcnt(0)
    s_barrier
    v_mfma_f32_32x32x16_bf16 v[64:79], v[48:51], v[32:35], v[64:79]
    ds_read_b128 v[148:151], v12 offset:16384
    ds_read_b128 v[152:155], v16 offset:16384
    v_mfma_f32_32x32x16_bf16 v[80:95], v[48:51], v[36:39], v[80:95]
    ds_read_b64_tr_b16 v[156:157], v20 offset:16384
    ds_read_b64_tr_b16 v[158:159], v20 offset:17408
    v_mfma_f32_32x32x16_bf16 v[96:111], v[52:55], v[32:35], v[96:111]
    ds_read_b64_tr_b16 v[160:161], v21 offset:16384
    ds_read_b64_tr_b16 v[162:163], v21 offset:17408
    v_mfma_f32_32x32x16_bf16 v[112:127], v[52:55], v[36:39], v[112:127]
    v_mfma_f32_4x4x4_16b_bf16 v[128:131], v[32:33], v[32:33], v[128:131]
    v_mfma_f32_16x16x32_bf16 v[136:139], v[144:147], v[32:35], v[136:139]
    v_mfma_f32_4x4x4_16b_bf16 v[132:135], v[34:35], v[34:35], v[132:135]
    v_mfma_f32_16x16x32_bf16 v[140:143], v[144:147], v[48:51], v[140:143]
    v_mfma_f32_32x32x16_bf16 v[64:79], v[56:59], v[40:43], v[64:79]
    ds_read_b128 v[32:35], v13 offset:16384
    ds_read_b128 v[36:39], v17 offset:16384
    v_mfma_f32_32x32x16_bf16 v[80:95], v[56:59], v[44:47], v[80:95]
    ds_read_b64_tr_b16 v[48:49], v20 offset:20480
    ds_read_b64_tr_b16 v[50:51], v20 offset:21504
    v_mfma_f32_32x32x16_bf16 v[96:111], v[60:63], v[40:43], v[96:111]
    ds_read_b64_tr_b16 v[52:53], v21 offset:20480
    ds_read_b64_tr_b16 v[54:55], v21 offset:21504
    v_mfma_f32_32x32x16_bf16 v[112:127], v[60:63], v[44:47], v[112:127]
    v_mfma_f32_4x4x4_16b_bf16 v[128:131], v[40:41], v[40:41], v[128:131]
    v_mfma_f32_16x16x32_bf16 v[136:139], v[144:147], v[40:43], v[136:139]
    v_mfma_f32_4x4x4_16b_bf16 v[132:135], v[42:43], v[42:43], v[132:135]
    v_mfma_f32_16x16x32_bf16 v[140:143], v[144:147], v[56:59], v[140:143]
    s_waitcnt lgkmcnt(6)
    v_mfma_f32_32x32x16_bf16 v[64:79], v[156:159], v[148:151], v[64:79]
    ds_read_b128 v[40:43], v14 offset:16384
    ds_read_b128 v[44:47], v18 offset:16384
    v_mfma_f32_32x32x16_bf16 v[80:95], v[156:159], v[152:155], v[80:95]
    ds_read_b64_tr_b16 v[56:57], v20 offset:24576
    ds_read_b64_tr_b16 v[58:59], v20 offset:25600
    v_mfma_f32_32x32x16_bf16 v[96:111], v[160:163], v[148:151], v[96:111]
    ds_read_b64_tr_b16 v[60:61], v21 offset:24576
    ds_read_b64_tr_b16 v[62:63], v21 offset:25600
    v_mfma_f32_32x32x16_bf16 v[112:127], v[160:163], v[152:155], v[112:127]
    v_mfma_f32_4x4x4_16b_bf16 v[128:131], v[148:149], v[148:149], v[128:131]
    v_mfma_f32_16x16x32_bf16 v[136:139], v[144:147], v[148:151], v[136:139]
    v_mfma_f32_4x4x4_16b_bf16 v[132:135], v[150:151], v[150:151], v[132:135]
    v_mfma_f32_16x16x32_bf16 v[140:143], v[144:147], v[156:159], v[140:143]
    s_waitcnt lgkmcnt(6)
    v_mfma_f32_32x32x16_bf16 v[64:79], v[48:51], v[32:35], v[64:79]
    ds_read_b128 v[148:151], v15 offset:16384
    ds_read_b128 v[152:155], v19 offset:16384
    v_mfma_f32_32x32x16_bf16 v[80:95], v[48:51], v[36:39], v[80:95]
    ds_read_b64_tr_b16 v[156:157], v20 offset:28672
    ds_read_b64_tr_b16 v[158:159], v20 offset:29696
    v_mfma_f32_32x32x16_bf16 v[96:111], v[52:55], v[32:35], v[96:111]
    ds_read_b64_tr_b16 v[160:161], v21 offset:28672
    ds_read_b64_tr_b16 v[162:163], v21 offset:29696
    v_mfma_f32_32x32x16_bf16 v[112:127], v[52:55], v[36:39], v[112:127]
    v_mfma_f32_4x4x4_16b_bf16 v[128:131], v[32:33], v[32:33], v[128:131]
    v_mfma_f32_16x16x32_bf16 v[136:139], v[144:147], v[32:35], v[136:139]
    v_mfma_f32_4x4x4_16b_bf16 v[132:135], v[34:35], v[34:35], v[132:135]
    v_mfma_f32_16x16x32_bf16 v[140:143], v[144:147], v[48:51], v[140:143]
    s_waitcnt lgkmcnt(0)
    s_barrier
    v_mfma_f32_32x32x16_bf16 v[64:79], v[56:59], v[40:43], v[64:79]
    ds_read_b128 v[32:35], v12 offset:32768
    ds_read_b128 v[36:39], v16 offset:32768
    v_mfma_f32_32x32x16_bf16 v[80:95], v[56:59], v[44:47], v[80:95]
    ds_read_b64_tr_b16 v[48:49], v20 offset:32768
    ds_read_b64_tr_b16 v[50:51], v20 offset:33792
    v_mfma_f32_32x32x16_bf16 v[96:111], v[60:63], v[40:43], v[96:111]
    ds_read_b64_tr_b16 v[52:53], v21 offset:32768
    ds_read_b64_tr_b16 v[54:55], v21 offset:33792
    v_mfma_f32_32x32x16_bf16 v[112:127], v[60:63], v[44:47], v[112:127]
    v_mfma_f32_4x4x4_16b_bf16 v[128:131], v[40:41], v[40:41], v[128:131]
    v_mfma_f32_16x16x32_bf16 v[136:139], v[144:147], v[40:43], v[136:139]
    v_mfma_f32_4x4x4_16b_bf16 v[132:135], v[42:43], v[42:43], v[132:135]
    v_mfma_f32_16x16x32_bf16 v[140:143], v[144:147], v[56:59], v[140:143]
    v_mfma_f32_32x32x16_bf16 v[64:79], v[156:159], v[148:151], v[64:79]
    ds_read_b128 v[40:43], v13 offset:32768
    ds_read_b128 v[44:47], v17 offset:32768
    v_mfma_f32_32x32x16_bf16 v[80:95], v[156:159], v[152:155], v[80:95]
    ds_read_b64_tr_b16 v[56:57], v20 offset:36864
    ds_read_b64_tr_b16 v[58:59], v20 offset:37888
    v_mfma_f32_32x32x16_bf16 v[96:111], v[160:163], v[148:151], v[96:111]
    ds_read_b64_tr_b16 v[60:61], v21 offset:36864
    ds_read_b64_tr_b16 v[62:63], v21 offset:37888
    v_mfma_f32_32x32x16_bf16 v[112:127], v[160:163], v[152:155], v[112:127]
    v_mfma_f32_4x4x4_16b_bf16 v[128:131], v[148:149], v[148:149], v[128:131]
    v_mfma_f32_16x16x32_bf16 v[136:139], v[144:147], v[148:151], v[136:139]
    v_mfma_f32_4x4x4_16b_bf16 v[132:135], v[150:151], v[150:151], v[132:135]
    v_mfma_f32_16x16x32_bf16 v[140:143], v[144:147], v[156:159], v[140:143]
    s_waitcnt lgkmcnt(6)
    v_mfma_f32_32x32x16_bf16 v[64:79], v[48:51], v[32:35], v[64:79]
    ds_read_b128 v[148:151], v14 offset:32768
    ds_read_b128 v[152:155], v18 offset:32768
    v_mfma_f32_32x32x16_bf16 v[80:95], v[48:51], v[36:39], v[80:95]
    ds_read_b64_tr_b16 v[156:157], v20 offset:40960
    ds_read_b64_tr_b16 v[158:159], v20 offset:41984
    v_mfma_f32_32x32x16_bf16 v[96:111], v[52:55], v[32:35], v[96:111]
    ds_read_b64_tr_b16 v[160:161], v21 offset:40960
    ds_read_b64_tr_b16 v[162:163], v21 offset:41984
    v_mfma_f32_32x32x16_bf16 v[112:127], v[52:55], v[36:39], v[112:127]
    v_mfma_f32_4x4x4_16b_bf16 v[128:131], v[32:33], v[32:33], v[128:131]
    v_mfma_f32_16x16x32_bf16 v[136:139], v[144:147], v[32:35], v[136:139]
    v_mfma_f32_4x4x4_16b_bf16 v[132:135], v[34:35], v[34:35], v[132:135]
    v_mfma_f32_16x16x32_bf16 v[140:143], v[144:147], v[48:51], v[140:143]
    s_waitcnt lgkmcnt(6)
    v_mfma_f32_32x32x16_bf16 v[64:79], v[56:59], v[40:43], v[64:79]
    ds_read_b128 v[32:35], v15 offset:32768
    ds_read_b128 v[36:39], v19 offset:32768
    v_mfma_f32_32x32x16_bf16 v[80:95], v[56:59], v[44:47], v[80:95]
    ds_read_b64_tr_b16 v[48:49], v20 offset:45056
    ds_read_b64_tr_b16 v[50:51], v20 offset:46080
    v_mfma_f32_32x32x16_bf16 v[96:111], v[60:63], v[40:43], v[96:111]
    ds_read_b64_tr_b16 v[52:53], v21 offset:45056
    ds_read_b64_tr_b16 v[54:55], v21 offset:46080
    v_mfma_f32_32x32x16_bf16 v[112:127], v[60:63], v[44:47], v[112:127]
    v_mfma_f32_4x4x4_16b_bf16 v[128:131], v[40:41], v[40:41], v[128:131]
    v_mfma_f32_16x16x32_bf16 v[136:139], v[144:147], v[40:43], v[136:139]
    v_mfma_f32_4x4x4_16b_bf16 v[132:135], v[42:43], v[42:43], v[132:135]
    v_mfma_f32_16x16x32_bf16 v[140:143], v[144:147], v[56:59], v[140:143]
    s_waitcnt lgkmcnt(0)
    s_barrier
    v_mfma_f32_32x32x16_bf16 v[64:79], v[156:159], v[148:151], v[64:79]
    ds_read_b128 v[40:43], v12 offset:49152
    ds_read_b128 v[44:47], v16 offset:49152
    v_mfma_f32_32x32x16_bf16 v[80:95], v[156:159], v[152:155], v[80:95]
    ds_read_b64_tr_b16 v[56:57], v20 offset:49152
    ds_read_b64_tr_b16 v[58:59], v20 offset:50176
    v_mfma_f32_32x32x16_bf16 v[96:111], v[160:163], v[148:151], v[96:111]
    ds_read_b64_tr_b16 v[60:61], v21 offset:49152
    ds_read_b64_tr_b16 v[62:63], v21 offset:50176
    v_mfma_f32_32x32x16_bf16 v[112:127], v[160:163], v[152:155], v[112:127]
    v_mfma_f32_4x4x4_16b_bf16 v[128:131], v[148:149], v[148:149], v[128:131]
    v_mfma_f32_16x16x32_bf16 v[136:139], v[144:147], v[148:151], v[136:139]
    v_mfma_f32_4x4x4_16b_bf16 v[132:135], v[150:151], v[150:151], v[132:135]
    v_mfma_f32_16x16x32_bf16 v[140:143], v[144:147], v[156:159], v[140:143]
    v_mfma_f32_32x32x16_bf16 v[64:79], v[48:51], v[32:35], v[64:79]
    ds_read_b128 v[148:151], v13 offset:49152
    ds_read_b128 v[152:155], v17 offset:49152
    v_mfma_f32_32x32x16_bf16 v[80:95], v[48:51], v[36:39], v[80:95]
    ds_read_b64_tr_b16 v[156:157], v20 offset:53248
    ds_read_b64_tr_b16 v[158:159], v20 offset:54272
    v_mfma_f32_32x32x16_bf16 v[96:111], v[52:55], v[32:35], v[96:111]
    ds_read_b64_tr_b16 v[160:161], v21 offset:53248
    ds_read_b64_tr_b16 v[162:163], v21 offset:54272
    v_mfma_f32_32x32x16_bf16 v[112:127], v[52:55], v[36:39], v[112:127]
    v_mfma_f32_4x4x4_16b_bf16 v[128:131], v[32:33], v[32:33], v[128:131]
    v_mfma_f32_16x16x32_bf16 v[136:139], v[144:147], v[32:35], v[136:139]
    v_mfma_f32_4x4x4_16b_bf16 v[132:135], v[34:35], v[34:35], v[132:135]
    v_mfma_f32_16x16x32_bf16 v[140:143], v[144:147], v[48:51], v[140:143]
    s_waitcnt lgkmcnt(6)
    v_mfma_f32_32x32x16_bf16 v[64:79], v[56:59], v[40:43], v[64:79]
    ds_read_b128 v[32:35], v14 offset:49152
    ds_read_b128 v[36:39], v18 offset:49152
    v_mfma_f32_32x32x16_bf16 v[80:95], v[56:59], v[44:47], v[80:95]
    ds_read_b64_tr_b16 v[48:49], v20 offset:57344
    ds_read_b64_tr_b16 v[50:51], v20 offset:58368
    v_mfma_f32_32x32x16_bf16 v[96:111], v[60:63], v[40:43], v[96:111]
    ds_read_b64_tr_b16 v[52:53], v21 offset:57344
    ds_read_b64_tr_b16 v[54:55], v21 offset:58368
    v_mfma_f32_32x32x16_bf16 v[112:127], v[60:63], v[44:47], v[112:127]
    v_mfma_f32_4x4x4_16b_bf16 v[128:131], v[40:41], v[40:41], v[128:131]
    v_mfma_f32_16x16x32_bf16 v[136:139], v[144:147], v[40:43], v[136:139]
    v_mfma_f32_4x4x4_16b_bf16 v[132:135], v[42:43], v[42:43], v[132:135]
    v_mfma_f32_16x16x32_bf16 v[140:143], v[144:147], v[56:59], v[140:143]
    s_waitcnt lgkmcnt(6)
    v_mfma_f32_32x32x16_bf16 v[64:79], v[156:159], v[148:151], v[64:79]
    ds_read_b128 v[40:43], v15 offset:49152
    ds_read_b128 v[44:47], v19 offset:49152
    v_mfma_f32_32x32x16_bf16 v[80:95], v[156:159], v[152:155], v[80:95]
    ds_read_b64_tr_b16 v[56:57], v20 offset:61440
    ds_read_b64_tr_b16 v[58:59], v20 offset:62464
    v_mfma_f32_32x32x16_bf16 v[96:111], v[160:163], v[148:151], v[96:111]
    ds_read_b64_tr_b16 v[60:61], v21 offset:61440
    ds_read_b64_tr_b16 v[62:63], v21 offset:62464
    v_mfma_f32_32x32x16_bf16 v[112:127], v[160:163], v[152:155], v[112:127]
    v_mfma_f32_4x4x4_16b_bf16 v[128:131], v[148:149], v[148:149], v[128:131]
    v_mfma_f32_16x16x32_bf16 v[136:139], v[144:147], v[148:151], v[136:139]
    v_mfma_f32_4x4x4_16b_bf16 v[132:135], v[150:151], v[150:151], v[132:135]
    v_mfma_f32_16x16x32_bf16 v[140:143], v[144:147], v[156:159], v[140:143]
    s_waitcnt lgkmcnt(0)
    s_barrier
    v_mfma_f32_32x32x16_bf16 v[64:79], v[48:51], v[32:35], v[64:79]
    ds_read_b128 v[148:151], v12 offset:0
    ds_read_b128 v[152:155], v16 offset:0
    v_mfma_f32_32x32x16_bf16 v[80:95], v[48:51], v[36:39], v[80:95]
    ds_read_b64_tr_b16 v[156:157], v20 offset:0
    ds_read_b64_tr_b16 v[158:159], v20 offset:1024
    v_mfma_f32_32x32x16_bf16 v[96:111], v[52:55], v[32:35], v[96:111]
    ds_read_b64_tr_b16 v[160:161], v21 offset:0
    ds_read_b64_tr_b16 v[162:163], v21 offset:1024
    v_mfma_f32_32x32x16_bf16 v[112:127], v[52:55], v[36:39], v[112:127]
    v_mfma_f32_4x4x4_16b_bf16 v[128:131], v[32:33], v[32:33], v[128:131]
    v_mfma_f32_16x16x32_bf16 v[136:139], v[144:147], v[32:35], v[136:139]
    v_mfma_f32_4x4x4_16b_bf16 v[132:135], v[34:35], v[34:35], v[132:135]
    v_mfma_f32_16x16x32_bf16 v[140:143], v[144:147], v[48:51], v[140:143]
    v_mfma_f32_32x32x16_bf16 v[64:79], v[56:59], v[40:43], v[64:79]
    ds_read_b128 v[32:35], v13 offset:0
    ds_read_b128 v[36:39], v17 offset:0
    v_mfma_f32_32x32x16_bf16 v[80:95], v[56:59], v[44:47], v[80:95]
    ds_read_b64_tr_b16 v[48:49], v20 offset:4096
    ds_read_b64_tr_b16 v[50:51], v20 offset:5120
    v_mfma_f32_32x32x16_bf16 v[96:111], v[60:63], v[40:43], v[96:111]
    ds_read_b64_tr_b16 v[52:53], v21 offset:4096
    ds_read_b64_tr_b16 v[54:55], v21 offset:5120
    v_mfma_f32_32x32x16_bf16 v[112:127], v[60:63], v[44:47], v[112:127]
    v_mfma_f32_4x4x4_16b_bf16 v[128:131], v[40:41], v[40:41], v[128:131]
    v_mfma_f32_16x16x32_bf16 v[136:139], v[144:147], v[40:43], v[136:139]
    v_mfma_f32_4x4x4_16b_bf16 v[132:135], v[42:43], v[42:43], v[132:135]
    v_mfma_f32_16x16x32_bf16 v[140:143], v[144:147], v[56:59], v[140:143]
    s_waitcnt lgkmcnt(6)
    v_mfma_f32_32x32x16_bf16 v[64:79], v[156:159], v[148:151], v[64:79]
    ds_read_b128 v[40:43], v14 offset:0
    ds_read_b128 v[44:47], v18 offset:0
    v_mfma_f32_32x32x16_bf16 v[80:95], v[156:159], v[152:155], v[80:95]
    ds_read_b64_tr_b16 v[56:57], v20 offset:8192
    ds_read_b64_tr_b16 v[58:59], v20 offset:9216
    v_mfma_f32_32x32x16_bf16 v[96:111], v[160:163], v[148:151], v[96:111]
    ds_read_b64_tr_b16 v[60:61], v21 offset:8192
    ds_read_b64_tr_b16 v[62:63], v21 offset:9216
    v_mfma_f32_32x32x16_bf16 v[112:127], v[160:163], v[152:155], v[112:127]
    v_mfma_f32_4x4x4_16b_bf16 v[128:131], v[148:149], v[148:149], v[128:131]
    v_mfma_f32_16x16x32_bf16 v[136:139], v[144:147], v[148:151], v[136:139]
    v_mfma_f32_4x4x4_16b_bf16 v[132:135], v[150:151], v[150:151], v[132:135]
    v_mfma_f32_16x16x32_bf16 v[140:143], v[144:147], v[156:159], v[140:143]
    s_waitcnt lgkmcnt(6)
    v_mfma_f32_32x32x16_bf16 v[64:79], v[48:51], v[32:35], v[64:79]
    ds_read_b128 v[148:151], v15 offset:0
    ds_read_b128 v[152:155], v19 offset:0
    v_mfma_f32_32x32x16_bf16 v[80:95], v[48:51], v[36:39], v[80:95]
    ds_read_b64_tr_b16 v[156:157], v20 offset:12288
    ds_read_b64_tr_b16 v[158:159], v20 offset:13312
    v_mfma_f32_32x32x16_bf16 v[96:111], v[52:55], v[32:35], v[96:111]
    ds_read_b64_tr_b16 v[160:161], v21 offset:12288
    ds_read_b64_tr_b16 v[162:163], v21 offset:13312
    v_mfma_f32_32x32x16_bf16 v[112:127], v[52:55], v[36:39], v[112:127]
    v_mfma_f32_4x4x4_16b_bf16 v[128:131], v[32:33], v[32:33], v[128:131]
    v_mfma_f32_16x16x32_bf16 v[136:139], v[144:147], v[32:35], v[136:139]
    v_mfma_f32_4x4x4_16b_bf16 v[132:135], v[34:35], v[34:35], v[132:135]
    v_mfma_f32_16x16x32_bf16 v[140:143], v[144:147], v[48:51], v[140:143]
    s_waitcnt lgkmcnt(0)
    s_barrier
    v_mfma_f32_32x32x16_bf16 v[64:79], v[56:59], v[40:43], v[64:79]
    ds_read_b128 v[32:35], v12 offset:16384
    ds_read_b128 v[36:39], v16 offset:16384
    v_mfma_f32_32x32x16_bf16 v[80:95], v[56:59], v[44:47], v[80:95]
    ds_read_b64_tr_b16 v[48:49], v20 offset:16384
    ds_read_b64_tr_b16 v[50:51], v20 offset:17408
    v_mfma_f32_32x32x16_bf16 v[96:111], v[60:63], v[40:43], v[96:111]
    ds_read_b64_tr_b16 v[52:53], v21 offset:16384
    ds_read_b64_tr_b16 v[54:55], v21 offset:17408
    v_mfma_f32_32x32x16_bf16 v[112:127], v[60:63], v[44:47], v[112:127]
    v_mfma_f32_4x4x4_16b_bf16 v[128:131], v[40:41], v[40:41], v[128:131]
    v_mfma_f32_16x16x32_bf16 v[136:139], v[144:147], v[40:43], v[136:139]
    v_mfma_f32_4x4x4_16b_bf16 v[132:135], v[42:43], v[42:43], v[132:135]
    v_mfma_f32_16x16x32_bf16 v[140:143], v[144:147], v[56:59], v[140:143]
    v_mfma_f32_32x32x16_bf16 v[64:79], v[156:159], v[148:151], v[64:79]
    ds_read_b128 v[40:43], v13 offset:16384
    ds_read_b128 v[44:47], v17 offset:16384
    v_mfma_f32_32x32x16_bf16 v[80:95], v[156:159], v[152:155], v[80:95]
    ds_read_b64_tr_b16 v[56:57], v20 offset:20480
    ds_read_b64_tr_b16 v[58:59], v20 offset:21504
    v_mfma_f32_32x32x16_bf16 v[96:111], v[160:163], v[148:151], v[96:111]
    ds_read_b64_tr_b16 v[60:61], v21 offset:20480
    ds_read_b64_tr_b16 v[62:63], v21 offset:21504
    v_mfma_f32_32x32x16_bf16 v[112:127], v[160:163], v[152:155], v[112:127]
    v_mfma_f32_4x4x4_16b_bf16 v[128:131], v[148:149], v[148:149], v[128:131]
    v_mfma_f32_16x16x32_bf16 v[136:139], v[144:147], v[148:151], v[136:139]
    v_mfma_f32_4x4x4_16b_bf16 v[132:135], v[150:151], v[150:151], v[132:135]
    v_mfma_f32_16x16x32_bf16 v[140:143], v[144:147], v[156:159], v[140:143]
    s_waitcnt lgkmcnt(6)
    v_mfma_f32_32x32x16_bf16 v[64:79], v[48:51], v[32:35], v[64:79]
    ds_read_b128 v[148:151], v14 offset:16384
    ds_read_b128 v[152:155], v18 offset:16384
    v_mfma_f32_32x32x16_bf16 v[80:95], v[48:51], v[36:39], v[80:95]
    ds_read_b64_tr_b16 v[156:157], v20 offset:24576
    ds_read_b64_tr_b16 v[158:159], v20 offset:25600
    v_mfma_f32_32x32x16_bf16 v[96:111], v[52:55], v[32:35], v[96:111]
    ds_read_b64_tr_b16 v[160:161], v21 offset:24576
    ds_read_b64_tr_b16 v[162:163], v21 offset:25600
    v_mfma_f32_32x32x16_bf16 v[112:127], v[52:55], v[36:39], v[112:127]
    v_mfma_f32_4x4x4_16b_bf16 v[128:131], v[32:33], v[32:33], v[128:131]
    v_mfma_f32_16x16x32_bf16 v[136:139], v[144:147], v[32:35], v[136:139]
    v_mfma_f32_4x4x4_16b_bf16 v[132:135], v[34:35], v[34:35], v[132:135]
    v_mfma_f32_16x16x32_bf16 v[140:143], v[144:147], v[48:51], v[140:143]
    s_waitcnt lgkmcnt(6)
    v_mfma_f32_32x32x16_bf16 v[64:79], v[56:59], v[40:43], v[64:79]
    ds_read_b128 v[32:35], v15 offset:16384
    ds_read_b128 v[36:39], v19 offset:16384
    v_mfma_f32_32x32x16_bf16 v[80:95], v[56:59], v[44:47], v[80:95]
    ds_read_b64_tr_b16 v[48:49], v20 offset:28672
    ds_read_b64_tr_b16 v[50:51], v20 offset:29696
    v_mfma_f32_32x32x16_bf16 v[96:111], v[60:63], v[40:43], v[96:111]
    ds_read_b64_tr_b16 v[52:53], v21 offset:28672
    ds_read_b64_tr_b16 v[54:55], v21 offset:29696
    v_mfma_f32_32x32x16_bf16 v[112:127], v[60:63], v[44:47], v[112:127]
    v_mfma_f32_4x4x4_16b_bf16 v[128:131], v[40:41], v[40:41], v[128:131]
    v_mfma_f32_16x16x32_bf16 v[136:139], v[144:147], v[40:43], v[136:139]
    v_mfma_f32_4x4x4_16b_bf16 v[132:135], v[42:43], v[42:43], v[132:135]
    v_mfma_f32_16x16x32_bf16 v[140:143], v[144:147], v[56:59], v[140:143]
    s_waitcnt lgkmcnt(6)
    v_mfma_f32_32x32x16_bf16 v[64:79], v[156:159], v[148:151], v[64:79]
    v_mfma_f32_32x32x16_bf16 v[80:95], v[156:159], v[152:155], v[80:95]
    v_mfma_f32_32x32x16_bf16 v[96:111], v[160:163], v[148:151], v[96:111]
    v_mfma_f32_32x32x16_bf16 v[112:127], v[160:163], v[152:155], v[112:127]
    v_mfma_f32_4x4x4_16b_bf16 v[128:131], v[148:149], v[148:149], v[128:131]
    v_mfma_f32_16x16x32_bf16 v[136:139], v[144:147], v[148:151], v[136:139]
    v_mfma_f32_4x4x4_16b_bf16 v[132:135], v[150:151], v[150:151], v[132:135]
    v_mfma_f32_16x16x32_bf16 v[140:143], v[144:147], v[156:159], v[140:143]
    s_waitcnt lgkmcnt(0)
    v_mfma_f32_4x4x4_16b_bf16 v[128:131], v[32:33], v[32:33], v[128:131]
    v_mfma_f32_16x16x32_bf16 v[136:139], v[144:147], v[32:35], v[136:139]
    v_mfma_f32_4x4x4_16b_bf16 v[132:135], v[34:35], v[34:35], v[132:135]
    v_mfma_f32_16x16x32_bf16 v[140:143], v[144:147], v[48:51], v[140:143]
    v_mfma_f32_32x32x16_bf16 v[64:79], v[48:51], v[32:35], v[64:79]
    v_mfma_f32_32x32x16_bf16 v[80:95], v[48:51], v[36:39], v[80:95]
    v_mfma_f32_32x32x16_bf16 v[96:111], v[52:55], v[32:35], v[96:111]
    v_mfma_f32_32x32x16_bf16 v[112:127], v[52:55], v[36:39], v[112:127]
    s_nop 1
    v_add_f32 v128, v128, v132
    v_add_f32 v129, v129, v133
    v_add_f32 v130, v130, v134
    v_add_f32 v131, v131, v135
    v_cndmask_b32 v128, v128, v129, s[28:29]
    v_cndmask_b32 v128, v128, v130, s[30:31]
    v_cndmask_b32 v128, v128, v131, s[44:45]
    v_mov_b32 v132, v128
    v_mul_f32 v2, 0x3acccccd, v136
    s_mov_b64 exec, 0xffffffff
    ds_write_b32 v241, v140
    s_mov_b64 exec, -1
    v_permlane32_swap_b32 v128, v132
    v_add_f32 v128, v128, v132
    v_mul_f32 v3, v2, v2
    v_fma_f32 v3, v128, s36, -v3
    v_max_f32 v3, 0, v3
    v_add_f32 v3, 0x3727c5ac, v3
    v_rsq_f32 v3, v3
    s_mov_b64 exec, 0xffffffff
    v_mul_f32 v3, s37, v3
    v_mul_f32 v2, -v2, v3
    ds_write_b32 v240, v3
    ds_write_b32 v240, v2 offset:512
    s_mov_b64 exec, -1
    s_waitcnt lgkmcnt(0)
    s_barrier
    ds_read_b32 v148, v242
    ds_read_b32 v150, v242 offset:512
    ds_read_b32 v149, v243
    ds_read_b32 v151, v243 offset:512
    ds_read_b128 v[152:155], v244 offset:0
    ds_read_b128 v[156:159], v244 offset:32
    ds_read_b128 v[160:163], v244 offset:64
    ds_read_b128 v[164:167], v244 offset:96
    ds_read_b128 v[168:171], v245 offset:0
    ds_read_b128 v[172:175], v245 offset:32
    ds_read_b128 v[176:179], v245 offset:64
    ds_read_b128 v[180:183], v245 offset:96
    s_cmp_eq_u32 s24, 0
    s_cbranch_scc1 L1_e2
    s_cmp_eq_u32 s23, 0
    s_cbranch_scc1 L1_e1
    s_waitcnt lgkmcnt(0)
    v_pk_mul_f32 v[188:189], v[152:153], v[150:151] op_sel:[0,0] op_sel_hi:[1,0]
    v_pk_mul_f32 v[190:191], v[154:155], v[150:151] op_sel:[0,0] op_sel_hi:[1,0]
    v_pk_mul_f32 v[192:193], v[156:157], v[150:151] op_sel:[0,0] op_sel_hi:[1,0]
    v_pk_mul_f32 v[194:195], v[158:159], v[150:151] op_sel:[0,0] op_sel_hi:[1,0]
    v_pk_fma_f32 v[188:189], v[64:65], v[148:149], v[188:189] op_sel:[0,0,0] op_sel_hi:[1,0,1]
    v_pk_fma_f32 v[190:191], v[66:67], v[148:149], v[190:191] op_sel:[0,0,0] op_sel_hi:[1,0,1]
    v_pk_fma_f32 v[192:193], v[68:69], v[148:149], v[192:193] op_sel:[0,0,0] op_sel_hi:[1,0,1]
    v_pk_fma_f32 v[194:195], v[70:71], v[148:149], v[194:195] op_sel:[0,0,0] op_sel_hi:[1,0,1]
    v_cvt_pk_bf16_f32 v196, v188, v189
    v_cvt_pk_bf16_f32 v197, v190, v191
    v_cvt_pk_bf16_f32 v198, v192, v193
    v_cvt_pk_bf16_f32 v199, v194, v195
    s_mov_b64 exec, s[50:51]
    buffer_store_dwordx2 v[196:197], v22, s[76:79], s38 offen sc1
    buffer_store_dwordx2 v[198:199], v23, s[76:79], s38 offen sc1
    s_not_b64 exec, exec
    s_cbranch_execz Lnochunk_11
    buffer_store_dwordx4 v[196:199], v22, s[76:79], s38 offen sc1
Lnochunk_11:
    s_mov_b64 exec, -1
    v_pk_mul_f32 v[200:201], v[160:161], v[150:151] op_sel:[0,0] op_sel_hi:[1,0]
    v_pk_mul_f32 v[202:203], v[162:163], v[150:151] op_sel:[0,0] op_sel_hi:[1,0]
    v_pk_mul_f32 v[204:205], v[164:165], v[150:151] op_sel:[0,0] op_sel_hi:[1,0]
    v_pk_mul_f32 v[206:207], v[166:167], v[150:151] op_sel:[0,0] op_sel_hi:[1,0]
    v_pk_fma_f32 v[200:201], v[72:73], v[148:149], v[200:201] op_sel:[0,0,0] op_sel_hi:[1,0,1]
    v_pk_fma_f32 v[202:203], v[74:75], v[148:149], v[202:203] op_sel:[0,0,0] op_sel_hi:[1,0,1]
    v_pk_fma_f32 v[204:205], v[76:77], v[148:149], v[204:205] op_sel:[0,0,0] op_sel_hi:[1,0,1]
    v_pk_fma_f32 v[206:207], v[78:79], v[148:149], v[206:207] op_sel:[0,0,0] op_sel_hi:[1,0,1]
    v_cvt_pk_bf16_f32 v208, v200, v201
    v_cvt_pk_bf16_f32 v209, v202, v203
    v_cvt_pk_bf16_f32 v210, v204, v205
    v_cvt_pk_bf16_f32 v211, v206, v207
    buffer_store_dwordx2 v[208:209], v24, s[76:79], s38 offen sc1
    buffer_store_dwordx2 v[210:211], v25, s[76:79], s38 offen sc1
    v_pk_mul_f32 v[188:189], v[152:153], v[150:151] op_sel:[0,1] op_sel_hi:[1,1]
    v_pk_mul_f32 v[190:191], v[154:155], v[150:151] op_sel:[0,1] op_sel_hi:[1,1]
    v_pk_mul_f32 v[192:193], v[156:157], v[150:151] op_sel:[0,1] op_sel_hi:[1,1]
    v_pk_mul_f32 v[194:195], v[158:159], v[150:151] op_sel:[0,1] op_sel_hi:[1,1]
    v_pk_fma_f32 v[188:189], v[80:81], v[148:149], v[188:189] op_sel:[0,1,0] op_sel_hi:[1,1,1]
    v_pk_fma_f32 v[190:191], v[82:83], v[148:149], v[190:191] op_sel:[0,1,0] op_sel_hi:[1,1,1]
    v_pk_fma_f32 v[192:193], v[84:85], v[148:149], v[192:193] op_sel:[0,1,0] op_sel_hi:[1,1,1]
    v_pk_fma_f32 v[194:195], v[86:87], v[148:149], v[194:195] op_sel:[0,1,0] op_sel_hi:[1,1,1]
    v_cvt_pk_bf16_f32 v196, v188, v189
    v_cvt_pk_bf16_f32 v197, v190, v191
    v_cvt_pk_bf16_f32 v198, v192, v193
    v_cvt_pk_bf16_f32 v199, v194, v195
    s_mov_b64 exec, s[50:51]
    buffer_store_dwordx2 v[196:197], v22, s[76:79], s39 offen sc1
    buffer_store_dwordx2 v[198:199], v23, s[76:79], s39 offen sc1
    s_not_b64 exec, exec
    s_cbranch_execz Lnochunk_12
    buffer_store_dwordx4 v[196:199], v22, s[76:79], s39 offen sc1
Lnochunk_12:
    s_mov_b64 exec, -1
    v_pk_mul_f32 v[200:201], v[160:161], v[150:151] op_sel:[0,1] op_sel_hi:[1,1]
    v_pk_mul_f32 v[202:203], v[162:163], v[150:151] op_sel:[0,1] op_sel_hi:[1,1]
    v_pk_mul_f32 v[204:205], v[164:165], v[150:151] op_sel:[0,1] op_sel_hi:[1,1]
    v_pk_mul_f32 v[206:207], v[166:167], v[150:151] op_sel:[0,1] op_sel_hi:[1,1]
    v_pk_fma_f32 v[200:201], v[88:89], v[148:149], v[200:201] op_sel:[0,1,0] op_sel_hi:[1,1,1]
    v_pk_fma_f32 v[202:203], v[90:91], v[148:149], v[202:203] op_sel:[0,1,0] op_sel_hi:[1,1,1]
    v_pk_fma_f32 v[204:205], v[92:93], v[148:149], v[204:205] op_sel:[0,1,0] op_sel_hi:[1,1,1]
    v_pk_fma_f32 v[206:207], v[94:95], v[148:149], v[206:207] op_sel:[0,1,0] op_sel_hi:[1,1,1]
    v_cvt_pk_bf16_f32 v208, v200, v201
    v_cvt_pk_bf16_f32 v209, v202, v203
    v_cvt_pk_bf16_f32 v210, v204, v205
    v_cvt_pk_bf16_f32 v211, v206, v207
    buffer_store_dwordx2 v[208:209], v24, s[76:79], s39 offen sc1
    buffer_store_dwordx2 v[210:211], v25, s[76:79], s39 offen sc1
    v_pk_mul_f32 v[188:189], v[168:169], v[150:151] op_sel:[0,0] op_sel_hi:[1,0]
    v_pk_mul_f32 v[190:191], v[170:171], v[150:151] op_sel:[0,0] op_sel_hi:[1,0]
    v_pk_mul_f32 v[192:193], v[172:173], v[150:151] op_sel:[0,0] op_sel_hi:[1,0]
    v_pk_mul_f32 v[194:195], v[174:175], v[150:151] op_sel:[0,0] op_sel_hi:[1,0]
    v_pk_fma_f32 v[188:189], v[96:97], v[148:149], v[188:189] op_sel:[0,0,0] op_sel_hi:[1,0,1]
    v_pk_fma_f32 v[190:191], v[98:99], v[148:149], v[190:191] op_sel:[0,0,0] op_sel_hi:[1,0,1]
    v_pk_fma_f32 v[192:193], v[100:101], v[148:149], v[192:193] op_sel:[0,0,0] op_sel_hi:[1,0,1]
    v_pk_fma_f32 v[194:195], v[102:103], v[148:149], v[194:195] op_sel:[0,0,0] op_sel_hi:[1,0,1]
    v_cvt_pk_bf16_f32 v196, v188, v189
    v_cvt_pk_bf16_f32 v197, v190, v191
    v_cvt_pk_bf16_f32 v198, v192, v193
    v_cvt_pk_bf16_f32 v199, v194, v195
    buffer_store_dwordx4 v[196:199], v26, s[76:79], s38 offen sc1
    v_pk_mul_f32 v[200:201], v[176:177], v[150:151] op_sel:[0,0] op_sel_hi:[1,0]
    v_pk_mul_f32 v[202:203], v[178:179], v[150:151] op_sel:[0,0] op_sel_hi:[1,0]
    v_pk_mul_f32 v[204:205], v[180:181], v[150:151] op_sel:[0,0] op_sel_hi:[1,0]
    v_pk_mul_f32 v[206:207], v[182:183], v[150:151] op_sel:[0,0] op_sel_hi:[1,0]
    v_pk_fma_f32 v[200:201], v[104:105], v[148:149], v[200:201] op_sel:[0,0,0] op_sel_hi:[1,0,1]
    v_pk_fma_f32 v[202:203], v[106:107], v[148:149], v[202:203] op_sel:[0,0,0] op_sel_hi:[1,0,1]
    v_pk_fma_f32 v[204:205], v[108:109], v[148:149], v[204:205] op_sel:[0,0,0] op_sel_hi:[1,0,1]
    v_pk_fma_f32 v[206:207], v[110:111], v[148:149], v[206:207] op_sel:[0,0,0] op_sel_hi:[1,0,1]
    v_cvt_pk_bf16_f32 v208, v200, v201
    v_cvt_pk_bf16_f32 v209, v202, v203
    v_cvt_pk_bf16_f32 v210, v204, v205
    v_cvt_pk_bf16_f32 v211, v206, v207
    buffer_store_dwordx4 v[208:211], v28, s[76:79], s38 offen sc1
    v_pk_mul_f32 v[188:189], v[168:169], v[150:151] op_sel:[0,1] op_sel_hi:[1,1]
    v_pk_mul_f32 v[190:191], v[170:171], v[150:151] op_sel:[0,1] op_sel_hi:[1,1]
    v_pk_mul_f32 v[192:193], v[172:173], v[150:151] op_sel:[0,1] op_sel_hi:[1,1]
    v_pk_mul_f32 v[194:195], v[174:175], v[150:151] op_sel:[0,1] op_sel_hi:[1,1]
    v_pk_fma_f32 v[188:189], v[112:113], v[148:149], v[188:189] op_sel:[0,1,0] op_sel_hi:[1,1,1]
    v_pk_fma_f32 v[190:191], v[114:115], v[148:149], v[190:191] op_sel:[0,1,0] op_sel_hi:[1,1,1]
    v_pk_fma_f32 v[192:193], v[116:117], v[148:149], v[192:193] op_sel:[0,1,0] op_sel_hi:[1,1,1]
    v_pk_fma_f32 v[194:195], v[118:119], v[148:149], v[194:195] op_sel:[0,1,0] op_sel_hi:[1,1,1]
    v_cvt_pk_bf16_f32 v196, v188, v189
    v_cvt_pk_bf16_f32 v197, v190, v191
    v_cvt_pk_bf16_f32 v198, v192, v193
    v_cvt_pk_bf16_f32 v199, v194, v195
    buffer_store_dwordx4 v[196:199], v26, s[76:79], s39 offen sc1
    v_pk_mul_f32 v[200:201], v[176:177], v[150:151] op_sel:[0,1] op_sel_hi:[1,1]
    v_pk_mul_f32 v[202:203], v[178:179], v[150:151] op_sel:[0,1] op_sel_hi:[1,1]
    v_pk_mul_f32 v[204:205], v[180:181], v[150:151] op_sel:[0,1] op_sel_hi:[1,1]
    v_pk_mul_f32 v[206:207], v[182:183], v[150:151] op_sel:[0,1] op_sel_hi:[1,1]
    v_pk_fma_f32 v[200:201], v[120:121], v[148:149], v[200:201] op_sel:[0,1,0] op_sel_hi:[1,1,1]
    v_pk_fma_f32 v[202:203], v[122:123], v[148:149], v[202:203] op_sel:[0,1,0] op_sel_hi:[1,1,1]
    v_pk_fma_f32 v[204:205], v[124:125], v[148:149], v[204:205] op_sel:[0,1,0] op_sel_hi:[1,1,1]
    v_pk_fma_f32 v[206:207], v[126:127], v[148:149], v[206:207] op_sel:[0,1,0] op_sel_hi:[1,1,1]
    v_cvt_pk_bf16_f32 v208, v200, v201
    v_cvt_pk_bf16_f32 v209, v202, v203
    v_cvt_pk_bf16_f32 v210, v204, v205
    v_cvt_pk_bf16_f32 v211, v206, v207
    buffer_store_dwordx4 v[208:211], v28, s[76:79], s39 offen sc1
    s_branch L1_join
L1_e1:
    s_waitcnt lgkmcnt(0)
    v_pk_mul_f32 v[188:189], v[152:153], v[150:151] op_sel:[0,0] op_sel_hi:[1,0]
    v_pk_mul_f32 v[190:191], v[154:155], v[150:151] op_sel:[0,0] op_sel_hi:[1,0]
    v_pk_mul_f32 v[192:193], v[156:157], v[150:151] op_sel:[0,0] op_sel_hi:[1,0]
    v_pk_mul_f32 v[194:195], v[158:159], v[150:151] op_sel:[0,0] op_sel_hi:[1,0]
    v_pk_fma_f32 v[188:189], v[64:65], v[148:149], v[188:189] op_sel:[0,0,0] op_sel_hi:[1,0,1]
    v_pk_fma_f32 v[190:191], v[66:67], v[148:149], v[190:191] op_sel:[0,0,0] op_sel_hi:[1,0,1]
    v_pk_fma_f32 v[192:193], v[68:69], v[148:149], v[192:193] op_sel:[0,0,0] op_sel_hi:[1,0,1]
    v_pk_fma_f32 v[194:195], v[70:71], v[148:149], v[194:195] op_sel:[0,0,0] op_sel_hi:[1,0,1]
    v_cvt_pk_bf16_f32 v196, v188, v189
    v_cvt_pk_bf16_f32 v197, v190, v191
    v_cvt_pk_bf16_f32 v198, v192, v193
    v_cvt_pk_bf16_f32 v199, v194, v195
    buffer_store_dwordx4 v[196:199], v22, s[76:79], s38 offen sc1
    v_pk_mul_f32 v[200:201], v[160:161], v[150:151] op_sel:[0,0] op_sel_hi:[1,0]
    v_pk_mul_f32 v[202:203], v[162:163], v[150:151] op_sel:[0,0] op_sel_hi:[1,0]
    v_pk_mul_f32 v[204:205], v[164:165], v[150:151] op_sel:[0,0] op_sel_hi:[1,0]
    v_pk_mul_f32 v[206:207], v[166:167], v[150:151] op_sel:[0,0] op_sel_hi:[1,0]
    v_pk_fma_f32 v[200:201], v[72:73], v[148:149], v[200:201] op_sel:[0,0,0] op_sel_hi:[1,0,1]
    v_pk_fma_f32 v[202:203], v[74:75], v[148:149], v[202:203] op_sel:[0,0,0] op_sel_hi:[1,0,1]
    v_pk_fma_f32 v[204:205], v[76:77], v[148:149], v[204:205] op_sel:[0,0,0] op_sel_hi:[1,0,1]
    v_pk_fma_f32 v[206:207], v[78:79], v[148:149], v[206:207] op_sel:[0,0,0] op_sel_hi:[1,0,1]
    v_cvt_pk_bf16_f32 v208, v200, v201
    v_cvt_pk_bf16_f32 v209, v202, v203
    v_cvt_pk_bf16_f32 v210, v204, v205
    v_cvt_pk_bf16_f32 v211, v206, v207
    buffer_store_dwordx4 v[208:211], v24, s[76:79], s38 offen sc1
    v_pk_mul_f32 v[188:189], v[152:153], v[150:151] op_sel:[0,1] op_sel_hi:[1,1]
    v_pk_mul_f32 v[190:191], v[154:155], v[150:151] op_sel:[0,1] op_sel_hi:[1,1]
    v_pk_mul_f32 v[192:193], v[156:157], v[150:151] op_sel:[0,1] op_sel_hi:[1,1]
    v_pk_mul_f32 v[194:195], v[158:159], v[150:151] op_sel:[0,1] op_sel_hi:[1,1]
    v_pk_fma_f32 v[188:189], v[80:81], v[148:149], v[188:189] op_sel:[0,1,0] op_sel_hi:[1,1,1]
    v_pk_fma_f32 v[190:191], v[82:83], v[148:149], v[190:191] op_sel:[0,1,0] op_sel_hi:[1,1,1]
    v_pk_fma_f32 v[192:193], v[84:85], v[148:149], v[192:193] op_sel:[0,1,0] op_sel_hi:[1,1,1]
    v_pk_fma_f32 v[194:195], v[86:87], v[148:149], v[194:195] op_sel:[0,1,0] op_sel_hi:[1,1,1]
    v_cvt_pk_bf16_f32 v196, v188, v189
    v_cvt_pk_bf16_f32 v197, v190, v191
    v_cvt_pk_bf16_f32 v198, v192, v193
    v_cvt_pk_bf16_f32 v199, v194, v195
    buffer_store_dwordx4 v[196:199], v22, s[76:79], s39 offen sc1
    v_pk_mul_f32 v[200:201], v[160:161], v[150:151] op_sel:[0,1] op_sel_hi:[1,1]
    v_pk_mul_f32 v[202:203], v[162:163], v[150:151] op_sel:[0,1] op_sel_hi:[1,1]
    v_pk_mul_f32 v[204:205], v[164:165], v[150:151] op_sel:[0,1] op_sel_hi:[1,1]
    v_pk_mul_f32 v[206:207], v[166:167], v[150:151] op_sel:[0,1] op_sel_hi:[1,1]
    v_pk_fma_f32 v[200:201], v[88:89], v[148:149], v[200:201] op_sel:[0,1,0] op_sel_hi:[1,1,1]
    v_pk_fma_f32 v[202:203], v[90:91], v[148:149], v[202:203] op_sel:[0,1,0] op_sel_hi:[1,1,1]
    v_pk_fma_f32 v[204:205], v[92:93], v[148:149], v[204:205] op_sel:[0,1,0] op_sel_hi:[1,1,1]
    v_pk_fma_f32 v[206:207], v[94:95], v[148:149], v[206:207] op_sel:[0,1,0] op_sel_hi:[1,1,1]
    v_cvt_pk_bf16_f32 v208, v200, v201
    v_cvt_pk_bf16_f32 v209, v202, v203
    v_cvt_pk_bf16_f32 v210, v204, v205
    v_cvt_pk_bf16_f32 v211, v206, v207
    buffer_store_dwordx4 v[208:211], v24, s[76:79], s39 offen sc1
    v_pk_mul_f32 v[188:189], v[168:169], v[150:151] op_sel:[0,0] op_sel_hi:[1,0]
    v_pk_mul_f32 v[190:191], v[170:171], v[150:151] op_sel:[0,0] op_sel_hi:[1,0]
    v_pk_mul_f32 v[192:193], v[172:173], v[150:151] op_sel:[0,0] op_sel_hi:[1,0]
    v_pk_mul_f32 v[194:195], v[174:175], v[150:151] op_sel:[0,0] op_sel_hi:[1,0]
    v_pk_fma_f32 v[188:189], v[96:97], v[148:149], v[188:189] op_sel:[0,0,0] op_sel_hi:[1,0,1]
    v_pk_fma_f32 v[190:191], v[98:99], v[148:149], v[190:191] op_sel:[0,0,0] op_sel_hi:[1,0,1]
    v_pk_fma_f32 v[192:193], v[100:101], v[148:149], v[192:193] op_sel:[0,0,0] op_sel_hi:[1,0,1]
    v_pk_fma_f32 v[194:195], v[102:103], v[148:149], v[194:195] op_sel:[0,0,0] op_sel_hi:[1,0,1]
    v_cvt_pk_bf16_f32 v196, v188, v189
    v_cvt_pk_bf16_f32 v197, v190, v191
    v_cvt_pk_bf16_f32 v198, v192, v193
    v_cvt_pk_bf16_f32 v199, v194, v195
    s_mov_b64 exec, s[52:53]
    buffer_store_dwordx2 v[196:197], v26, s[76:79], s38 offen sc1
    buffer_store_dwordx2 v[198:199], v27, s[76:79], s38 offen sc1
    s_not_b64 exec, exec
    s_cbranch_execz Lnochunk_13
    buffer_store_dwordx4 v[196:199], v26, s[76:79], s38 offen sc1
Lnochunk_13:
    s_mov_b64 exec, -1
    v_pk_mul_f32 v[200:201], v[176:177], v[150:151] op_sel:[0,0] op_sel_hi:[1,0]
    v_pk_mul_f32 v[202:203], v[178:179], v[150:151] op_sel:[0,0] op_sel_hi:[1,0]
    v_pk_mul_f32 v[204:205], v[180:181], v[150:151] op_sel:[0,0] op_sel_hi:[1,0]
    v_pk_mul_f32 v[206:207], v[182:183], v[150:151] op_sel:[0,0] op_sel_hi:[1,0]
    v_pk_fma_f32 v[200:201], v[104:105], v[148:149], v[200:201] op_sel:[0,0,0] op_sel_hi:[1,0,1]
    v_pk_fma_f32 v[202:203], v[106:107], v[148:149], v[202:203] op_sel:[0,0,0] op_sel_hi:[1,0,1]
    v_pk_fma_f32 v[204:205], v[108:109], v[148:149], v[204:205] op_sel:[0,0,0] op_sel_hi:[1,0,1]
    v_pk_fma_f32 v[206:207], v[110:111], v[148:149], v[206:207] op_sel:[0,0,0] op_sel_hi:[1,0,1]
    v_cvt_pk_bf16_f32 v208, v200, v201
    v_cvt_pk_bf16_f32 v209, v202, v203
    v_cvt_pk_bf16_f32 v210, v204, v205
    v_cvt_pk_bf16_f32 v211, v206, v207
    buffer_store_dwordx2 v[208:209], v28, s[76:79], s38 offen sc1
    buffer_store_dwordx2 v[210:211], v29, s[76:79], s38 offen sc1
    v_pk_mul_f32 v[188:189], v[168:169], v[150:151] op_sel:[0,1] op_sel_hi:[1,1]
    v_pk_mul_f32 v[190:191], v[170:171], v[150:151] op_sel:[0,1] op_sel_hi:[1,1]
    v_pk_mul_f32 v[192:193], v[172:173], v[150:151] op_sel:[0,1] op_sel_hi:[1,1]
    v_pk_mul_f32 v[194:195], v[174:175], v[150:151] op_sel:[0,1] op_sel_hi:[1,1]
    v_pk_fma_f32 v[188:189], v[112:113], v[148:149], v[188:189] op_sel:[0,1,0] op_sel_hi:[1,1,1]
    v_pk_fma_f32 v[190:191], v[114:115], v[148:149], v[190:191] op_sel:[0,1,0] op_sel_hi:[1,1,1]
    v_pk_fma_f32 v[192:193], v[116:117], v[148:149], v[192:193] op_sel:[0,1,0] op_sel_hi:[1,1,1]
    v_pk_fma_f32 v[194:195], v[118:119], v[148:149], v[194:195] op_sel:[0,1,0] op_sel_hi:[1,1,1]
    v_cvt_pk_bf16_f32 v196, v188, v189
    v_cvt_pk_bf16_f32 v197, v190, v191
    v_cvt_pk_bf16_f32 v198, v192, v193
    v_cvt_pk_bf16_f32 v199, v194, v195
    s_mov_b64 exec, s[52:53]
    buffer_store_dwordx2 v[196:197], v26, s[76:79], s39 offen sc1
    buffer_store_dwordx2 v[198:199], v27, s[76:79], s39 offen sc1
    s_not_b64 exec, exec
    s_cbranch_execz Lnochunk_14
    buffer_store_dwordx4 v[196:199], v26, s[76:79], s39 offen sc1
Lnochunk_14:
    s_mov_b64 exec, -1
    v_pk_mul_f32 v[200:201], v[176:177], v[150:151] op_sel:[0,1] op_sel_hi:[1,1]
    v_pk_mul_f32 v[202:203], v[178:179], v[150:151] op_sel:[0,1] op_sel_hi:[1,1]
    v_pk_mul_f32 v[204:205], v[180:181], v[150:151] op_sel:[0,1] op_sel_hi:[1,1]
    v_pk_mul_f32 v[206:207], v[182:183], v[150:151] op_sel:[0,1] op_sel_hi:[1,1]
    v_pk_fma_f32 v[200:201], v[120:121], v[148:149], v[200:201] op_sel:[0,1,0] op_sel_hi:[1,1,1]
    v_pk_fma_f32 v[202:203], v[122:123], v[148:149], v[202:203] op_sel:[0,1,0] op_sel_hi:[1,1,1]
    v_pk_fma_f32 v[204:205], v[124:125], v[148:149], v[204:205] op_sel:[0,1,0] op_sel_hi:[1,1,1]
    v_pk_fma_f32 v[206:207], v[126:127], v[148:149], v[206:207] op_sel:[0,1,0] op_sel_hi:[1,1,1]
    v_cvt_pk_bf16_f32 v208, v200, v201
    v_cvt_pk_bf16_f32 v209, v202, v203
    v_cvt_pk_bf16_f32 v210, v204, v205
    v_cvt_pk_bf16_f32 v211, v206, v207
    buffer_store_dwordx2 v[208:209], v28, s[76:79], s39 offen sc1
    buffer_store_dwordx2 v[210:211], v29, s[76:79], s39 offen sc1
    s_branch L1_join
L1_e2:
    s_waitcnt lgkmcnt(0)
    v_pk_mul_f32 v[188:189], v[152:153], v[150:151] op_sel:[0,0] op_sel_hi:[1,0]
    v_pk_mul_f32 v[190:191], v[154:155], v[150:151] op_sel:[0,0] op_sel_hi:[1,0]
    v_pk_mul_f32 v[192:193], v[156:157], v[150:151] op_sel:[0,0] op_sel_hi:[1,0]
    v_pk_mul_f32 v[194:195], v[158:159], v[150:151] op_sel:[0,0] op_sel_hi:[1,0]
    v_pk_fma_f32 v[188:189], v[64:65], v[148:149], v[188:189] op_sel:[0,0,0] op_sel_hi:[1,0,1]
    v_pk_fma_f32 v[190:191], v[66:67], v[148:149], v[190:191] op_sel:[0,0,0] op_sel_hi:[1,0,1]
    v_pk_fma_f32 v[192:193], v[68:69], v[148:149], v[192:193] op_sel:[0,0,0] op_sel_hi:[1,0,1]
    v_pk_fma_f32 v[194:195], v[70:71], v[148:149], v[194:195] op_sel:[0,0,0] op_sel_hi:[1,0,1]
    v_cvt_pk_bf16_f32 v196, v188, v189
    v_cvt_pk_bf16_f32 v197, v190, v191
    v_cvt_pk_bf16_f32 v198, v192, v193
    v_cvt_pk_bf16_f32 v199, v194, v195
    buffer_store_dwordx4 v[196:199], v22, s[76:79], s38 offen sc1
    v_pk_mul_f32 v[200:201], v[160:161], v[150:151] op_sel:[0,0] op_sel_hi:[1,0]
    v_pk_mul_f32 v[202:203], v[162:163], v[150:151] op_sel:[0,0] op_sel_hi:[1,0]
    v_pk_mul_f32 v[204:205], v[164:165], v[150:151] op_sel:[0,0] op_sel_hi:[1,0]
    v_pk_mul_f32 v[206:207], v[166:167], v[150:151] op_sel:[0,0] op_sel_hi:[1,0]
    v_pk_fma_f32 v[200:201], v[72:73], v[148:149], v[200:201] op_sel:[0,0,0] op_sel_hi:[1,0,1]
    v_pk_fma_f32 v[202:203], v[74:75], v[148:149], v[202:203] op_sel:[0,0,0] op_sel_hi:[1,0,1]
    v_pk_fma_f32 v[204:205], v[76:77], v[148:149], v[204:205] op_sel:[0,0,0] op_sel_hi:[1,0,1]
    v_pk_fma_f32 v[206:207], v[78:79], v[148:149], v[206:207] op_sel:[0,0,0] op_sel_hi:[1,0,1]
    v_cvt_pk_bf16_f32 v208, v200, v201
    v_cvt_pk_bf16_f32 v209, v202, v203
    v_cvt_pk_bf16_f32 v210, v204, v205
    v_cvt_pk_bf16_f32 v211, v206, v207
    buffer_store_dwordx4 v[208:211], v24, s[76:79], s38 offen sc1
    v_pk_mul_f32 v[188:189], v[152:153], v[150:151] op_sel:[0,1] op_sel_hi:[1,1]
    v_pk_mul_f32 v[190:191], v[154:155], v[150:151] op_sel:[0,1] op_sel_hi:[1,1]
    v_pk_mul_f32 v[192:193], v[156:157], v[150:151] op_sel:[0,1] op_sel_hi:[1,1]
    v_pk_mul_f32 v[194:195], v[158:159], v[150:151] op_sel:[0,1] op_sel_hi:[1,1]
    v_pk_fma_f32 v[188:189], v[80:81], v[148:149], v[188:189] op_sel:[0,1,0] op_sel_hi:[1,1,1]
    v_pk_fma_f32 v[190:191], v[82:83], v[148:149], v[190:191] op_sel:[0,1,0] op_sel_hi:[1,1,1]
    v_pk_fma_f32 v[192:193], v[84:85], v[148:149], v[192:193] op_sel:[0,1,0] op_sel_hi:[1,1,1]
    v_pk_fma_f32 v[194:195], v[86:87], v[148:149], v[194:195] op_sel:[0,1,0] op_sel_hi:[1,1,1]
    v_cvt_pk_bf16_f32 v196, v188, v189
    v_cvt_pk_bf16_f32 v197, v190, v191
    v_cvt_pk_bf16_f32 v198, v192, v193
    v_cvt_pk_bf16_f32 v199, v194, v195
    buffer_store_dwordx4 v[196:199], v22, s[76:79], s39 offen sc1
    v_pk_mul_f32 v[200:201], v[160:161], v[150:151] op_sel:[0,1] op_sel_hi:[1,1]
    v_pk_mul_f32 v[202:203], v[162:163], v[150:151] op_sel:[0,1] op_sel_hi:[1,1]
    v_pk_mul_f32 v[204:205], v[164:165], v[150:151] op_sel:[0,1] op_sel_hi:[1,1]
    v_pk_mul_f32 v[206:207], v[166:167], v[150:151] op_sel:[0,1] op_sel_hi:[1,1]
    v_pk_fma_f32 v[200:201], v[88:89], v[148:149], v[200:201] op_sel:[0,1,0] op_sel_hi:[1,1,1]
    v_pk_fma_f32 v[202:203], v[90:91], v[148:149], v[202:203] op_sel:[0,1,0] op_sel_hi:[1,1,1]
    v_pk_fma_f32 v[204:205], v[92:93], v[148:149], v[204:205] op_sel:[0,1,0] op_sel_hi:[1,1,1]
    v_pk_fma_f32 v[206:207], v[94:95], v[148:149], v[206:207] op_sel:[0,1,0] op_sel_hi:[1,1,1]
    v_cvt_pk_bf16_f32 v208, v200, v201
    v_cvt_pk_bf16_f32 v209, v202, v203
    v_cvt_pk_bf16_f32 v210, v204, v205
    v_cvt_pk_bf16_f32 v211, v206, v207
    buffer_store_dwordx4 v[208:211], v24, s[76:79], s39 offen sc1
    v_pk_mul_f32 v[188:189], v[168:169], v[150:151] op_sel:[0,0] op_sel_hi:[1,0]
    v_pk_mul_f32 v[190:191], v[170:171], v[150:151] op_sel:[0,0] op_sel_hi:[1,0]
    v_pk_mul_f32 v[192:193], v[172:173], v[150:151] op_sel:[0,0] op_sel_hi:[1,0]
    v_pk_mul_f32 v[194:195], v[174:175], v[150:151] op_sel:[0,0] op_sel_hi:[1,0]
    v_pk_fma_f32 v[188:189], v[96:97], v[148:149], v[188:189] op_sel:[0,0,0] op_sel_hi:[1,0,1]
    v_pk_fma_f32 v[190:191], v[98:99], v[148:149], v[190:191] op_sel:[0,0,0] op_sel_hi:[1,0,1]
    v_pk_fma_f32 v[192:193], v[100:101], v[148:149], v[192:193] op_sel:[0,0,0] op_sel_hi:[1,0,1]
    v_pk_fma_f32 v[194:195], v[102:103], v[148:149], v[194:195] op_sel:[0,0,0] op_sel_hi:[1,0,1]
    v_cvt_pk_bf16_f32 v196, v188, v189
    v_cvt_pk_bf16_f32 v197, v190, v191
    v_cvt_pk_bf16_f32 v198, v192, v193
    v_cvt_pk_bf16_f32 v199, v194, v195
    buffer_store_dwordx4 v[196:199], v26, s[76:79], s38 offen sc1
    v_pk_mul_f32 v[200:201], v[176:177], v[150:151] op_sel:[0,0] op_sel_hi:[1,0]
    v_pk_mul_f32 v[202:203], v[178:179], v[150:151] op_sel:[0,0] op_sel_hi:[1,0]
    v_pk_mul_f32 v[204:205], v[180:181], v[150:151] op_sel:[0,0] op_sel_hi:[1,0]
    v_pk_mul_f32 v[206:207], v[182:183], v[150:151] op_sel:[0,0] op_sel_hi:[1,0]
    v_pk_fma_f32 v[200:201], v[104:105], v[148:149], v[200:201] op_sel:[0,0,0] op_sel_hi:[1,0,1]
    v_pk_fma_f32 v[202:203], v[106:107], v[148:149], v[202:203] op_sel:[0,0,0] op_sel_hi:[1,0,1]
    v_pk_fma_f32 v[204:205], v[108:109], v[148:149], v[204:205] op_sel:[0,0,0] op_sel_hi:[1,0,1]
    v_pk_fma_f32 v[206:207], v[110:111], v[148:149], v[206:207] op_sel:[0,0,0] op_sel_hi:[1,0,1]
    v_cvt_pk_bf16_f32 v208, v200, v201
    v_cvt_pk_bf16_f32 v209, v202, v203
    v_cvt_pk_bf16_f32 v210, v204, v205
    v_cvt_pk_bf16_f32 v211, v206, v207
    buffer_store_dwordx4 v[208:211], v28, s[76:79], s38 offen sc1
    v_pk_mul_f32 v[188:189], v[168:169], v[150:151] op_sel:[0,1] op_sel_hi:[1,1]
    v_pk_mul_f32 v[190:191], v[170:171], v[150:151] op_sel:[0,1] op_sel_hi:[1,1]
    v_pk_mul_f32 v[192:193], v[172:173], v[150:151] op_sel:[0,1] op_sel_hi:[1,1]
    v_pk_mul_f32 v[194:195], v[174:175], v[150:151] op_sel:[0,1] op_sel_hi:[1,1]
    v_pk_fma_f32 v[188:189], v[112:113], v[148:149], v[188:189] op_sel:[0,1,0] op_sel_hi:[1,1,1]
    v_pk_fma_f32 v[190:191], v[114:115], v[148:149], v[190:191] op_sel:[0,1,0] op_sel_hi:[1,1,1]
    v_pk_fma_f32 v[192:193], v[116:117], v[148:149], v[192:193] op_sel:[0,1,0] op_sel_hi:[1,1,1]
    v_pk_fma_f32 v[194:195], v[118:119], v[148:149], v[194:195] op_sel:[0,1,0] op_sel_hi:[1,1,1]
    v_cvt_pk_bf16_f32 v196, v188, v189
    v_cvt_pk_bf16_f32 v197, v190, v191
    v_cvt_pk_bf16_f32 v198, v192, v193
    v_cvt_pk_bf16_f32 v199, v194, v195
    buffer_store_dwordx4 v[196:199], v26, s[76:79], s39 offen sc1
    v_pk_mul_f32 v[200:201], v[176:177], v[150:151] op_sel:[0,1] op_sel_hi:[1,1]
    v_pk_mul_f32 v[202:203], v[178:179], v[150:151] op_sel:[0,1] op_sel_hi:[1,1]
    v_pk_mul_f32 v[204:205], v[180:181], v[150:151] op_sel:[0,1] op_sel_hi:[1,1]
    v_pk_mul_f32 v[206:207], v[182:183], v[150:151] op_sel:[0,1] op_sel_hi:[1,1]
    v_pk_fma_f32 v[200:201], v[120:121], v[148:149], v[200:201] op_sel:[0,1,0] op_sel_hi:[1,1,1]
    v_pk_fma_f32 v[202:203], v[122:123], v[148:149], v[202:203] op_sel:[0,1,0] op_sel_hi:[1,1,1]
    v_pk_fma_f32 v[204:205], v[124:125], v[148:149], v[204:205] op_sel:[0,1,0] op_sel_hi:[1,1,1]
    v_pk_fma_f32 v[206:207], v[126:127], v[148:149], v[206:207] op_sel:[0,1,0] op_sel_hi:[1,1,1]
    v_cvt_pk_bf16_f32 v208, v200, v201
    v_cvt_pk_bf16_f32 v209, v202, v203
    v_cvt_pk_bf16_f32 v210, v204, v205
    v_cvt_pk_bf16_f32 v211, v206, v207
    buffer_store_dwordx4 v[208:211], v28, s[76:79], s39 offen sc1
    s_branch L1_join
L1_v:
    s_lshl_b32 s33, s24, 1
    s_add_u32 s33, s33, s23
    v_xor_b32 v4, s33, v30
    v_lshl_add_u32 v4, v4, 6, v31
    v_bfe_u32 v5, v0, 4, 1
    v_lshl_add_u32 v4, v5, 5, v4
    v_and_b32 v5, 3, v0
    v_lshl_add_u32 v20, v5, 3, v4
    v_xor_b32 v21, 64, v20
    s_waitcnt lgkmcnt(0)
    s_barrier
    ds_read_b128 v[32:35], v12 offset:0
    ds_read_b128 v[36:39], v16 offset:0
    ds_read_b64_tr_b16 v[48:49], v20 offset:0
    ds_read_b64_tr_b16 v[50:51], v20 offset:1024
    ds_read_b64_tr_b16 v[52:53], v21 offset:0
    ds_read_b64_tr_b16 v[54:55], v21 offset:1024
    ds_read_b128 v[40:43], v13 offset:0
    ds_read_b128 v[44:47], v17 offset:0
    ds_read_b64_tr_b16 v[56:57], v20 offset:4096
    ds_read_b64_tr_b16 v[58:59], v20 offset:5120
    ds_read_b64_tr_b16 v[60:61], v21 offset:4096
    ds_read_b64_tr_b16 v[62:63], v21 offset:5120
    s_waitcnt lgkmcnt(6)
    v_mfma_f32_32x32x16_bf16 v[64:79], v[32:35], v[48:51], 0
    ds_read_b128 v[148:151], v14 offset:0
    ds_read_b128 v[152:155], v18 offset:0
    s_mov_b32 s76, s74
    s_mov_b32 s77, s75
    s_mov_b32 s78, 26411008
    s_mov_b32 s79, 0x20000
    v_mfma_f32_32x32x16_bf16 v[80:95], v[36:39], v[48:51], 0
    ds_read_b64_tr_b16 v[156:157], v20 offset:8192
    ds_read_b64_tr_b16 v[158:159], v20 offset:9216
    s_mov_b32 s37, 1.0
    s_mul_i32 s38, s24, 2560
    s_sub_u32 s39, 2560, s38
    s_lshl_b32 s32, s20, 2
    v_mfma_f32_32x32x16_bf16 v[96:111], v[32:35], v[52:55], 0
    ds_read_b64_tr_b16 v[160:161], v21 offset:8192
    ds_read_b64_tr_b16 v[162:163], v21 offset:9216
    s_lshl_b32 s33, s23, 1
    s_add_u32 s32, s32, s33
    s_mul_i32 s32, s32, 2560
    s_add_u32 s42, s32, 2622720
    v_mfma_f32_32x32x16_bf16 v[112:127], v[36:39], v[52:55], 0
    s_sub_u32 s32, s21, 10
    s_lshl_b32 s32, s32, 7
    s_lshl_b32 s33, s24, 6
    s_add_u32 s32, s32, s33
    v_mfma_f32_4x4x4_16b_bf16 v[128:131], v[32:33], v[32:33], 0
    v_mfma_f32_16x16x32_bf16 v[136:139], v[144:147], v[32:35], 0
    v_mfma_f32_4x4x4_16b_bf16 v[132:135], v[34:35], v[34:35], 0
    v_mfma_f32_16x16x32_bf16 v[140:143], v[144:147], v[48:51], 0
    s_waitcnt lgkmcnt(6)
    v_mfma_f32_32x32x16_bf16 v[64:79], v[40:43], v[56:59], v[64:79]
    ds_read_b128 v[32:35], v15 offset:0
    ds_read_b128 v[36:39], v19 offset:0
    s_mov_b32 s41, 163840
    s_xor_b32 s33, s23, 0
    s_lshl_b32 s33, s33, 5
    s_add_u32 s33, s33, s32
    v_mfma_f32_32x32x16_bf16 v[80:95], v[44:47], v[56:59], v[80:95]
    ds_read_b64_tr_b16 v[48:49], v20 offset:12288
    ds_read_b64_tr_b16 v[50:51], v20 offset:13312
    v_add_u32 v4, s33, v1
    v_mul_u32_u24 v5, 3277, v4
    v_lshrrev_b32 v5, 16, v5
    v_mul_u32_u24 v6, 20, v5
    v_mfma_f32_32x32x16_bf16 v[96:111], v[40:43], v[60:63], v[96:111]
    ds_read_b64_tr_b16 v[52:53], v21 offset:12288
    ds_read_b64_tr_b16 v[54:55], v21 offset:13312
    v_sub_u32 v6, v4, v6
    v_lshrrev_b32 v7, 4, v6
    v_xor_b32 v7, v7, v2
    v_lshl_add_u32 v6, v6, 1, v7
    v_mfma_f32_32x32x16_bf16 v[112:127], v[44:47], v[60:63], v[112:127]
    v_lshlrev_b32 v6, 4, v6
    v_mul_lo_u32 v5, v5, s41
    v_add3_u32 v22, v5, v6, s42
    s_xor_b32 s33, s23, 1
    v_mfma_f32_4x4x4_16b_bf16 v[128:131], v[40:41], v[40:41], v[128:131]
    v_mfma_f32_16x16x32_bf16 v[136:139], v[144:147], v[40:43], v[136:139]
    v_mfma_f32_4x4x4_16b_bf16 v[132:135], v[42:43], v[42:43], v[132:135]
    v_mfma_f32_16x16x32_bf16 v[140:143], v[144:147], v[56:59], v[140:143]
    s_waitcnt lgkmcnt(0)
    s_barrier
    v_mfma_f32_32x32x16_bf16 v[64:79], v[148:151], v[156:159], v[64:79]
    ds_read_b128 v[40:43], v12 offset:16384
    ds_read_b128 v[44:47], v16 offset:16384
    s_lshl_b32 s33, s33, 5
    s_add_u32 s33, s33, s32
    v_add_u32 v4, s33, v1
    v_mul_u32_u24 v5, 3277, v4
    v_mfma_f32_32x32x16_bf16 v[80:95], v[152:155], v[156:159], v[80:95]
    ds_read_b64_tr_b16 v[56:57], v20 offset:16384
    ds_read_b64_tr_b16 v[58:59], v20 offset:17408
    v_lshrrev_b32 v5, 16, v5
    v_mul_u32_u24 v6, 20, v5
    v_sub_u32 v6, v4, v6
    v_lshrrev_b32 v7, 4, v6
    v_mfma_f32_32x32x16_bf16 v[96:111], v[148:151], v[160:163], v[96:111]
    ds_read_b64_tr_b16 v[60:61], v21 offset:16384
    ds_read_b64_tr_b16 v[62:63], v21 offset:17408
    v_xor_b32 v7, v7, v2
    v_lshl_add_u32 v6, v6, 1, v7
    v_lshlrev_b32 v6, 4, v6
    v_mul_lo_u32 v5, v5, s41
    v_mfma_f32_32x32x16_bf16 v[112:127], v[152:155], v[160:163], v[112:127]
    v_add3_u32 v23, v5, v6, s42
    s_lshl_b32 s32, s23, 6
    s_lshl_b32 s33, s24, 5
    s_add_u32 s32, s32, s33
    v_mfma_f32_4x4x4_16b_bf16 v[128:131], v[148:149], v[148:149], v[128:131]
    v_mfma_f32_16x16x32_bf16 v[136:139], v[144:147], v[148:151], v[136:139]
    v_mfma_f32_4x4x4_16b_bf16 v[132:135], v[150:151], v[150:151], v[132:135]
    v_mfma_f32_16x16x32_bf16 v[140:143], v[144:147], v[156:159], v[140:143]
    v_mfma_f32_32x32x16_bf16 v[64:79], v[32:35], v[48:51], v[64:79]
    ds_read_b128 v[148:151], v13 offset:16384
    ds_read_b128 v[152:155], v17 offset:16384
    s_lshl_b32 s33, s24, 6
    s_lshl_b32 s34, s23, 5
    s_add_u32 s33, s33, s34
    v_add_lshl_u32 v240, v1, s32, 2
    v_mfma_f32_32x32x16_bf16 v[80:95], v[36:39], v[48:51], v[80:95]
    ds_read_b64_tr_b16 v[156:157], v20 offset:20480
    ds_read_b64_tr_b16 v[158:159], v20 offset:21504
    v_add_lshl_u32 v241, v1, s33, 2
    v_add_u32 v240, 131072, v240
    v_add_u32 v241, 132096, v241
    v_mov_b32 v242, v241
    v_mfma_f32_32x32x16_bf16 v[96:111], v[32:35], v[52:55], v[96:111]
    ds_read_b64_tr_b16 v[160:161], v21 offset:20480
    ds_read_b64_tr_b16 v[162:163], v21 offset:21504
    v_xor_b32 v243, 128, v242
    s_lshl_b32 s32, s23, 8
    s_lshl_b32 s33, s24, 7
    s_add_u32 s32, s32, s33
    v_mfma_f32_32x32x16_bf16 v[112:127], v[36:39], v[52:55], v[112:127]
    s_add_u32 s32, s32, 131072
    v_lshlrev_b32 v244, 4, v2
    v_add_u32 v244, s32, v244
    v_xor_b32 v245, 128, v244
    v_mfma_f32_4x4x4_16b_bf16 v[128:131], v[32:33], v[32:33], v[128:131]
    v_mfma_f32_16x16x32_bf16 v[136:139], v[144:147], v[32:35], v[136:139]
    v_mfma_f32_4x4x4_16b_bf16 v[132:135], v[34:35], v[34:35], v[132:135]
    v_mfma_f32_16x16x32_bf16 v[140:143], v[144:147], v[48:51], v[140:143]
    s_waitcnt lgkmcnt(6)
    v_mfma_f32_32x32x16_bf16 v[64:79], v[40:43], v[56:59], v[64:79]
    ds_read_b128 v[32:35], v14 offset:16384
    ds_read_b128 v[36:39], v18 offset:16384
    v_and_b32 v3, 3, v0
    v_cmp_eq_u32 s[28:29], 1, v3
    v_cmp_eq_u32 s[30:31], 2, v3
    v_cmp_eq_u32 s[44:45], 3, v3
    v_mfma_f32_32x32x16_bf16 v[80:95], v[44:47], v[56:59], v[80:95]
    ds_read_b64_tr_b16 v[48:49], v20 offset:24576
    ds_read_b64_tr_b16 v[50:51], v20 offset:25600
    v_mfma_f32_32x32x16_bf16 v[96:111], v[40:43], v[60:63], v[96:111]
    ds_read_b64_tr_b16 v[52:53], v21 offset:24576
    ds_read_b64_tr_b16 v[54:55], v21 offset:25600
    v_mfma_f32_32x32x16_bf16 v[112:127], v[44:47], v[60:63], v[112:127]
    v_mfma_f32_4x4x4_16b_bf16 v[128:131], v[40:41], v[40:41], v[128:131]
    v_mfma_f32_16x16x32_bf16 v[136:139], v[144:147], v[40:43], v[136:139]
    v_mfma_f32_4x4x4_16b_bf16 v[132:135], v[42:43], v[42:43], v[132:135]
    v_mfma_f32_16x16x32_bf16 v[140:143], v[144:147], v[56:59], v[140:143]
    s_waitcnt lgkmcnt(6)
    v_mfma_f32_32x32x16_bf16 v[64:79], v[148:151], v[156:159], v[64:79]
    ds_read_b128 v[40:43], v15 offset:16384
    ds_read_b128 v[44:47], v19 offset:16384
    v_mfma_f32_32x32x16_bf16 v[80:95], v[152:155], v[156:159], v[80:95]
    ds_read_b64_tr_b16 v[56:57], v20 offset:28672
    ds_read_b64_tr_b16 v[58:59], v20 offset:29696
    v_mfma_f32_32x32x16_bf16 v[96:111], v[148:151], v[160:163], v[96:111]
    ds_read_b64_tr_b16 v[60:61], v21 offset:28672
    ds_read_b64_tr_b16 v[62:63], v21 offset:29696
    v_mfma_f32_32x32x16_bf16 v[112:127], v[152:155], v[160:163], v[112:127]
    v_mfma_f32_4x4x4_16b_bf16 v[128:131], v[148:149], v[148:149], v[128:131]
    v_mfma_f32_16x16x32_bf16 v[136:139], v[144:147], v[148:151], v[136:139]
    v_mfma_f32_4x4x4_16b_bf16 v[132:135], v[150:151], v[150:151], v[132:135]
    v_mfma_f32_16x16x32_bf16 v[140:143], v[144:147], v[156:159], v[140:143]
    s_waitcnt lgkmcnt(0)
    s_barrier
    v_mfma_f32_32x32x16_bf16 v[64:79], v[32:35], v[48:51], v[64:79]
    ds_read_b128 v[148:151], v12 offset:32768
    ds_read_b128 v[152:155], v16 offset:32768
    v_mfma_f32_32x32x16_bf16 v[80:95], v[36:39], v[48:51], v[80:95]
    ds_read_b64_tr_b16 v[156:157], v20 offset:32768
    ds_read_b64_tr_b16 v[158:159], v20 offset:33792
    v_mfma_f32_32x32x16_bf16 v[96:111], v[32:35], v[52:55], v[96:111]
    ds_read_b64_tr_b16 v[160:161], v21 offset:32768
    ds_read_b64_tr_b16 v[162:163], v21 offset:33792
    v_mfma_f32_32x32x16_bf16 v[112:127], v[36:39], v[52:55], v[112:127]
    v_mfma_f32_4x4x4_16b_bf16 v[128:131], v[32:33], v[32:33], v[128:131]
    v_mfma_f32_16x16x32_bf16 v[136:139], v[144:147], v[32:35], v[136:139]
    v_mfma_f32_4x4x4_16b_bf16 v[132:135], v[34:35], v[34:35], v[132:135]
    v_mfma_f32_16x16x32_bf16 v[140:143], v[144:147], v[48:51], v[140:143]
    v_mfma_f32_32x32x16_bf16 v[64:79], v[40:43], v[56:59], v[64:79]
    ds_read_b128 v[32:35], v13 offset:32768
    ds_read_b128 v[36:39], v17 offset:32768
    v_mfma_f32_32x32x16_bf16 v[80:95], v[44:47], v[56:59], v[80:95]
    ds_read_b64_tr_b16 v[48:49], v20 offset:36864
    ds_read_b64_tr_b16 v[50:51], v20 offset:37888
    v_mfma_f32_32x32x16_bf16 v[96:111], v[40:43], v[60:63], v[96:111]
    ds_read_b64_tr_b16 v[52:53], v21 offset:36864
    ds_read_b64_tr_b16 v[54:55], v21 offset:37888
    v_mfma_f32_32x32x16_bf16 v[112:127], v[44:47], v[60:63], v[112:127]
    v_mfma_f32_4x4x4_16b_bf16 v[128:131], v[40:41], v[40:41], v[128:131]
    v_mfma_f32_16x16x32_bf16 v[136:139], v[144:147], v[40:43], v[136:139]
    v_mfma_f32_4x4x4_16b_bf16 v[132:135], v[42:43], v[42:43], v[132:135]
    v_mfma_f32_16x16x32_bf16 v[140:143], v[144:147], v[56:59], v[140:143]
    s_waitcnt lgkmcnt(6)
    v_mfma_f32_32x32x16_bf16 v[64:79], v[148:151], v[156:159], v[64:79]
    ds_read_b128 v[40:43], v14 offset:32768
    ds_read_b128 v[44:47], v18 offset:32768
    v_mfma_f32_32x32x16_bf16 v[80:95], v[152:155], v[156:159], v[80:95]
    ds_read_b64_tr_b16 v[56:57], v20 offset:40960
    ds_read_b64_tr_b16 v[58:59], v20 offset:41984
    v_mfma_f32_32x32x16_bf16 v[96:111], v[148:151], v[160:163], v[96:111]
    ds_read_b64_tr_b16 v[60:61], v21 offset:40960
    ds_read_b64_tr_b16 v[62:63], v21 offset:41984
    v_mfma_f32_32x32x16_bf16 v[112:127], v[152:155], v[160:163], v[112:127]
    v_mfma_f32_4x4x4_16b_bf16 v[128:131], v[148:149], v[148:149], v[128:131]
    v_mfma_f32_16x16x32_bf16 v[136:139], v[144:147], v[148:151], v[136:139]
    v_mfma_f32_4x4x4_16b_bf16 v[132:135], v[150:151], v[150:151], v[132:135]
    v_mfma_f32_16x16x32_bf16 v[140:143], v[144:147], v[156:159], v[140:143]
    s_waitcnt lgkmcnt(6)
    v_mfma_f32_32x32x16_bf16 v[64:79], v[32:35], v[48:51], v[64:79]
    ds_read_b128 v[148:151], v15 offset:32768
    ds_read_b128 v[152:155], v19 offset:32768
    v_mfma_f32_32x32x16_bf16 v[80:95], v[36:39], v[48:51], v[80:95]
    ds_read_b64_tr_b16 v[156:157], v20 offset:45056
    ds_read_b64_tr_b16 v[158:159], v20 offset:46080
    v_mfma_f32_32x32x16_bf16 v[96:111], v[32:35], v[52:55], v[96:111]
    ds_read_b64_tr_b16 v[160:161], v21 offset:45056
    ds_read_b64_tr_b16 v[162:163], v21 offset:46080
    v_mfma_f32_32x32x16_bf16 v[112:127], v[36:39], v[52:55], v[112:127]
    v_mfma_f32_4x4x4_16b_bf16 v[128:131], v[32:33], v[32:33], v[128:131]
    v_mfma_f32_16x16x32_bf16 v[136:139], v[144:147], v[32:35], v[136:139]
    v_mfma_f32_4x4x4_16b_bf16 v[132:135], v[34:35], v[34:35], v[132:135]
    v_mfma_f32_16x16x32_bf16 v[140:143], v[144:147], v[48:51], v[140:143]
    s_waitcnt lgkmcnt(0)
    s_barrier
    v_mfma_f32_32x32x16_bf16 v[64:79], v[40:43], v[56:59], v[64:79]
    ds_read_b128 v[32:35], v12 offset:49152
    ds_read_b128 v[36:39], v16 offset:49152
    v_mfma_f32_32x32x16_bf16 v[80:95], v[44:47], v[56:59], v[80:95]
    ds_read_b64_tr_b16 v[48:49], v20 offset:49152
    ds_read_b64_tr_b16 v[50:51], v20 offset:50176
    v_mfma_f32_32x32x16_bf16 v[96:111], v[40:43], v[60:63], v[96:111]
    ds_read_b64_tr_b16 v[52:53], v21 offset:49152
    ds_read_b64_tr_b16 v[54:55], v21 offset:50176
    v_mfma_f32_32x32x16_bf16 v[112:127], v[44:47], v[60:63], v[112:127]
    v_mfma_f32_4x4x4_16b_bf16 v[128:131], v[40:41], v[40:41], v[128:131]
    v_mfma_f32_16x16x32_bf16 v[136:139], v[144:147], v[40:43], v[136:139]
    v_mfma_f32_4x4x4_16b_bf16 v[132:135], v[42:43], v[42:43], v[132:135]
    v_mfma_f32_16x16x32_bf16 v[140:143], v[144:147], v[56:59], v[140:143]
    v_mfma_f32_32x32x16_bf16 v[64:79], v[148:151], v[156:159], v[64:79]
    ds_read_b128 v[40:43], v13 offset:49152
    ds_read_b128 v[44:47], v17 offset:49152
    v_mfma_f32_32x32x16_bf16 v[80:95], v[152:155], v[156:159], v[80:95]
    ds_read_b64_tr_b16 v[56:57], v20 offset:53248
    ds_read_b64_tr_b16 v[58:59], v20 offset:54272
    v_mfma_f32_32x32x16_bf16 v[96:111], v[148:151], v[160:163], v[96:111]
    ds_read_b64_tr_b16 v[60:61], v21 offset:53248
    ds_read_b64_tr_b16 v[62:63], v21 offset:54272
    v_mfma_f32_32x32x16_bf16 v[112:127], v[152:155], v[160:163], v[112:127]
    v_mfma_f32_4x4x4_16b_bf16 v[128:131], v[148:149], v[148:149], v[128:131]
    v_mfma_f32_16x16x32_bf16 v[136:139], v[144:147], v[148:151], v[136:139]
    v_mfma_f32_4x4x4_16b_bf16 v[132:135], v[150:151], v[150:151], v[132:135]
    v_mfma_f32_16x16x32_bf16 v[140:143], v[144:147], v[156:159], v[140:143]
    s_waitcnt lgkmcnt(6)
    v_mfma_f32_32x32x16_bf16 v[64:79], v[32:35], v[48:51], v[64:79]
    ds_read_b128 v[148:151], v14 offset:49152
    ds_read_b128 v[152:155], v18 offset:49152
    v_mfma_f32_32x32x16_bf16 v[80:95], v[36:39], v[48:51], v[80:95]
    ds_read_b64_tr_b16 v[156:157], v20 offset:57344
    ds_read_b64_tr_b16 v[158:159], v20 offset:58368
    v_mfma_f32_32x32x16_bf16 v[96:111], v[32:35], v[52:55], v[96:111]
    ds_read_b64_tr_b16 v[160:161], v21 offset:57344
    ds_read_b64_tr_b16 v[162:163], v21 offset:58368
    v_mfma_f32_32x32x16_bf16 v[112:127], v[36:39], v[52:55], v[112:127]
    v_mfma_f32_4x4x4_16b_bf16 v[128:131], v[32:33], v[32:33], v[128:131]
    v_mfma_f32_16x16x32_bf16 v[136:139], v[144:147], v[32:35], v[136:139]
    v_mfma_f32_4x4x4_16b_bf16 v[132:135], v[34:35], v[34:35], v[132:135]
    v_mfma_f32_16x16x32_bf16 v[140:143], v[144:147], v[48:51], v[140:143]
    s_waitcnt lgkmcnt(6)
    v_mfma_f32_32x32x16_bf16 v[64:79], v[40:43], v[56:59], v[64:79]
    ds_read_b128 v[32:35], v15 offset:49152
    ds_read_b128 v[36:39], v19 offset:49152
    v_mfma_f32_32x32x16_bf16 v[80:95], v[44:47], v[56:59], v[80:95]
    ds_read_b64_tr_b16 v[48:49], v20 offset:61440
    ds_read_b64_tr_b16 v[50:51], v20 offset:62464
    v_mfma_f32_32x32x16_bf16 v[96:111], v[40:43], v[60:63], v[96:111]
    ds_read_b64_tr_b16 v[52:53], v21 offset:61440
    ds_read_b64_tr_b16 v[54:55], v21 offset:62464
    v_mfma_f32_32x32x16_bf16 v[112:127], v[44:47], v[60:63], v[112:127]
    v_mfma_f32_4x4x4_16b_bf16 v[128:131], v[40:41], v[40:41], v[128:131]
    v_mfma_f32_16x16x32_bf16 v[136:139], v[144:147], v[40:43], v[136:139]
    v_mfma_f32_4x4x4_16b_bf16 v[132:135], v[42:43], v[42:43], v[132:135]
    v_mfma_f32_16x16x32_bf16 v[140:143], v[144:147], v[56:59], v[140:143]
    s_waitcnt lgkmcnt(0)
    s_barrier
    v_mfma_f32_32x32x16_bf16 v[64:79], v[148:151], v[156:159], v[64:79]
    ds_read_b128 v[40:43], v12 offset:0
    ds_read_b128 v[44:47], v16 offset:0
    v_mfma_f32_32x32x16_bf16 v[80:95], v[152:155], v[156:159], v[80:95]
    ds_read_b64_tr_b16 v[56:57], v20 offset:0
    ds_read_b64_tr_b16 v[58:59], v20 offset:1024
    v_mfma_f32_32x32x16_bf16 v[96:111], v[148:151], v[160:163], v[96:111]
    ds_read_b64_tr_b16 v[60:61], v21 offset:0
    ds_read_b64_tr_b16 v[62:63], v21 offset:1024
    v_mfma_f32_32x32x16_bf16 v[112:127], v[152:155], v[160:163], v[112:127]
    v_mfma_f32_4x4x4_16b_bf16 v[128:131], v[148:149], v[148:149], v[128:131]
    v_mfma_f32_16x16x32_bf16 v[136:139], v[144:147], v[148:151], v[136:139]
    v_mfma_f32_4x4x4_16b_bf16 v[132:135], v[150:151], v[150:151], v[132:135]
    v_mfma_f32_16x16x32_bf16 v[140:143], v[144:147], v[156:159], v[140:143]
    v_mfma_f32_32x32x16_bf16 v[64:79], v[32:35], v[48:51], v[64:79]
    ds_read_b128 v[148:151], v13 offset:0
    ds_read_b128 v[152:155], v17 offset:0
    v_mfma_f32_32x32x16_bf16 v[80:95], v[36:39], v[48:51], v[80:95]
    ds_read_b64_tr_b16 v[156:157], v20 offset:4096
    ds_read_b64_tr_b16 v[158:159], v20 offset:5120
    v_mfma_f32_32x32x16_bf16 v[96:111], v[32:35], v[52:55], v[96:111]
    ds_read_b64_tr_b16 v[160:161], v21 offset:4096
    ds_read_b64_tr_b16 v[162:163], v21 offset:5120
    v_mfma_f32_32x32x16_bf16 v[112:127], v[36:39], v[52:55], v[112:127]
    v_mfma_f32_4x4x4_16b_bf16 v[128:131], v[32:33], v[32:33], v[128:131]
    v_mfma_f32_16x16x32_bf16 v[136:139], v[144:147], v[32:35], v[136:139]
    v_mfma_f32_4x4x4_16b_bf16 v[132:135], v[34:35], v[34:35], v[132:135]
    v_mfma_f32_16x16x32_bf16 v[140:143], v[144:147], v[48:51], v[140:143]
    s_waitcnt lgkmcnt(6)
    v_mfma_f32_32x32x16_bf16 v[64:79], v[40:43], v[56:59], v[64:79]
    ds_read_b128 v[32:35], v14 offset:0
    ds_read_b128 v[36:39], v18 offset:0
    v_mfma_f32_32x32x16_bf16 v[80:95], v[44:47], v[56:59], v[80:95]
    ds_read_b64_tr_b16 v[48:49], v20 offset:8192
    ds_read_b64_tr_b16 v[50:51], v20 offset:9216
    v_mfma_f32_32x32x16_bf16 v[96:111], v[40:43], v[60:63], v[96:111]
    ds_read_b64_tr_b16 v[52:53], v21 offset:8192
    ds_read_b64_tr_b16 v[54:55], v21 offset:9216
    v_mfma_f32_32x32x16_bf16 v[112:127], v[44:47], v[60:63], v[112:127]
    v_mfma_f32_4x4x4_16b_bf16 v[128:131], v[40:41], v[40:41], v[128:131]
    v_mfma_f32_16x16x32_bf16 v[136:139], v[144:147], v[40:43], v[136:139]
    v_mfma_f32_4x4x4_16b_bf16 v[132:135], v[42:43], v[42:43], v[132:135]
    v_mfma_f32_16x16x32_bf16 v[140:143], v[144:147], v[56:59], v[140:143]
    s_waitcnt lgkmcnt(6)
    v_mfma_f32_32x32x16_bf16 v[64:79], v[148:151], v[156:159], v[64:79]
    ds_read_b128 v[40:43], v15 offset:0
    ds_read_b128 v[44:47], v19 offset:0
    v_mfma_f32_32x32x16_bf16 v[80:95], v[152:155], v[156:159], v[80:95]
    ds_read_b64_tr_b16 v[56:57], v20 offset:12288
    ds_read_b64_tr_b16 v[58:59], v20 offset:13312
    v_mfma_f32_32x32x16_bf16 v[96:111], v[148:151], v[160:163], v[96:111]
    ds_read_b64_tr_b16 v[60:61], v21 offset:12288
    ds_read_b64_tr_b16 v[62:63], v21 offset:13312
    v_mfma_f32_32x32x16_bf16 v[112:127], v[152:155], v[160:163], v[112:127]
    v_mfma_f32_4x4x4_16b_bf16 v[128:131], v[148:149], v[148:149], v[128:131]
    v_mfma_f32_16x16x32_bf16 v[136:139], v[144:147], v[148:151], v[136:139]
    v_mfma_f32_4x4x4_16b_bf16 v[132:135], v[150:151], v[150:151], v[132:135]
    v_mfma_f32_16x16x32_bf16 v[140:143], v[144:147], v[156:159], v[140:143]
    s_waitcnt lgkmcnt(0)
    s_barrier
    v_mfma_f32_32x32x16_bf16 v[64:79], v[32:35], v[48:51], v[64:79]
    ds_read_b128 v[148:151], v12 offset:16384
    ds_read_b128 v[152:155], v16 offset:16384
    v_mfma_f32_32x32x16_bf16 v[80:95], v[36:39], v[48:51], v[80:95]
    ds_read_b64_tr_b16 v[156:157], v20 offset:16384
    ds_read_b64_tr_b16 v[158:159], v20 offset:17408
    v_mfma_f32_32x32x16_bf16 v[96:111], v[32:35], v[52:55], v[96:111]
    ds_read_b64_tr_b16 v[160:161], v21 offset:16384
    ds_read_b64_tr_b16 v[162:163], v21 offset:17408
    v_mfma_f32_32x32x16_bf16 v[112:127], v[36:39], v[52:55], v[112:127]
    v_mfma_f32_4x4x4_16b_bf16 v[128:131], v[32:33], v[32:33], v[128:131]
    v_mfma_f32_16x16x32_bf16 v[136:139], v[144:147], v[32:35], v[136:139]
    v_mfma_f32_4x4x4_16b_bf16 v[132:135], v[34:35], v[34:35], v[132:135]
    v_mfma_f32_16x16x32_bf16 v[140:143], v[144:147], v[48:51], v[140:143]
    v_mfma_f32_32x32x16_bf16 v[64:79], v[40:43], v[56:59], v[64:79]
    ds_read_b128 v[32:35], v13 offset:16384
    ds_read_b128 v[36:39], v17 offset:16384
    v_mfma_f32_32x32x16_bf16 v[80:95], v[44:47], v[56:59], v[80:95]
    ds_read_b64_tr_b16 v[48:49], v20 offset:20480
    ds_read_b64_tr_b16 v[50:51], v20 offset:21504
    v_mfma_f32_32x32x16_bf16 v[96:111], v[40:43], v[60:63], v[96:111]
    ds_read_b64_tr_b16 v[52:53], v21 offset:20480
    ds_read_b64_tr_b16 v[54:55], v21 offset:21504
    v_mfma_f32_32x32x16_bf16 v[112:127], v[44:47], v[60:63], v[112:127]
    v_mfma_f32_4x4x4_16b_bf16 v[128:131], v[40:41], v[40:41], v[128:131]
    v_mfma_f32_16x16x32_bf16 v[136:139], v[144:147], v[40:43], v[136:139]
    v_mfma_f32_4x4x4_16b_bf16 v[132:135], v[42:43], v[42:43], v[132:135]
    v_mfma_f32_16x16x32_bf16 v[140:143], v[144:147], v[56:59], v[140:143]
    s_waitcnt lgkmcnt(6)
    v_mfma_f32_32x32x16_bf16 v[64:79], v[148:151], v[156:159], v[64:79]
    ds_read_b128 v[40:43], v14 offset:16384
    ds_read_b128 v[44:47], v18 offset:16384
    v_mfma_f32_32x32x16_bf16 v[80:95], v[152:155], v[156:159], v[80:95]
    ds_read_b64_tr_b16 v[56:57], v20 offset:24576
    ds_read_b64_tr_b16 v[58:59], v20 offset:25600
    v_mfma_f32_32x32x16_bf16 v[96:111], v[148:151], v[160:163], v[96:111]
    ds_read_b64_tr_b16 v[60:61], v21 offset:24576
    ds_read_b64_tr_b16 v[62:63], v21 offset:25600
    v_mfma_f32_32x32x16_bf16 v[112:127], v[152:155], v[160:163], v[112:127]
    v_mfma_f32_4x4x4_16b_bf16 v[128:131], v[148:149], v[148:149], v[128:131]
    v_mfma_f32_16x16x32_bf16 v[136:139], v[144:147], v[148:151], v[136:139]
    v_mfma_f32_4x4x4_16b_bf16 v[132:135], v[150:151], v[150:151], v[132:135]
    v_mfma_f32_16x16x32_bf16 v[140:143], v[144:147], v[156:159], v[140:143]
    s_waitcnt lgkmcnt(6)
    v_mfma_f32_32x32x16_bf16 v[64:79], v[32:35], v[48:51], v[64:79]
    ds_read_b128 v[148:151], v15 offset:16384
    ds_read_b128 v[152:155], v19 offset:16384
    v_mfma_f32_32x32x16_bf16 v[80:95], v[36:39], v[48:51], v[80:95]
    ds_read_b64_tr_b16 v[156:157], v20 offset:28672
    ds_read_b64_tr_b16 v[158:159], v20 offset:29696
    v_mfma_f32_32x32x16_bf16 v[96:111], v[32:35], v[52:55], v[96:111]
    ds_read_b64_tr_b16 v[160:161], v21 offset:28672
    ds_read_b64_tr_b16 v[162:163], v21 offset:29696
    v_mfma_f32_32x32x16_bf16 v[112:127], v[36:39], v[52:55], v[112:127]
    v_mfma_f32_4x4x4_16b_bf16 v[128:131], v[32:33], v[32:33], v[128:131]
    v_mfma_f32_16x16x32_bf16 v[136:139], v[144:147], v[32:35], v[136:139]
    v_mfma_f32_4x4x4_16b_bf16 v[132:135], v[34:35], v[34:35], v[132:135]
    v_mfma_f32_16x16x32_bf16 v[140:143], v[144:147], v[48:51], v[140:143]
    s_waitcnt lgkmcnt(0)
    s_barrier
    v_mfma_f32_32x32x16_bf16 v[64:79], v[40:43], v[56:59], v[64:79]
    ds_read_b128 v[32:35], v12 offset:32768
    ds_read_b128 v[36:39], v16 offset:32768
    v_mfma_f32_32x32x16_bf16 v[80:95], v[44:47], v[56:59], v[80:95]
    ds_read_b64_tr_b16 v[48:49], v20 offset:32768
    ds_read_b64_tr_b16 v[50:51], v20 offset:33792
    v_mfma_f32_32x32x16_bf16 v[96:111], v[40:43], v[60:63], v[96:111]
    ds_read_b64_tr_b16 v[52:53], v21 offset:32768
    ds_read_b64_tr_b16 v[54:55], v21 offset:33792
    v_mfma_f32_32x32x16_bf16 v[112:127], v[44:47], v[60:63], v[112:127]
    v_mfma_f32_4x4x4_16b_bf16 v[128:131], v[40:41], v[40:41], v[128:131]
    v_mfma_f32_16x16x32_bf16 v[136:139], v[144:147], v[40:43], v[136:139]
    v_mfma_f32_4x4x4_16b_bf16 v[132:135], v[42:43], v[42:43], v[132:135]
    v_mfma_f32_16x16x32_bf16 v[140:143], v[144:147], v[56:59], v[140:143]
    v_mfma_f32_32x32x16_bf16 v[64:79], v[148:151], v[156:159], v[64:79]
    ds_read_b128 v[40:43], v13 offset:32768
    ds_read_b128 v[44:47], v17 offset:32768
    v_mfma_f32_32x32x16_bf16 v[80:95], v[152:155], v[156:159], v[80:95]
    ds_read_b64_tr_b16 v[56:57], v20 offset:36864
    ds_read_b64_tr_b16 v[58:59], v20 offset:37888
    v_mfma_f32_32x32x16_bf16 v[96:111], v[148:151], v[160:163], v[96:111]
    ds_read_b64_tr_b16 v[60:61], v21 offset:36864
    ds_read_b64_tr_b16 v[62:63], v21 offset:37888
    v_mfma_f32_32x32x16_bf16 v[112:127], v[152:155], v[160:163], v[112:127]
    v_mfma_f32_4x4x4_16b_bf16 v[128:131], v[148:149], v[148:149], v[128:131]
    v_mfma_f32_16x16x32_bf16 v[136:139], v[144:147], v[148:151], v[136:139]
    v_mfma_f32_4x4x4_16b_bf16 v[132:135], v[150:151], v[150:151], v[132:135]
    v_mfma_f32_16x16x32_bf16 v[140:143], v[144:147], v[156:159], v[140:143]
    s_waitcnt lgkmcnt(6)
    v_mfma_f32_32x32x16_bf16 v[64:79], v[32:35], v[48:51], v[64:79]
    ds_read_b128 v[148:151], v14 offset:32768
    ds_read_b128 v[152:155], v18 offset:32768
    v_mfma_f32_32x32x16_bf16 v[80:95], v[36:39], v[48:51], v[80:95]
    ds_read_b64_tr_b16 v[156:157], v20 offset:40960
    ds_read_b64_tr_b16 v[158:159], v20 offset:41984
    v_mfma_f32_32x32x16_bf16 v[96:111], v[32:35], v[52:55], v[96:111]
    ds_read_b64_tr_b16 v[160:161], v21 offset:40960
    ds_read_b64_tr_b16 v[162:163], v21 offset:41984
    v_mfma_f32_32x32x16_bf16 v[112:127], v[36:39], v[52:55], v[112:127]
    v_mfma_f32_4x4x4_16b_bf16 v[128:131], v[32:33], v[32:33], v[128:131]
    v_mfma_f32_16x16x32_bf16 v[136:139], v[144:147], v[32:35], v[136:139]
    v_mfma_f32_4x4x4_16b_bf16 v[132:135], v[34:35], v[34:35], v[132:135]
    v_mfma_f32_16x16x32_bf16 v[140:143], v[144:147], v[48:51], v[140:143]
    s_waitcnt lgkmcnt(6)
    v_mfma_f32_32x32x16_bf16 v[64:79], v[40:43], v[56:59], v[64:79]
    ds_read_b128 v[32:35], v15 offset:32768
    ds_read_b128 v[36:39], v19 offset:32768
    v_mfma_f32_32x32x16_bf16 v[80:95], v[44:47], v[56:59], v[80:95]
    ds_read_b64_tr_b16 v[48:49], v20 offset:45056
    ds_read_b64_tr_b16 v[50:51], v20 offset:46080
    v_mfma_f32_32x32x16_bf16 v[96:111], v[40:43], v[60:63], v[96:111]
    ds_read_b64_tr_b16 v[52:53], v21 offset:45056
    ds_read_b64_tr_b16 v[54:55], v21 offset:46080
    v_mfma_f32_32x32x16_bf16 v[112:127], v[44:47], v[60:63], v[112:127]
    v_mfma_f32_4x4x4_16b_bf16 v[128:131], v[40:41], v[40:41], v[128:131]
    v_mfma_f32_16x16x32_bf16 v[136:139], v[144:147], v[40:43], v[136:139]
    v_mfma_f32_4x4x4_16b_bf16 v[132:135], v[42:43], v[42:43], v[132:135]
    v_mfma_f32_16x16x32_bf16 v[140:143], v[144:147], v[56:59], v[140:143]
    s_waitcnt lgkmcnt(0)
    s_barrier
    v_mfma_f32_32x32x16_bf16 v[64:79], v[148:151], v[156:159], v[64:79]
    ds_read_b128 v[40:43], v12 offset:49152
    ds_read_b128 v[44:47], v16 offset:49152
    v_mfma_f32_32x32x16_bf16 v[80:95], v[152:155], v[156:159], v[80:95]
    ds_read_b64_tr_b16 v[56:57], v20 offset:49152
    ds_read_b64_tr_b16 v[58:59], v20 offset:50176
    v_mfma_f32_32x32x16_bf16 v[96:111], v[148:151], v[160:163], v[96:111]
    ds_read_b64_tr_b16 v[60:61], v21 offset:49152
    ds_read_b64_tr_b16 v[62:63], v21 offset:50176
    v_mfma_f32_32x32x16_bf16 v[112:127], v[152:155], v[160:163], v[112:127]
    v_mfma_f32_4x4x4_16b_bf16 v[128:131], v[148:149], v[148:149], v[128:131]
    v_mfma_f32_16x16x32_bf16 v[136:139], v[144:147], v[148:151], v[136:139]
    v_mfma_f32_4x4x4_16b_bf16 v[132:135], v[150:151], v[150:151], v[132:135]
    v_mfma_f32_16x16x32_bf16 v[140:143], v[144:147], v[156:159], v[140:143]
    v_mfma_f32_32x32x16_bf16 v[64:79], v[32:35], v[48:51], v[64:79]
    ds_read_b128 v[148:151], v13 offset:49152
    ds_read_b128 v[152:155], v17 offset:49152
    v_mfma_f32_32x32x16_bf16 v[80:95], v[36:39], v[48:51], v[80:95]
    ds_read_b64_tr_b16 v[156:157], v20 offset:53248
    ds_read_b64_tr_b16 v[158:159], v20 offset:54272
    v_mfma_f32_32x32x16_bf16 v[96:111], v[32:35], v[52:55], v[96:111]
    ds_read_b64_tr_b16 v[160:161], v21 offset:53248
    ds_read_b64_tr_b16 v[162:163], v21 offset:54272
    v_mfma_f32_32x32x16_bf16 v[112:127], v[36:39], v[52:55], v[112:127]
    v_mfma_f32_4x4x4_16b_bf16 v[128:131], v[32:33], v[32:33], v[128:131]
    v_mfma_f32_16x16x32_bf16 v[136:139], v[144:147], v[32:35], v[136:139]
    v_mfma_f32_4x4x4_16b_bf16 v[132:135], v[34:35], v[34:35], v[132:135]
    v_mfma_f32_16x16x32_bf16 v[140:143], v[144:147], v[48:51], v[140:143]
    s_waitcnt lgkmcnt(6)
    v_mfma_f32_32x32x16_bf16 v[64:79], v[40:43], v[56:59], v[64:79]
    ds_read_b128 v[32:35], v14 offset:49152
    ds_read_b128 v[36:39], v18 offset:49152
    v_mfma_f32_32x32x16_bf16 v[80:95], v[44:47], v[56:59], v[80:95]
    ds_read_b64_tr_b16 v[48:49], v20 offset:57344
    ds_read_b64_tr_b16 v[50:51], v20 offset:58368
    v_mfma_f32_32x32x16_bf16 v[96:111], v[40:43], v[60:63], v[96:111]
    ds_read_b64_tr_b16 v[52:53], v21 offset:57344
    ds_read_b64_tr_b16 v[54:55], v21 offset:58368
    v_mfma_f32_32x32x16_bf16 v[112:127], v[44:47], v[60:63], v[112:127]
    v_mfma_f32_4x4x4_16b_bf16 v[128:131], v[40:41], v[40:41], v[128:131]
    v_mfma_f32_16x16x32_bf16 v[136:139], v[144:147], v[40:43], v[136:139]
    v_mfma_f32_4x4x4_16b_bf16 v[132:135], v[42:43], v[42:43], v[132:135]
    v_mfma_f32_16x16x32_bf16 v[140:143], v[144:147], v[56:59], v[140:143]
    s_waitcnt lgkmcnt(6)
    v_mfma_f32_32x32x16_bf16 v[64:79], v[148:151], v[156:159], v[64:79]
    ds_read_b128 v[40:43], v15 offset:49152
    ds_read_b128 v[44:47], v19 offset:49152
    v_mfma_f32_32x32x16_bf16 v[80:95], v[152:155], v[156:159], v[80:95]
    ds_read_b64_tr_b16 v[56:57], v20 offset:61440
    ds_read_b64_tr_b16 v[58:59], v20 offset:62464
    v_mfma_f32_32x32x16_bf16 v[96:111], v[148:151], v[160:163], v[96:111]
    ds_read_b64_tr_b16 v[60:61], v21 offset:61440
    ds_read_b64_tr_b16 v[62:63], v21 offset:62464
    v_mfma_f32_32x32x16_bf16 v[112:127], v[152:155], v[160:163], v[112:127]
    v_mfma_f32_4x4x4_16b_bf16 v[128:131], v[148:149], v[148:149], v[128:131]
    v_mfma_f32_16x16x32_bf16 v[136:139], v[144:147], v[148:151], v[136:139]
    v_mfma_f32_4x4x4_16b_bf16 v[132:135], v[150:151], v[150:151], v[132:135]
    v_mfma_f32_16x16x32_bf16 v[140:143], v[144:147], v[156:159], v[140:143]
    s_waitcnt lgkmcnt(0)
    s_barrier
    v_mfma_f32_32x32x16_bf16 v[64:79], v[32:35], v[48:51], v[64:79]
    ds_read_b128 v[148:151], v12 offset:0
    ds_read_b128 v[152:155], v16 offset:0
    v_mfma_f32_32x32x16_bf16 v[80:95], v[36:39], v[48:51], v[80:95]
    ds_read_b64_tr_b16 v[156:157], v20 offset:0
    ds_read_b64_tr_b16 v[158:159], v20 offset:1024
    v_mfma_f32_32x32x16_bf16 v[96:111], v[32:35], v[52:55], v[96:111]
    ds_read_b64_tr_b16 v[160:161], v21 offset:0
    ds_read_b64_tr_b16 v[162:163], v21 offset:1024
    v_mfma_f32_32x32x16_bf16 v[112:127], v[36:39], v[52:55], v[112:127]
    v_mfma_f32_4x4x4_16b_bf16 v[128:131], v[32:33], v[32:33], v[128:131]
    v_mfma_f32_16x16x32_bf16 v[136:139], v[144:147], v[32:35], v[136:139]
    v_mfma_f32_4x4x4_16b_bf16 v[132:135], v[34:35], v[34:35], v[132:135]
    v_mfma_f32_16x16x32_bf16 v[140:143], v[144:147], v[48:51], v[140:143]
    v_mfma_f32_32x32x16_bf16 v[64:79], v[40:43], v[56:59], v[64:79]
    ds_read_b128 v[32:35], v13 offset:0
    ds_read_b128 v[36:39], v17 offset:0
    v_mfma_f32_32x32x16_bf16 v[80:95], v[44:47], v[56:59], v[80:95]
    ds_read_b64_tr_b16 v[48:49], v20 offset:4096
    ds_read_b64_tr_b16 v[50:51], v20 offset:5120
    v_mfma_f32_32x32x16_bf16 v[96:111], v[40:43], v[60:63], v[96:111]
    ds_read_b64_tr_b16 v[52:53], v21 offset:4096
    ds_read_b64_tr_b16 v[54:55], v21 offset:5120
    v_mfma_f32_32x32x16_bf16 v[112:127], v[44:47], v[60:63], v[112:127]
    v_mfma_f32_4x4x4_16b_bf16 v[128:131], v[40:41], v[40:41], v[128:131]
    v_mfma_f32_16x16x32_bf16 v[136:139], v[144:147], v[40:43], v[136:139]
    v_mfma_f32_4x4x4_16b_bf16 v[132:135], v[42:43], v[42:43], v[132:135]
    v_mfma_f32_16x16x32_bf16 v[140:143], v[144:147], v[56:59], v[140:143]
    s_waitcnt lgkmcnt(6)
    v_mfma_f32_32x32x16_bf16 v[64:79], v[148:151], v[156:159], v[64:79]
    ds_read_b128 v[40:43], v14 offset:0
    ds_read_b128 v[44:47], v18 offset:0
    v_mfma_f32_32x32x16_bf16 v[80:95], v[152:155], v[156:159], v[80:95]
    ds_read_b64_tr_b16 v[56:57], v20 offset:8192
    ds_read_b64_tr_b16 v[58:59], v20 offset:9216
    v_mfma_f32_32x32x16_bf16 v[96:111], v[148:151], v[160:163], v[96:111]
    ds_read_b64_tr_b16 v[60:61], v21 offset:8192
    ds_read_b64_tr_b16 v[62:63], v21 offset:9216
    v_mfma_f32_32x32x16_bf16 v[112:127], v[152:155], v[160:163], v[112:127]
    v_mfma_f32_4x4x4_16b_bf16 v[128:131], v[148:149], v[148:149], v[128:131]
    v_mfma_f32_16x16x32_bf16 v[136:139], v[144:147], v[148:151], v[136:139]
    v_mfma_f32_4x4x4_16b_bf16 v[132:135], v[150:151], v[150:151], v[132:135]
    v_mfma_f32_16x16x32_bf16 v[140:143], v[144:147], v[156:159], v[140:143]
    s_waitcnt lgkmcnt(6)
    v_mfma_f32_32x32x16_bf16 v[64:79], v[32:35], v[48:51], v[64:79]
    ds_read_b128 v[148:151], v15 offset:0
    ds_read_b128 v[152:155], v19 offset:0
    v_mfma_f32_32x32x16_bf16 v[80:95], v[36:39], v[48:51], v[80:95]
    ds_read_b64_tr_b16 v[156:157], v20 offset:12288
    ds_read_b64_tr_b16 v[158:159], v20 offset:13312
    v_mfma_f32_32x32x16_bf16 v[96:111], v[32:35], v[52:55], v[96:111]
    ds_read_b64_tr_b16 v[160:161], v21 offset:12288
    ds_read_b64_tr_b16 v[162:163], v21 offset:13312
    v_mfma_f32_32x32x16_bf16 v[112:127], v[36:39], v[52:55], v[112:127]
    v_mfma_f32_4x4x4_16b_bf16 v[128:131], v[32:33], v[32:33], v[128:131]
    v_mfma_f32_16x16x32_bf16 v[136:139], v[144:147], v[32:35], v[136:139]
    v_mfma_f32_4x4x4_16b_bf16 v[132:135], v[34:35], v[34:35], v[132:135]
    v_mfma_f32_16x16x32_bf16 v[140:143], v[144:147], v[48:51], v[140:143]
    s_waitcnt lgkmcnt(0)
    s_barrier
    v_mfma_f32_32x32x16_bf16 v[64:79], v[40:43], v[56:59], v[64:79]
    ds_read_b128 v[32:35], v12 offset:16384
    ds_read_b128 v[36:39], v16 offset:16384
    v_mfma_f32_32x32x16_bf16 v[80:95], v[44:47], v[56:59], v[80:95]
    ds_read_b64_tr_b16 v[48:49], v20 offset:16384
    ds_read_b64_tr_b16 v[50:51], v20 offset:17408
    v_mfma_f32_32x32x16_bf16 v[96:111], v[40:43], v[60:63], v[96:111]
    ds_read_b64_tr_b16 v[52:53], v21 offset:16384
    ds_read_b64_tr_b16 v[54:55], v21 offset:17408
    v_mfma_f32_32x32x16_bf16 v[112:127], v[44:47], v[60:63], v[112:127]
    v_mfma_f32_4x4x4_16b_bf16 v[128:131], v[40:41], v[40:41], v[128:131]
    v_mfma_f32_16x16x32_bf16 v[136:139], v[144:147], v[40:43], v[136:139]
    v_mfma_f32_4x4x4_16b_bf16 v[132:135], v[42:43], v[42:43], v[132:135]
    v_mfma_f32_16x16x32_bf16 v[140:143], v[144:147], v[56:59], v[140:143]
    v_mfma_f32_32x32x16_bf16 v[64:79], v[148:151], v[156:159], v[64:79]
    ds_read_b128 v[40:43], v13 offset:16384
    ds_read_b128 v[44:47], v17 offset:16384
    v_mfma_f32_32x32x16_bf16 v[80:95], v[152:155], v[156:159], v[80:95]
    ds_read_b64_tr_b16 v[56:57], v20 offset:20480
    ds_read_b64_tr_b16 v[58:59], v20 offset:21504
    v_mfma_f32_32x32x16_bf16 v[96:111], v[148:151], v[160:163], v[96:111]
    ds_read_b64_tr_b16 v[60:61], v21 offset:20480
    ds_read_b64_tr_b16 v[62:63], v21 offset:21504
    v_mfma_f32_32x32x16_bf16 v[112:127], v[152:155], v[160:163], v[112:127]
    v_mfma_f32_4x4x4_16b_bf16 v[128:131], v[148:149], v[148:149], v[128:131]
    v_mfma_f32_16x16x32_bf16 v[136:139], v[144:147], v[148:151], v[136:139]
    v_mfma_f32_4x4x4_16b_bf16 v[132:135], v[150:151], v[150:151], v[132:135]
    v_mfma_f32_16x16x32_bf16 v[140:143], v[144:147], v[156:159], v[140:143]
    s_waitcnt lgkmcnt(6)
    v_mfma_f32_32x32x16_bf16 v[64:79], v[32:35], v[48:51], v[64:79]
    ds_read_b128 v[148:151], v14 offset:16384
    ds_read_b128 v[152:155], v18 offset:16384
    v_mfma_f32_32x32x16_bf16 v[80:95], v[36:39], v[48:51], v[80:95]
    ds_read_b64_tr_b16 v[156:157], v20 offset:24576
    ds_read_b64_tr_b16 v[158:159], v20 offset:25600
    v_mfma_f32_32x32x16_bf16 v[96:111], v[32:35], v[52:55], v[96:111]
    ds_read_b64_tr_b16 v[160:161], v21 offset:24576
    ds_read_b64_tr_b16 v[162:163], v21 offset:25600
    v_mfma_f32_32x32x16_bf16 v[112:127], v[36:39], v[52:55], v[112:127]
    v_mfma_f32_4x4x4_16b_bf16 v[128:131], v[32:33], v[32:33], v[128:131]
    v_mfma_f32_16x16x32_bf16 v[136:139], v[144:147], v[32:35], v[136:139]
    v_mfma_f32_4x4x4_16b_bf16 v[132:135], v[34:35], v[34:35], v[132:135]
    v_mfma_f32_16x16x32_bf16 v[140:143], v[144:147], v[48:51], v[140:143]
    s_waitcnt lgkmcnt(6)
    v_mfma_f32_32x32x16_bf16 v[64:79], v[40:43], v[56:59], v[64:79]
    ds_read_b128 v[32:35], v15 offset:16384
    ds_read_b128 v[36:39], v19 offset:16384
    v_mfma_f32_32x32x16_bf16 v[80:95], v[44:47], v[56:59], v[80:95]
    ds_read_b64_tr_b16 v[48:49], v20 offset:28672
    ds_read_b64_tr_b16 v[50:51], v20 offset:29696
    v_mfma_f32_32x32x16_bf16 v[96:111], v[40:43], v[60:63], v[96:111]
    ds_read_b64_tr_b16 v[52:53], v21 offset:28672
    ds_read_b64_tr_b16 v[54:55], v21 offset:29696
    v_mfma_f32_32x32x16_bf16 v[112:127], v[44:47], v[60:63], v[112:127]
    v_mfma_f32_4x4x4_16b_bf16 v[128:131], v[40:41], v[40:41], v[128:131]
    v_mfma_f32_16x16x32_bf16 v[136:139], v[144:147], v[40:43], v[136:139]
    v_mfma_f32_4x4x4_16b_bf16 v[132:135], v[42:43], v[42:43], v[132:135]
    v_mfma_f32_16x16x32_bf16 v[140:143], v[144:147], v[56:59], v[140:143]
    s_waitcnt lgkmcnt(6)
    v_mfma_f32_32x32x16_bf16 v[64:79], v[148:151], v[156:159], v[64:79]
    v_mfma_f32_32x32x16_bf16 v[80:95], v[152:155], v[156:159], v[80:95]
    v_mfma_f32_32x32x16_bf16 v[96:111], v[148:151], v[160:163], v[96:111]
    v_mfma_f32_32x32x16_bf16 v[112:127], v[152:155], v[160:163], v[112:127]
    v_mfma_f32_4x4x4_16b_bf16 v[128:131], v[148:149], v[148:149], v[128:131]
    v_mfma_f32_16x16x32_bf16 v[136:139], v[144:147], v[148:151], v[136:139]
    v_mfma_f32_4x4x4_16b_bf16 v[132:135], v[150:151], v[150:151], v[132:135]
    v_mfma_f32_16x16x32_bf16 v[140:143], v[144:147], v[156:159], v[140:143]
    s_waitcnt lgkmcnt(0)
    v_mfma_f32_4x4x4_16b_bf16 v[128:131], v[32:33], v[32:33], v[128:131]
    v_mfma_f32_16x16x32_bf16 v[136:139], v[144:147], v[32:35], v[136:139]
    v_mfma_f32_4x4x4_16b_bf16 v[132:135], v[34:35], v[34:35], v[132:135]
    v_mfma_f32_16x16x32_bf16 v[140:143], v[144:147], v[48:51], v[140:143]
    v_mfma_f32_32x32x16_bf16 v[64:79], v[32:35], v[48:51], v[64:79]
    v_mfma_f32_32x32x16_bf16 v[80:95], v[36:39], v[48:51], v[80:95]
    v_mfma_f32_32x32x16_bf16 v[96:111], v[32:35], v[52:55], v[96:111]
    v_mfma_f32_32x32x16_bf16 v[112:127], v[36:39], v[52:55], v[112:127]
    s_nop 1
    v_add_f32 v128, v128, v132
    v_add_f32 v129, v129, v133
    v_add_f32 v130, v130, v134
    v_add_f32 v131, v131, v135
    v_cndmask_b32 v128, v128, v129, s[28:29]
    v_cndmask_b32 v128, v128, v130, s[30:31]
    v_cndmask_b32 v128, v128, v131, s[44:45]
    v_mov_b32 v132, v128
    v_mul_f32 v2, 0x3acccccd, v136
    s_mov_b64 exec, 0xffffffff
    ds_write_b32 v241, v140
    s_mov_b64 exec, -1
    v_permlane32_swap_b32 v128, v132
    v_add_f32 v128, v128, v132
    v_mul_f32 v3, v2, v2
    v_fma_f32 v3, v128, s36, -v3
    v_max_f32 v3, 0, v3
    v_add_f32 v3, 0x3727c5ac, v3
    v_rsq_f32 v3, v3
    s_mov_b64 exec, 0xffffffff
    v_mul_f32 v3, s37, v3
    v_mul_f32 v2, -v2, v3
    ds_write_b32 v240, v3
    ds_write_b32 v240, v2 offset:512
    s_mov_b64 exec, -1
    s_waitcnt lgkmcnt(0)
    s_barrier
    ds_read_b32 v148, v242
    ds_read_b32 v149, v243
    ds_read_b128 v[184:187], v244 offset:512
    ds_read_b128 v[152:155], v244 offset:0
    ds_read_b128 v[188:191], v244 offset:544
    ds_read_b128 v[156:159], v244 offset:32
    ds_read_b128 v[192:195], v244 offset:576
    ds_read_b128 v[160:163], v244 offset:64
    ds_read_b128 v[196:199], v244 offset:608
    ds_read_b128 v[164:167], v244 offset:96
    ds_read_b128 v[200:203], v245 offset:512
    ds_read_b128 v[168:171], v245 offset:0
    ds_read_b128 v[204:207], v245 offset:544
    ds_read_b128 v[172:175], v245 offset:32
    s_waitcnt lgkmcnt(4)
    ds_read_b128 v[208:211], v245 offset:576
    ds_read_b128 v[176:179], v245 offset:64
    ds_read_b128 v[212:215], v245 offset:608
    ds_read_b128 v[180:183], v245 offset:96
    v_pk_mul_f32 v[216:217], v[184:185], v[148:149] op_sel:[0,0] op_sel_hi:[1,0]
    v_pk_mul_f32 v[218:219], v[186:187], v[148:149] op_sel:[0,0] op_sel_hi:[1,0]
    v_pk_mul_f32 v[220:221], v[188:189], v[148:149] op_sel:[0,0] op_sel_hi:[1,0]
    v_pk_mul_f32 v[222:223], v[190:191], v[148:149] op_sel:[0,0] op_sel_hi:[1,0]
    v_pk_fma_f32 v[216:217], v[64:65], v[152:153], v[216:217]
    v_pk_fma_f32 v[218:219], v[66:67], v[154:155], v[218:219]
    v_pk_fma_f32 v[220:221], v[68:69], v[156:157], v[220:221]
    v_pk_fma_f32 v[222:223], v[70:71], v[158:159], v[222:223]
    v_cvt_pk_bf16_f32 v224, v216, v217
    v_cvt_pk_bf16_f32 v225, v218, v219
    v_cvt_pk_bf16_f32 v226, v220, v221
    v_cvt_pk_bf16_f32 v227, v222, v223
    buffer_store_dwordx4 v[224:227], v22, s[76:79], s38 offen offset:0 sc1
    v_pk_mul_f32 v[228:229], v[192:193], v[148:149] op_sel:[0,0] op_sel_hi:[1,0]
    v_pk_mul_f32 v[230:231], v[194:195], v[148:149] op_sel:[0,0] op_sel_hi:[1,0]
    v_pk_mul_f32 v[232:233], v[196:197], v[148:149] op_sel:[0,0] op_sel_hi:[1,0]
    v_pk_mul_f32 v[234:235], v[198:199], v[148:149] op_sel:[0,0] op_sel_hi:[1,0]
    v_pk_fma_f32 v[228:229], v[72:73], v[160:161], v[228:229]
    v_pk_fma_f32 v[230:231], v[74:75], v[162:163], v[230:231]
    v_pk_fma_f32 v[232:233], v[76:77], v[164:165], v[232:233]
    v_pk_fma_f32 v[234:235], v[78:79], v[166:167], v[234:235]
    v_cvt_pk_bf16_f32 v236, v228, v229
    v_cvt_pk_bf16_f32 v237, v230, v231
    v_cvt_pk_bf16_f32 v238, v232, v233
    v_cvt_pk_bf16_f32 v239, v234, v235
    buffer_store_dwordx4 v[236:239], v22, s[76:79], s38 offen offset:640 sc1
    v_pk_mul_f32 v[216:217], v[184:185], v[148:149] op_sel:[0,1] op_sel_hi:[1,1]
    v_pk_mul_f32 v[218:219], v[186:187], v[148:149] op_sel:[0,1] op_sel_hi:[1,1]
    v_pk_mul_f32 v[220:221], v[188:189], v[148:149] op_sel:[0,1] op_sel_hi:[1,1]
    v_pk_mul_f32 v[222:223], v[190:191], v[148:149] op_sel:[0,1] op_sel_hi:[1,1]
    v_pk_fma_f32 v[216:217], v[96:97], v[152:153], v[216:217]
    v_pk_fma_f32 v[218:219], v[98:99], v[154:155], v[218:219]
    v_pk_fma_f32 v[220:221], v[100:101], v[156:157], v[220:221]
    v_pk_fma_f32 v[222:223], v[102:103], v[158:159], v[222:223]
    v_cvt_pk_bf16_f32 v224, v216, v217
    v_cvt_pk_bf16_f32 v225, v218, v219
    v_cvt_pk_bf16_f32 v226, v220, v221
    v_cvt_pk_bf16_f32 v227, v222, v223
    buffer_store_dwordx4 v[224:227], v23, s[76:79], s38 offen offset:0 sc1
    v_pk_mul_f32 v[228:229], v[192:193], v[148:149] op_sel:[0,1] op_sel_hi:[1,1]
    v_pk_mul_f32 v[230:231], v[194:195], v[148:149] op_sel:[0,1] op_sel_hi:[1,1]
    v_pk_mul_f32 v[232:233], v[196:197], v[148:149] op_sel:[0,1] op_sel_hi:[1,1]
    v_pk_mul_f32 v[234:235], v[198:199], v[148:149] op_sel:[0,1] op_sel_hi:[1,1]
    v_pk_fma_f32 v[228:229], v[104:105], v[160:161], v[228:229]
    v_pk_fma_f32 v[230:231], v[106:107], v[162:163], v[230:231]
    v_pk_fma_f32 v[232:233], v[108:109], v[164:165], v[232:233]
    v_pk_fma_f32 v[234:235], v[110:111], v[166:167], v[234:235]
    v_cvt_pk_bf16_f32 v236, v228, v229
    v_cvt_pk_bf16_f32 v237, v230, v231
    v_cvt_pk_bf16_f32 v238, v232, v233
    v_cvt_pk_bf16_f32 v239, v234, v235
    buffer_store_dwordx4 v[236:239], v23, s[76:79], s38 offen offset:640 sc1
    s_waitcnt lgkmcnt(0)
    v_pk_mul_f32 v[216:217], v[200:201], v[148:149] op_sel:[0,0] op_sel_hi:[1,0]
    v_pk_mul_f32 v[218:219], v[202:203], v[148:149] op_sel:[0,0] op_sel_hi:[1,0]
    v_pk_mul_f32 v[220:221], v[204:205], v[148:149] op_sel:[0,0] op_sel_hi:[1,0]
    v_pk_mul_f32 v[222:223], v[206:207], v[148:149] op_sel:[0,0] op_sel_hi:[1,0]
    v_pk_fma_f32 v[216:217], v[80:81], v[168:169], v[216:217]
    v_pk_fma_f32 v[218:219], v[82:83], v[170:171], v[218:219]
    v_pk_fma_f32 v[220:221], v[84:85], v[172:173], v[220:221]
    v_pk_fma_f32 v[222:223], v[86:87], v[174:175], v[222:223]
    v_cvt_pk_bf16_f32 v224, v216, v217
    v_cvt_pk_bf16_f32 v225, v218, v219
    v_cvt_pk_bf16_f32 v226, v220, v221
    v_cvt_pk_bf16_f32 v227, v222, v223
    buffer_store_dwordx4 v[224:227], v22, s[76:79], s39 offen offset:0 sc1
    v_pk_mul_f32 v[228:229], v[208:209], v[148:149] op_sel:[0,0] op_sel_hi:[1,0]
    v_pk_mul_f32 v[230:231], v[210:211], v[148:149] op_sel:[0,0] op_sel_hi:[1,0]
    v_pk_mul_f32 v[232:233], v[212:213], v[148:149] op_sel:[0,0] op_sel_hi:[1,0]
    v_pk_mul_f32 v[234:235], v[214:215], v[148:149] op_sel:[0,0] op_sel_hi:[1,0]
    v_pk_fma_f32 v[228:229], v[88:89], v[176:177], v[228:229]
    v_pk_fma_f32 v[230:231], v[90:91], v[178:179], v[230:231]
    v_pk_fma_f32 v[232:233], v[92:93], v[180:181], v[232:233]
    v_pk_fma_f32 v[234:235], v[94:95], v[182:183], v[234:235]
    v_cvt_pk_bf16_f32 v236, v228, v229
    v_cvt_pk_bf16_f32 v237, v230, v231
    v_cvt_pk_bf16_f32 v238, v232, v233
    v_cvt_pk_bf16_f32 v239, v234, v235
    buffer_store_dwordx4 v[236:239], v22, s[76:79], s39 offen offset:640 sc1
    v_pk_mul_f32 v[216:217], v[200:201], v[148:149] op_sel:[0,1] op_sel_hi:[1,1]
    v_pk_mul_f32 v[218:219], v[202:203], v[148:149] op_sel:[0,1] op_sel_hi:[1,1]
    v_pk_mul_f32 v[220:221], v[204:205], v[148:149] op_sel:[0,1] op_sel_hi:[1,1]
    v_pk_mul_f32 v[222:223], v[206:207], v[148:149] op_sel:[0,1] op_sel_hi:[1,1]
    v_pk_fma_f32 v[216:217], v[112:113], v[168:169], v[216:217]
    v_pk_fma_f32 v[218:219], v[114:115], v[170:171], v[218:219]
    v_pk_fma_f32 v[220:221], v[116:117], v[172:173], v[220:221]
    v_pk_fma_f32 v[222:223], v[118:119], v[174:175], v[222:223]
    v_cvt_pk_bf16_f32 v224, v216, v217
    v_cvt_pk_bf16_f32 v225, v218, v219
    v_cvt_pk_bf16_f32 v226, v220, v221
    v_cvt_pk_bf16_f32 v227, v222, v223
    buffer_store_dwordx4 v[224:227], v23, s[76:79], s39 offen offset:0 sc1
    v_pk_mul_f32 v[228:229], v[208:209], v[148:149] op_sel:[0,1] op_sel_hi:[1,1]
    v_pk_mul_f32 v[230:231], v[210:211], v[148:149] op_sel:[0,1] op_sel_hi:[1,1]
    v_pk_mul_f32 v[232:233], v[212:213], v[148:149] op_sel:[0,1] op_sel_hi:[1,1]
    v_pk_mul_f32 v[234:235], v[214:215], v[148:149] op_sel:[0,1] op_sel_hi:[1,1]
    v_pk_fma_f32 v[228:229], v[120:121], v[176:177], v[228:229]
    v_pk_fma_f32 v[230:231], v[122:123], v[178:179], v[230:231]
    v_pk_fma_f32 v[232:233], v[124:125], v[180:181], v[232:233]
    v_pk_fma_f32 v[234:235], v[126:127], v[182:183], v[234:235]
    v_cvt_pk_bf16_f32 v236, v228, v229
    v_cvt_pk_bf16_f32 v237, v230, v231
    v_cvt_pk_bf16_f32 v238, v232, v233
    v_cvt_pk_bf16_f32 v239, v234, v235
    buffer_store_dwordx4 v[236:239], v23, s[76:79], s39 offen offset:640 sc1
    s_branch L1_join
L1_help:
    s_sub_u32 s20, s20, 30
    s_lshl_b32 s20, s20, 3
    s_add_u32 s20, s20, s21
    s_mov_b32 s21, 15
    s_waitcnt lgkmcnt(0)
    s_mov_b32 s76, s74
    s_mov_b32 s77, s75
    s_mov_b32 s78, 26411008
    s_mov_b32 s79, 0x20000
    s_cmp_lt_u32 s3, 4
    s_cbranch_scc1 L1_hc
    s_cmp_lg_u32 s3, 4
    s_cbranch_scc1 L1_hp
    s_lshl_b32 s32, s20, 4
    v_add_u32 v16, s32, v0
    v_lshlrev_b32 v16, 7, v16
    v_add_u32 v16, 26279936, v16
    s_mov_b32 s16, s72
    s_mov_b32 s17, s73
    s_mov_b32 s18, 256
    s_mov_b32 s19, 0x20000
    v_mov_b32 v17, 0
    v_mov_b32 v18, 1
    s_mov_b64 exec, 0xffff
    buffer_store_dword v17, v16, s[76:79], 0 offen sc1
    s_waitcnt vmcnt(0)
    s_mov_b64 exec, 1
    buffer_atomic_add v18, v17, s[16:19], 0 offen sc1
    s_mov_b64 exec, -1
L1_hp:
    s_lshl_b32 s44, s22, 8
    s_add_u32 s44, s44, s2
    s_mul_i32 s46, s22, 10240
    s_cmp_lt_u32 s22, 2
    s_cselect_b32 s36, 0, 45056
    s_add_u32 s46, s46, s36
    s_add_u32 s46, s46, 32768
    v_lshrrev_b32 v16, 4, v0
    v_bfe_u32 v17, v0, 2, 2
    v_and_b32 v18, 3, v0
    s_mov_b32 s19, 0x20000
    s_cmp_lt_u32 s44, 640
    s_cbranch_scc0 Lod_15
    s_lshr_b32 s40, s44, 1
    s_and_b32 s41, s44, 1
    s_mul_hi_u32 s36, s40, 214748365
    s_mul_i32 s37, s36, 20
    s_sub_u32 s37, s40, s37
    s_mul_i32 s45, s40, 12288
    s_lshl_b32 s39, s41, 10
    s_add_u32 s45, s45, s39
    s_add_u32 s45, s45, 22315008
    s_mul_i32 s38, s37, 98304
    s_mul_i32 s39, s36, 192
    s_add_u32 s38, s38, s39
    s_cmp_eq_u32 s41, 0
    s_cselect_b32 s16, s64, s66
    s_cselect_b32 s17, s65, s67
    s_mov_b32 s18, 1966080
    v_lshrrev_b32 v19, 1, v0
    v_mul_u32_u24 v19, 3072, v19
    v_and_b32 v21, 1, v0
    v_lshl_add_u32 v19, v21, 4, v19
    s_add_u32 m0, s46, 0
    s_add_u32 s39, s38, 0
    buffer_load_dwordx4 v19, s[16:19], s39 offen  lds
    s_add_u32 m0, s46, 1024
    s_add_u32 s39, s38, 32
    buffer_load_dwordx4 v19, s[16:19], s39 offen  lds
    s_add_u32 m0, s46, 2048
    s_add_u32 s39, s38, 64
    buffer_load_dwordx4 v19, s[16:19], s39 offen  lds
    s_add_u32 m0, s46, 3072
    s_add_u32 s39, s38, 96
    buffer_load_dwordx4 v19, s[16:19], s39 offen  lds
    s_add_u32 m0, s46, 4096
    s_add_u32 s39, s38, 128
    buffer_load_dwordx4 v19, s[16:19], s39 offen  lds
    s_add_u32 m0, s46, 5120
    s_add_u32 s39, s38, 160
    buffer_load_dwordx4 v19, s[16:19], s39 offen  lds
    s_branch Ljd_16
Lnojob_18:
    s_branch Ljd_16
Lod_15:
    s_mov_b32 s45, 0
    s_mov_b32 s52, 0
    s_cmp_lt_u32 s44, 912
    s_cbranch_scc0 Lnojob_18
    s_sub_u32 s36, s44, 640
    s_sub_u32 s37, s44, 720
    s_cmp_lt_u32 s44, 720
    s_cselect_b32 s36, s36, s37
    s_cselect_b32 s37, 429496730, 0
    s_cselect_b32 s38, 0, 178956971
    s_or_b32 s37, s37, s38
    s_cmp_lt_u32 s44, 720
    s_cselect_b32 s38, 10, 24
    s_cselect_b32 s39, 19529728, 0
    s_cselect_b32 s40, 0, 20348928
    s_cselect_b32 s16, s60, s68
    s_cselect_b32 s17, s61, s69
    s_cselect_b32 s18, 819200, 0
    s_cselect_b32 s41, 0, 1966080
    s_cselect_b64 s[42:43], -1, 0
    s_or_b32 s39, s39, s40
    s_or_b32 s18, s18, s41
    s_mul_i32 s45, s36, 10240
    s_add_u32 s45, s45, s39
    s_mul_hi_u32 s37, s36, s37
    s_mul_i32 s38, s37, s38
    s_sub_u32 s38, s36, s38
    s_add_u32 s52, s45, 5120
    s_cmp_lt_u32 s44, 720
    s_cbranch_scc1 Lwo_17
    s_mul_i32 s39, s37, 245760
    s_add_u32 s39, s39, 20348928
    s_lshl_b32 s40, s38, 1
    s_add_u32 s40, s40, 0
    s_mul_hi_u32 s41, s40, 1431655766
    s_mul_i32 s45, s41, 3
    s_sub_u32 s40, s40, s45
    s_lshl_b32 s40, s40, 4
    s_add_u32 s40, s40, s41
    s_mul_i32 s40, s40, 5120
    s_add_u32 s45, s40, s39
    s_lshl_b32 s40, s38, 1
    s_add_u32 s40, s40, 1
    s_mul_hi_u32 s41, s40, 1431655766
    s_mul_i32 s52, s41, 3
    s_sub_u32 s40, s40, s52
    s_lshl_b32 s40, s40, 4
    s_add_u32 s40, s40, s41
    s_mul_i32 s40, s40, 5120
    s_add_u32 s52, s40, s39
Lwo_17:
    s_mul_i32 s37, s37, 160
    s_lshl_b32 s39, s38, 3
    s_lshl_b32 s40, s38, 6
    v_lshrrev_b32 v19, 1, v0
    v_and_b32 v21, 1, v0
    v_bfe_u32 v25, v0, 3, 1
    v_bfe_u32 v27, v0, 1, 2
    v_add3_u32 v22, v16, s39, 0
    v_cmp_le_u32 vcc, 64, v22
    v_lshrrev_b32 v23, 1, v22
    v_subrev_u32 v24, 64, v22
    v_lshl_add_u32 v24, v24, 1, v25
    v_cndmask_b32 v26, v23, v24, vcc
    v_mul_u32_u24 v26, 20, v26
    v_and_b32 v24, 1, v22
    v_lshlrev_b32 v24, 2, v24
    v_lshl_add_u32 v24, v25, 3, v24
    v_cndmask_b32 v24, v24, 16, vcc
    v_add3_u32 v26, v26, v24, v27
    v_add3_u32 v20, v19, s40, 0
    v_cndmask_b32 v20, v20, v26, s[42:43]
    v_mul_u32_u24 v20, 1280, v20
    v_lshl_add_u32 v20, v21, 4, v20
    s_add_u32 m0, s46, 0
    s_add_u32 s41, s37, 0
    buffer_load_dwordx4 v20, s[16:19], s41 offen  lds
    s_add_u32 m0, s46, 1024
    s_add_u32 s41, s37, 32
    buffer_load_dwordx4 v20, s[16:19], s41 offen  lds
    s_add_u32 m0, s46, 2048
    s_add_u32 s41, s37, 64
    buffer_load_dwordx4 v20, s[16:19], s41 offen  lds
    s_add_u32 m0, s46, 3072
    s_add_u32 s41, s37, 96
    buffer_load_dwordx4 v20, s[16:19], s41 offen  lds
    s_add_u32 m0, s46, 4096
    s_add_u32 s41, s37, 128
    buffer_load_dwordx4 v20, s[16:19], s41 offen  lds
    v_add3_u32 v22, v16, s39, 4
    v_cmp_le_u32 vcc, 64, v22
    v_lshrrev_b32 v23, 1, v22
    v_subrev_u32 v24, 64, v22
    v_lshl_add_u32 v24, v24, 1, v25
    v_cndmask_b32 v26, v23, v24, vcc
    v_mul_u32_u24 v26, 20, v26
    v_and_b32 v24, 1, v22
    v_lshlrev_b32 v24, 2, v24
    v_lshl_add_u32 v24, v25, 3, v24
    v_cndmask_b32 v24, v24, 16, vcc
    v_add3_u32 v26, v26, v24, v27
    v_add3_u32 v20, v19, s40, 32
    v_cndmask_b32 v20, v20, v26, s[42:43]
    v_mul_u32_u24 v20, 1280, v20
    v_lshl_add_u32 v20, v21, 4, v20
    s_add_u32 m0, s46, 5120
    s_add_u32 s41, s37, 0
    buffer_load_dwordx4 v20, s[16:19], s41 offen  lds
    s_add_u32 m0, s46, 6144
    s_add_u32 s41, s37, 32
    buffer_load_dwordx4 v20, s[16:19], s41 offen  lds
    s_add_u32 m0, s46, 7168
    s_add_u32 s41, s37, 64
    buffer_load_dwordx4 v20, s[16:19], s41 offen  lds
    s_add_u32 m0, s46, 8192
    s_add_u32 s41, s37, 96
    buffer_load_dwordx4 v20, s[16:19], s41 offen  lds
    s_add_u32 m0, s46, 9216
    s_add_u32 s41, s37, 128
    buffer_load_dwordx4 v20, s[16:19], s41 offen  lds
Ljd_16:
    v_lshl_add_u32 v19, v16, 3, v17
    v_lshlrev_b32 v19, 5, v19
    v_add_u32 v19, s46, v19
    v_lshl_add_u32 v13, v18, 3, v19
    v_and_b32 v20, 1, v18
    v_lshl_add_u32 v19, v20, 4, v19
    v_lshrrev_b32 v20, 1, v18
    v_lshl_add_u32 v12, v20, 10, v19
    s_waitcnt vmcnt(0)
    s_cmp_lt_u32 s44, 640
    s_cbranch_scc0 Lfod_19
    ds_read_b64_tr_b16 v[176:177], v12 offset:0
    ds_read_b64_tr_b16 v[178:179], v12 offset:128
    ds_read_b64_tr_b16 v[180:181], v12 offset:8
    ds_read_b64_tr_b16 v[182:183], v12 offset:136
    ds_read_b64_tr_b16 v[184:185], v12 offset:2048
    ds_read_b64_tr_b16 v[186:187], v12 offset:2176
    ds_read_b64_tr_b16 v[188:189], v12 offset:2056
    ds_read_b64_tr_b16 v[190:191], v12 offset:2184
    ds_read_b64_tr_b16 v[192:193], v12 offset:4096
    ds_read_b64_tr_b16 v[194:195], v12 offset:4224
    ds_read_b64_tr_b16 v[196:197], v12 offset:4104
    ds_read_b64_tr_b16 v[198:199], v12 offset:4232
    s_branch Lfd_20
Lfod_19:
    ds_read_b64_tr_b16 v[176:177], v12 offset:0
    ds_read_b64_tr_b16 v[178:179], v12 offset:128
    ds_read_b64_tr_b16 v[180:181], v12 offset:8
    ds_read_b64_tr_b16 v[182:183], v12 offset:136
    ds_read_b64_tr_b16 v[184:185], v12 offset:2048
    ds_read_b64_tr_b16 v[186:187], v12 offset:2176
    ds_read_b64_tr_b16 v[188:189], v12 offset:2056
    ds_read_b64_tr_b16 v[190:191], v12 offset:2184
    ds_read_b64_tr_b16 v[192:193], v13 offset:4096
    ds_read_b64_tr_b16 v[194:195], v13 offset:4224
    s_waitcnt lgkmcnt(0)
    ds_read_b64_tr_b16 v[196:197], v12 offset:5120
    ds_read_b64_tr_b16 v[198:199], v12 offset:5248
    ds_read_b64_tr_b16 v[200:201], v12 offset:5128
    ds_read_b64_tr_b16 v[202:203], v12 offset:5256
    ds_read_b64_tr_b16 v[204:205], v12 offset:7168
    ds_read_b64_tr_b16 v[206:207], v12 offset:7296
    ds_read_b64_tr_b16 v[208:209], v12 offset:7176
    ds_read_b64_tr_b16 v[210:211], v12 offset:7304
    ds_read_b64_tr_b16 v[212:213], v13 offset:9216
    ds_read_b64_tr_b16 v[214:215], v13 offset:9344
Lfd_20:
    s_waitcnt lgkmcnt(0)
    v_mov_b32 v60, 132608
    v_mov_b32 v61, 0
    ds_write_b32 v60, v61
    s_waitcnt lgkmcnt(0)
    s_cmp_lg_u32 s22, 0
    s_cbranch_scc1 Lichk_21
    s_mov_b32 s16, s72
    s_mov_b32 s17, s73
    s_mov_b32 s18, 256
    s_mov_b32 s19, 0x20000
    v_mov_b32 v60, 0
    s_mov_b64 exec, 0x1
    s_mov_b32 s54, 262144
Lpoll_22:
    buffer_load_dword v61, v60, s[16:19], 0 offen sc1
    s_waitcnt vmcnt(0)
    v_cmp_le_u32 vcc, 16, v61
    s_sub_u32 s54, s54, 1
    s_cbranch_scc1 Lpdone_23
    s_cmp_eq_u64 vcc, exec
    s_cbranch_scc0 Lpoll_22
Lpdone_23:
    s_mov_b64 exec, -1
Lichk_21:
    s_barrier
    s_branch L1_join
L1_hc:
    s_lshr_b32 s22, s20, 3
    s_and_b32 s23, s20, 7
    s_lshl_b32 s24, s3, 6
    v_add_u32 v7, s24, v0
    s_mov_b32 s24, 2731
    v_mul_u32_u24 v1, s24, v7
    v_lshrrev_b32 v1, 16, v1
    v_mul_u32_u24 v2, 24, v1
    v_sub_u32 v2, v7, v2
    s_mul_i32 s25, s23, 384
    v_mul_u32_u24 v3, 3072, v1
    v_lshlrev_b32 v4, 4, v2
    v_add3_u32 v3, v3, v4, s25
    v_mov_b32 v4, 0x7fffffff
    v_cmp_gt_u32 vcc, 240, v7
    s_cmp_eq_u32 s22, 0
    s_cselect_b32 s8, s64, s66
    s_cselect_b32 s9, s65, s67
    s_mov_b32 s10, 1966080
    s_mov_b32 s11, 0x20000
    v_cndmask_b32 v3, v4, v3, vcc
    v_mov_b32 v8, 0
    v_mov_b32 v9, 0
    v_mov_b32 v10, 0
    v_mov_b32 v11, 0
    v_mov_b32 v12, 0
    v_mov_b32 v13, 0
    v_mov_b32 v14, 0
    v_mov_b32 v15, 0
    s_mov_b32 s26, 0
    buffer_load_dwordx4 v[32:35], v3, s[8:11], s26 offen
    s_add_u32 s26, s26, 30720
    buffer_load_dwordx4 v[36:39], v3, s[8:11], s26 offen
    s_add_u32 s26, s26, 30720
    buffer_load_dwordx4 v[40:43], v3, s[8:11], s26 offen
    s_add_u32 s26, s26, 30720
    buffer_load_dwordx4 v[44:47], v3, s[8:11], s26 offen
    s_add_u32 s26, s26, 30720
    buffer_load_dwordx4 v[48:51], v3, s[8:11], s26 offen
    s_add_u32 s26, s26, 30720
    buffer_load_dwordx4 v[52:55], v3, s[8:11], s26 offen
    s_add_u32 s26, s26, 30720
    buffer_load_dwordx4 v[56:59], v3, s[8:11], s26 offen
    s_add_u32 s26, s26, 30720
    buffer_load_dwordx4 v[60:63], v3, s[8:11], s26 offen
    s_add_u32 s26, s26, 30720
    buffer_load_dwordx4 v[64:67], v3, s[8:11], s26 offen
    s_add_u32 s26, s26, 30720
    buffer_load_dwordx4 v[68:71], v3, s[8:11], s26 offen
    s_add_u32 s26, s26, 30720
    buffer_load_dwordx4 v[72:75], v3, s[8:11], s26 offen
    s_add_u32 s26, s26, 30720
    buffer_load_dwordx4 v[76:79], v3, s[8:11], s26 offen
    s_add_u32 s26, s26, 30720
    buffer_load_dwordx4 v[80:83], v3, s[8:11], s26 offen
    s_add_u32 s26, s26, 30720
    buffer_load_dwordx4 v[84:87], v3, s[8:11], s26 offen
    s_add_u32 s26, s26, 30720
    buffer_load_dwordx4 v[88:91], v3, s[8:11], s26 offen
    s_add_u32 s26, s26, 30720
    buffer_load_dwordx4 v[92:95], v3, s[8:11], s26 offen
    s_add_u32 s26, s26, 30720
    s_mov_b32 s27, 3
Lhl_25:
    s_waitcnt vmcnt(15)
    v_lshlrev_b32 v16, 16, v32
    v_and_b32 v17, 0xffff0000, v32
    v_lshlrev_b32 v18, 16, v33
    v_and_b32 v19, 0xffff0000, v33
    v_lshlrev_b32 v20, 16, v34
    v_and_b32 v21, 0xffff0000, v34
    v_lshlrev_b32 v22, 16, v35
    v_and_b32 v23, 0xffff0000, v35
    v_pk_add_f32 v[8:9], v[8:9], v[16:17]
    v_pk_add_f32 v[10:11], v[10:11], v[18:19]
    v_pk_add_f32 v[12:13], v[12:13], v[20:21]
    v_pk_add_f32 v[14:15], v[14:15], v[22:23]
    buffer_load_dwordx4 v[32:35], v3, s[8:11], s26 offen
    s_add_u32 s26, s26, 30720
    s_waitcnt vmcnt(15)
    v_lshlrev_b32 v16, 16, v36
    v_and_b32 v17, 0xffff0000, v36
    v_lshlrev_b32 v18, 16, v37
    v_and_b32 v19, 0xffff0000, v37
    v_lshlrev_b32 v20, 16, v38
    v_and_b32 v21, 0xffff0000, v38
    v_lshlrev_b32 v22, 16, v39
    v_and_b32 v23, 0xffff0000, v39
    v_pk_add_f32 v[8:9], v[8:9], v[16:17]
    v_pk_add_f32 v[10:11], v[10:11], v[18:19]
    v_pk_add_f32 v[12:13], v[12:13], v[20:21]
    v_pk_add_f32 v[14:15], v[14:15], v[22:23]
    buffer_load_dwordx4 v[36:39], v3, s[8:11], s26 offen
    s_add_u32 s26, s26, 30720
    s_waitcnt vmcnt(15)
    v_lshlrev_b32 v16, 16, v40
    v_and_b32 v17, 0xffff0000, v40
    v_lshlrev_b32 v18, 16, v41
    v_and_b32 v19, 0xffff0000, v41
    v_lshlrev_b32 v20, 16, v42
    v_and_b32 v21, 0xffff0000, v42
    v_lshlrev_b32 v22, 16, v43
    v_and_b32 v23, 0xffff0000, v43
    v_pk_add_f32 v[8:9], v[8:9], v[16:17]
    v_pk_add_f32 v[10:11], v[10:11], v[18:19]
    v_pk_add_f32 v[12:13], v[12:13], v[20:21]
    v_pk_add_f32 v[14:15], v[14:15], v[22:23]
    buffer_load_dwordx4 v[40:43], v3, s[8:11], s26 offen
    s_add_u32 s26, s26, 30720
    s_waitcnt vmcnt(15)
    v_lshlrev_b32 v16, 16, v44
    v_and_b32 v17, 0xffff0000, v44
    v_lshlrev_b32 v18, 16, v45
    v_and_b32 v19, 0xffff0000, v45
    v_lshlrev_b32 v20, 16, v46
    v_and_b32 v21, 0xffff0000, v46
    v_lshlrev_b32 v22, 16, v47
    v_and_b32 v23, 0xffff0000, v47
    v_pk_add_f32 v[8:9], v[8:9], v[16:17]
    v_pk_add_f32 v[10:11], v[10:11], v[18:19]
    v_pk_add_f32 v[12:13], v[12:13], v[20:21]
    v_pk_add_f32 v[14:15], v[14:15], v[22:23]
    buffer_load_dwordx4 v[44:47], v3, s[8:11], s26 offen
    s_add_u32 s26, s26, 30720
    s_waitcnt vmcnt(15)
    v_lshlrev_b32 v16, 16, v48
    v_and_b32 v17, 0xffff0000, v48
    v_lshlrev_b32 v18, 16, v49
    v_and_b32 v19, 0xffff0000, v49
    v_lshlrev_b32 v20, 16, v50
    v_and_b32 v21, 0xffff0000, v50
    v_lshlrev_b32 v22, 16, v51
    v_and_b32 v23, 0xffff0000, v51
    v_pk_add_f32 v[8:9], v[8:9], v[16:17]
    v_pk_add_f32 v[10:11], v[10:11], v[18:19]
    v_pk_add_f32 v[12:13], v[12:13], v[20:21]
    v_pk_add_f32 v[14:15], v[14:15], v[22:23]
    buffer_load_dwordx4 v[48:51], v3, s[8:11], s26 offen
    s_add_u32 s26, s26, 30720
    s_waitcnt vmcnt(15)
    v_lshlrev_b32 v16, 16, v52
    v_and_b32 v17, 0xffff0000, v52
    v_lshlrev_b32 v18, 16, v53
    v_and_b32 v19, 0xffff0000, v53
    v_lshlrev_b32 v20, 16, v54
    v_and_b32 v21, 0xffff0000, v54
    v_lshlrev_b32 v22, 16, v55
    v_and_b32 v23, 0xffff0000, v55
    v_pk_add_f32 v[8:9], v[8:9], v[16:17]
    v_pk_add_f32 v[10:11], v[10:11], v[18:19]
    v_pk_add_f32 v[12:13], v[12:13], v[20:21]
    v_pk_add_f32 v[14:15], v[14:15], v[22:23]
    buffer_load_dwordx4 v[52:55], v3, s[8:11], s26 offen
    s_add_u32 s26, s26, 30720
    s_waitcnt vmcnt(15)
    v_lshlrev_b32 v16, 16, v56
    v_and_b32 v17, 0xffff0000, v56
    v_lshlrev_b32 v18, 16, v57
    v_and_b32 v19, 0xffff0000, v57
    v_lshlrev_b32 v20, 16, v58
    v_and_b32 v21, 0xffff0000, v58
    v_lshlrev_b32 v22, 16, v59
    v_and_b32 v23, 0xffff0000, v59
    v_pk_add_f32 v[8:9], v[8:9], v[16:17]
    v_pk_add_f32 v[10:11], v[10:11], v[18:19]
    v_pk_add_f32 v[12:13], v[12:13], v[20:21]
    v_pk_add_f32 v[14:15], v[14:15], v[22:23]
    buffer_load_dwordx4 v[56:59], v3, s[8:11], s26 offen
    s_add_u32 s26, s26, 30720
    s_waitcnt vmcnt(15)
    v_lshlrev_b32 v16, 16, v60
    v_and_b32 v17, 0xffff0000, v60
    v_lshlrev_b32 v18, 16, v61
    v_and_b32 v19, 0xffff0000, v61
    v_lshlrev_b32 v20, 16, v62
    v_and_b32 v21, 0xffff0000, v62
    v_lshlrev_b32 v22, 16, v63
    v_and_b32 v23, 0xffff0000, v63
    v_pk_add_f32 v[8:9], v[8:9], v[16:17]
    v_pk_add_f32 v[10:11], v[10:11], v[18:19]
    v_pk_add_f32 v[12:13], v[12:13], v[20:21]
    v_pk_add_f32 v[14:15], v[14:15], v[22:23]
    buffer_load_dwordx4 v[60:63], v3, s[8:11], s26 offen
    s_add_u32 s26, s26, 30720
    s_waitcnt vmcnt(15)
    v_lshlrev_b32 v16, 16, v64
    v_and_b32 v17, 0xffff0000, v64
    v_lshlrev_b32 v18, 16, v65
    v_and_b32 v19, 0xffff0000, v65
    v_lshlrev_b32 v20, 16, v66
    v_and_b32 v21, 0xffff0000, v66
    v_lshlrev_b32 v22, 16, v67
    v_and_b32 v23, 0xffff0000, v67
    v_pk_add_f32 v[8:9], v[8:9], v[16:17]
    v_pk_add_f32 v[10:11], v[10:11], v[18:19]
    v_pk_add_f32 v[12:13], v[12:13], v[20:21]
    v_pk_add_f32 v[14:15], v[14:15], v[22:23]
    buffer_load_dwordx4 v[64:67], v3, s[8:11], s26 offen
    s_add_u32 s26, s26, 30720
    s_waitcnt vmcnt(15)
    v_lshlrev_b32 v16, 16, v68
    v_and_b32 v17, 0xffff0000, v68
    v_lshlrev_b32 v18, 16, v69
    v_and_b32 v19, 0xffff0000, v69
    v_lshlrev_b32 v20, 16, v70
    v_and_b32 v21, 0xffff0000, v70
    v_lshlrev_b32 v22, 16, v71
    v_and_b32 v23, 0xffff0000, v71
    v_pk_add_f32 v[8:9], v[8:9], v[16:17]
    v_pk_add_f32 v[10:11], v[10:11], v[18:19]
    v_pk_add_f32 v[12:13], v[12:13], v[20:21]
    v_pk_add_f32 v[14:15], v[14:15], v[22:23]
    buffer_load_dwordx4 v[68:71], v3, s[8:11], s26 offen
    s_add_u32 s26, s26, 30720
    s_waitcnt vmcnt(15)
    v_lshlrev_b32 v16, 16, v72
    v_and_b32 v17, 0xffff0000, v72
    v_lshlrev_b32 v18, 16, v73
    v_and_b32 v19, 0xffff0000, v73
    v_lshlrev_b32 v20, 16, v74
    v_and_b32 v21, 0xffff0000, v74
    v_lshlrev_b32 v22, 16, v75
    v_and_b32 v23, 0xffff0000, v75
    v_pk_add_f32 v[8:9], v[8:9], v[16:17]
    v_pk_add_f32 v[10:11], v[10:11], v[18:19]
    v_pk_add_f32 v[12:13], v[12:13], v[20:21]
    v_pk_add_f32 v[14:15], v[14:15], v[22:23]
    buffer_load_dwordx4 v[72:75], v3, s[8:11], s26 offen
    s_add_u32 s26, s26, 30720
    s_waitcnt vmcnt(15)
    v_lshlrev_b32 v16, 16, v76
    v_and_b32 v17, 0xffff0000, v76
    v_lshlrev_b32 v18, 16, v77
    v_and_b32 v19, 0xffff0000, v77
    v_lshlrev_b32 v20, 16, v78
    v_and_b32 v21, 0xffff0000, v78
    v_lshlrev_b32 v22, 16, v79
    v_and_b32 v23, 0xffff0000, v79
    v_pk_add_f32 v[8:9], v[8:9], v[16:17]
    v_pk_add_f32 v[10:11], v[10:11], v[18:19]
    v_pk_add_f32 v[12:13], v[12:13], v[20:21]
    v_pk_add_f32 v[14:15], v[14:15], v[22:23]
    buffer_load_dwordx4 v[76:79], v3, s[8:11], s26 offen
    s_add_u32 s26, s26, 30720
    s_waitcnt vmcnt(15)
    v_lshlrev_b32 v16, 16, v80
    v_and_b32 v17, 0xffff0000, v80
    v_lshlrev_b32 v18, 16, v81
    v_and_b32 v19, 0xffff0000, v81
    v_lshlrev_b32 v20, 16, v82
    v_and_b32 v21, 0xffff0000, v82
    v_lshlrev_b32 v22, 16, v83
    v_and_b32 v23, 0xffff0000, v83
    v_pk_add_f32 v[8:9], v[8:9], v[16:17]
    v_pk_add_f32 v[10:11], v[10:11], v[18:19]
    v_pk_add_f32 v[12:13], v[12:13], v[20:21]
    v_pk_add_f32 v[14:15], v[14:15], v[22:23]
    buffer_load_dwordx4 v[80:83], v3, s[8:11], s26 offen
    s_add_u32 s26, s26, 30720
    s_waitcnt vmcnt(15)
    v_lshlrev_b32 v16, 16, v84
    v_and_b32 v17, 0xffff0000, v84
    v_lshlrev_b32 v18, 16, v85
    v_and_b32 v19, 0xffff0000, v85
    v_lshlrev_b32 v20, 16, v86
    v_and_b32 v21, 0xffff0000, v86
    v_lshlrev_b32 v22, 16, v87
    v_and_b32 v23, 0xffff0000, v87
    v_pk_add_f32 v[8:9], v[8:9], v[16:17]
    v_pk_add_f32 v[10:11], v[10:11], v[18:19]
    v_pk_add_f32 v[12:13], v[12:13], v[20:21]
    v_pk_add_f32 v[14:15], v[14:15], v[22:23]
    buffer_load_dwordx4 v[84:87], v3, s[8:11], s26 offen
    s_add_u32 s26, s26, 30720
    s_waitcnt vmcnt(15)
    v_lshlrev_b32 v16, 16, v88
    v_and_b32 v17, 0xffff0000, v88
    v_lshlrev_b32 v18, 16, v89
    v_and_b32 v19, 0xffff0000, v89
    v_lshlrev_b32 v20, 16, v90
    v_and_b32 v21, 0xffff0000, v90
    v_lshlrev_b32 v22, 16, v91
    v_and_b32 v23, 0xffff0000, v91
    v_pk_add_f32 v[8:9], v[8:9], v[16:17]
    v_pk_add_f32 v[10:11], v[10:11], v[18:19]
    v_pk_add_f32 v[12:13], v[12:13], v[20:21]
    v_pk_add_f32 v[14:15], v[14:15], v[22:23]
    buffer_load_dwordx4 v[88:91], v3, s[8:11], s26 offen
    s_add_u32 s26, s26, 30720
    s_waitcnt vmcnt(15)
    v_lshlrev_b32 v16, 16, v92
    v_and_b32 v17, 0xffff0000, v92
    v_lshlrev_b32 v18, 16, v93
    v_and_b32 v19, 0xffff0000, v93
    v_lshlrev_b32 v20, 16, v94
    v_and_b32 v21, 0xffff0000, v94
    v_lshlrev_b32 v22, 16, v95
    v_and_b32 v23, 0xffff0000, v95
    v_pk_add_f32 v[8:9], v[8:9], v[16:17]
    v_pk_add_f32 v[10:11], v[10:11], v[18:19]
    v_pk_add_f32 v[12:13], v[12:13], v[20:21]
    v_pk_add_f32 v[14:15], v[14:15], v[22:23]
    buffer_load_dwordx4 v[92:95], v3, s[8:11], s26 offen
    s_add_u32 s26, s26, 30720
    s_sub_u32 s27, s27, 1
    s_cmp_lg_u32 s27, 0
    s_cbranch_scc1 Lhl_25
    s_waitcnt vmcnt(15)
    v_lshlrev_b32 v16, 16, v32
    v_and_b32 v17, 0xffff0000, v32
    v_lshlrev_b32 v18, 16, v33
    v_and_b32 v19, 0xffff0000, v33
    v_lshlrev_b32 v20, 16, v34
    v_and_b32 v21, 0xffff0000, v34
    v_lshlrev_b32 v22, 16, v35
    v_and_b32 v23, 0xffff0000, v35
    v_pk_add_f32 v[8:9], v[8:9], v[16:17]
    v_pk_add_f32 v[10:11], v[10:11], v[18:19]
    v_pk_add_f32 v[12:13], v[12:13], v[20:21]
    v_pk_add_f32 v[14:15], v[14:15], v[22:23]
    s_waitcnt vmcnt(14)
    v_lshlrev_b32 v16, 16, v36
    v_and_b32 v17, 0xffff0000, v36
    v_lshlrev_b32 v18, 16, v37
    v_and_b32 v19, 0xffff0000, v37
    v_lshlrev_b32 v20, 16, v38
    v_and_b32 v21, 0xffff0000, v38
    v_lshlrev_b32 v22, 16, v39
    v_and_b32 v23, 0xffff0000, v39
    v_pk_add_f32 v[8:9], v[8:9], v[16:17]
    v_pk_add_f32 v[10:11], v[10:11], v[18:19]
    v_pk_add_f32 v[12:13], v[12:13], v[20:21]
    v_pk_add_f32 v[14:15], v[14:15], v[22:23]
    s_waitcnt vmcnt(13)
    v_lshlrev_b32 v16, 16, v40
    v_and_b32 v17, 0xffff0000, v40
    v_lshlrev_b32 v18, 16, v41
    v_and_b32 v19, 0xffff0000, v41
    v_lshlrev_b32 v20, 16, v42
    v_and_b32 v21, 0xffff0000, v42
    v_lshlrev_b32 v22, 16, v43
    v_and_b32 v23, 0xffff0000, v43
    v_pk_add_f32 v[8:9], v[8:9], v[16:17]
    v_pk_add_f32 v[10:11], v[10:11], v[18:19]
    v_pk_add_f32 v[12:13], v[12:13], v[20:21]
    v_pk_add_f32 v[14:15], v[14:15], v[22:23]
    s_waitcnt vmcnt(12)
    v_lshlrev_b32 v16, 16, v44
    v_and_b32 v17, 0xffff0000, v44
    v_lshlrev_b32 v18, 16, v45
    v_and_b32 v19, 0xffff0000, v45
    v_lshlrev_b32 v20, 16, v46
    v_and_b32 v21, 0xffff0000, v46
    v_lshlrev_b32 v22, 16, v47
    v_and_b32 v23, 0xffff0000, v47
    v_pk_add_f32 v[8:9], v[8:9], v[16:17]
    v_pk_add_f32 v[10:11], v[10:11], v[18:19]
    v_pk_add_f32 v[12:13], v[12:13], v[20:21]
    v_pk_add_f32 v[14:15], v[14:15], v[22:23]
    s_waitcnt vmcnt(11)
    v_lshlrev_b32 v16, 16, v48
    v_and_b32 v17, 0xffff0000, v48
    v_lshlrev_b32 v18, 16, v49
    v_and_b32 v19, 0xffff0000, v49
    v_lshlrev_b32 v20, 16, v50
    v_and_b32 v21, 0xffff0000, v50
    v_lshlrev_b32 v22, 16, v51
    v_and_b32 v23, 0xffff0000, v51
    v_pk_add_f32 v[8:9], v[8:9], v[16:17]
    v_pk_add_f32 v[10:11], v[10:11], v[18:19]
    v_pk_add_f32 v[12:13], v[12:13], v[20:21]
    v_pk_add_f32 v[14:15], v[14:15], v[22:23]
    s_waitcnt vmcnt(10)
    v_lshlrev_b32 v16, 16, v52
    v_and_b32 v17, 0xffff0000, v52
    v_lshlrev_b32 v18, 16, v53
    v_and_b32 v19, 0xffff0000, v53
    v_lshlrev_b32 v20, 16, v54
    v_and_b32 v21, 0xffff0000, v54
    v_lshlrev_b32 v22, 16, v55
    v_and_b32 v23, 0xffff0000, v55
    v_pk_add_f32 v[8:9], v[8:9], v[16:17]
    v_pk_add_f32 v[10:11], v[10:11], v[18:19]
    v_pk_add_f32 v[12:13], v[12:13], v[20:21]
    v_pk_add_f32 v[14:15], v[14:15], v[22:23]
    s_waitcnt vmcnt(9)
    v_lshlrev_b32 v16, 16, v56
    v_and_b32 v17, 0xffff0000, v56
    v_lshlrev_b32 v18, 16, v57
    v_and_b32 v19, 0xffff0000, v57
    v_lshlrev_b32 v20, 16, v58
    v_and_b32 v21, 0xffff0000, v58
    v_lshlrev_b32 v22, 16, v59
    v_and_b32 v23, 0xffff0000, v59
    v_pk_add_f32 v[8:9], v[8:9], v[16:17]
    v_pk_add_f32 v[10:11], v[10:11], v[18:19]
    v_pk_add_f32 v[12:13], v[12:13], v[20:21]
    v_pk_add_f32 v[14:15], v[14:15], v[22:23]
    s_waitcnt vmcnt(8)
    v_lshlrev_b32 v16, 16, v60
    v_and_b32 v17, 0xffff0000, v60
    v_lshlrev_b32 v18, 16, v61
    v_and_b32 v19, 0xffff0000, v61
    v_lshlrev_b32 v20, 16, v62
    v_and_b32 v21, 0xffff0000, v62
    v_lshlrev_b32 v22, 16, v63
    v_and_b32 v23, 0xffff0000, v63
    v_pk_add_f32 v[8:9], v[8:9], v[16:17]
    v_pk_add_f32 v[10:11], v[10:11], v[18:19]
    v_pk_add_f32 v[12:13], v[12:13], v[20:21]
    v_pk_add_f32 v[14:15], v[14:15], v[22:23]
    s_waitcnt vmcnt(7)
    v_lshlrev_b32 v16, 16, v64
    v_and_b32 v17, 0xffff0000, v64
    v_lshlrev_b32 v18, 16, v65
    v_and_b32 v19, 0xffff0000, v65
    v_lshlrev_b32 v20, 16, v66
    v_and_b32 v21, 0xffff0000, v66
    v_lshlrev_b32 v22, 16, v67
    v_and_b32 v23, 0xffff0000, v67
    v_pk_add_f32 v[8:9], v[8:9], v[16:17]
    v_pk_add_f32 v[10:11], v[10:11], v[18:19]
    v_pk_add_f32 v[12:13], v[12:13], v[20:21]
    v_pk_add_f32 v[14:15], v[14:15], v[22:23]
    s_waitcnt vmcnt(6)
    v_lshlrev_b32 v16, 16, v68
    v_and_b32 v17, 0xffff0000, v68
    v_lshlrev_b32 v18, 16, v69
    v_and_b32 v19, 0xffff0000, v69
    v_lshlrev_b32 v20, 16, v70
    v_and_b32 v21, 0xffff0000, v70
    v_lshlrev_b32 v22, 16, v71
    v_and_b32 v23, 0xffff0000, v71
    v_pk_add_f32 v[8:9], v[8:9], v[16:17]
    v_pk_add_f32 v[10:11], v[10:11], v[18:19]
    v_pk_add_f32 v[12:13], v[12:13], v[20:21]
    v_pk_add_f32 v[14:15], v[14:15], v[22:23]
    s_waitcnt vmcnt(5)
    v_lshlrev_b32 v16, 16, v72
    v_and_b32 v17, 0xffff0000, v72
    v_lshlrev_b32 v18, 16, v73
    v_and_b32 v19, 0xffff0000, v73
    v_lshlrev_b32 v20, 16, v74
    v_and_b32 v21, 0xffff0000, v74
    v_lshlrev_b32 v22, 16, v75
    v_and_b32 v23, 0xffff0000, v75
    v_pk_add_f32 v[8:9], v[8:9], v[16:17]
    v_pk_add_f32 v[10:11], v[10:11], v[18:19]
    v_pk_add_f32 v[12:13], v[12:13], v[20:21]
    v_pk_add_f32 v[14:15], v[14:15], v[22:23]
    s_waitcnt vmcnt(4)
    v_lshlrev_b32 v16, 16, v76
    v_and_b32 v17, 0xffff0000, v76
    v_lshlrev_b32 v18, 16, v77
    v_and_b32 v19, 0xffff0000, v77
    v_lshlrev_b32 v20, 16, v78
    v_and_b32 v21, 0xffff0000, v78
    v_lshlrev_b32 v22, 16, v79
    v_and_b32 v23, 0xffff0000, v79
    v_pk_add_f32 v[8:9], v[8:9], v[16:17]
    v_pk_add_f32 v[10:11], v[10:11], v[18:19]
    v_pk_add_f32 v[12:13], v[12:13], v[20:21]
    v_pk_add_f32 v[14:15], v[14:15], v[22:23]
    s_waitcnt vmcnt(3)
    v_lshlrev_b32 v16, 16, v80
    v_and_b32 v17, 0xffff0000, v80
    v_lshlrev_b32 v18, 16, v81
    v_and_b32 v19, 0xffff0000, v81
    v_lshlrev_b32 v20, 16, v82
    v_and_b32 v21, 0xffff0000, v82
    v_lshlrev_b32 v22, 16, v83
    v_and_b32 v23, 0xffff0000, v83
    v_pk_add_f32 v[8:9], v[8:9], v[16:17]
    v_pk_add_f32 v[10:11], v[10:11], v[18:19]
    v_pk_add_f32 v[12:13], v[12:13], v[20:21]
    v_pk_add_f32 v[14:15], v[14:15], v[22:23]
    s_waitcnt vmcnt(2)
    v_lshlrev_b32 v16, 16, v84
    v_and_b32 v17, 0xffff0000, v84
    v_lshlrev_b32 v18, 16, v85
    v_and_b32 v19, 0xffff0000, v85
    v_lshlrev_b32 v20, 16, v86
    v_and_b32 v21, 0xffff0000, v86
    v_lshlrev_b32 v22, 16, v87
    v_and_b32 v23, 0xffff0000, v87
    v_pk_add_f32 v[8:9], v[8:9], v[16:17]
    v_pk_add_f32 v[10:11], v[10:11], v[18:19]
    v_pk_add_f32 v[12:13], v[12:13], v[20:21]
    v_pk_add_f32 v[14:15], v[14:15], v[22:23]
    s_waitcnt vmcnt(1)
    v_lshlrev_b32 v16, 16, v88
    v_and_b32 v17, 0xffff0000, v88
    v_lshlrev_b32 v18, 16, v89
    v_and_b32 v19, 0xffff0000, v89
    v_lshlrev_b32 v20, 16, v90
    v_and_b32 v21, 0xffff0000, v90
    v_lshlrev_b32 v22, 16, v91
    v_and_b32 v23, 0xffff0000, v91
    v_pk_add_f32 v[8:9], v[8:9], v[16:17]
    v_pk_add_f32 v[10:11], v[10:11], v[18:19]
    v_pk_add_f32 v[12:13], v[12:13], v[20:21]
    v_pk_add_f32 v[14:15], v[14:15], v[22:23]
    s_waitcnt vmcnt(0)
    v_lshlrev_b32 v16, 16, v92
    v_and_b32 v17, 0xffff0000, v92
    v_lshlrev_b32 v18, 16, v93
    v_and_b32 v19, 0xffff0000, v93
    v_lshlrev_b32 v20, 16, v94
    v_and_b32 v21, 0xffff0000, v94
    v_lshlrev_b32 v22, 16, v95
    v_and_b32 v23, 0xffff0000, v95
    v_pk_add_f32 v[8:9], v[8:9], v[16:17]
    v_pk_add_f32 v[10:11], v[10:11], v[18:19]
    v_pk_add_f32 v[12:13], v[12:13], v[20:21]
    v_pk_add_f32 v[14:15], v[14:15], v[22:23]
    v_mul_u32_u24 v4, 768, v1
    v_lshlrev_b32 v5, 5, v2
    v_add_u32 v4, v4, v5
    ds_write_b128 v4, v[8:11]
    ds_write_b128 v4, v[12:15] offset:16
    v_lshlrev_b32 v5, 2, v7
    s_waitcnt lgkmcnt(0)
    s_barrier
    ds_read_b32 v16, v5 offset:0
    ds_read_b32 v17, v5 offset:768
    ds_read_b32 v18, v5 offset:1536
    ds_read_b32 v19, v5 offset:2304
    ds_read_b32 v20, v5 offset:3072
    ds_read_b32 v21, v5 offset:3840
    ds_read_b32 v22, v5 offset:4608
    ds_read_b32 v23, v5 offset:5376
    ds_read_b32 v24, v5 offset:6144
    ds_read_b32 v25, v5 offset:6912
    s_mul_i32 s25, s22, 6144
    s_mul_i32 s26, s23, 768
    s_add_u32 s25, s25, s26
    s_add_u32 s25, s25, 26247168
    v_mov_b32 v4, 0x7fffffff
    v_cmp_gt_u32 vcc, 192, v7
    s_waitcnt lgkmcnt(0)
    v_add_f32 v16, v16, v17
    v_add_f32 v16, v16, v18
    v_add_f32 v16, v16, v19
    v_add_f32 v16, v16, v20
    v_add_f32 v16, v16, v21
    v_add_f32 v16, v16, v22
    v_add_f32 v16, v16, v23
    v_add_f32 v16, v16, v24
    v_add_f32 v16, v16, v25
    v_cndmask_b32 v5, v4, v5, vcc
    buffer_store_dword v16, v5, s[76:79], s25 offen sc1
L1_join:
    s_mul_hi_u32 s32, s21, 858993460
    s_mul_i32 s33, s32, 5
    s_sub_u32 s33, s21, s33
    s_lshl_b32 s33, s33, 5
    s_mul_hi_u32 s34, s33, 858993460
    s_add_u32 s33, s33, 31
    s_mul_hi_u32 s35, s33, 858993460
    s_sub_u32 s35, s35, s34
    s_add_u32 s35, s35, 1
    s_lshl_b32 s32, s32, 5
    s_add_u32 s47, s32, s34
    s_cmp_eq_u32 s21, 15
    s_cselect_b32 s47, 128, s47
    s_cselect_b32 s35, 1, s35
    s_bfm_b64 s[48:49], s35, 0
    s_and_b32 s36, s2, 7
    s_lshl_b32 s36, s36, 2
    s_bfe_u32 s37, s2, 0x20003
    s_add_u32 s27, s36, s37
    s_lshr_b32 s28, s2, 5
    s_and_b32 s25, s3, 3
    s_lshr_b32 s26, s3, 2
    v_and_b32 v1, 31, v0
    v_lshrrev_b32 v2, 5, v0
    v_lshlrev_b32 v152, 4, v0
    v_lshlrev_b32 v153, 3, v1
    v_lshl_add_u32 v153, v2, 2, v153
    s_mul_i32 s36, s27, 163840
    s_add_u32 s36, s36, 2621440
    s_add_u32 s8, s74, s36
    s_addc_u32 s9, s75, 0
    s_mov_b32 s10, 163840
    s_mov_b32 s11, 0x20000
    s_lshl_b32 s38, s28, 3
    s_lshl_b32 s39, s25, 1
    s_add_u32 s38, s38, s39
    s_add_u32 s14, s38, s26
    s_xor_b32 s37, s14, 1
    s_mul_i32 s39, s27, 81920
    s_mul_i32 s12, s14, 1280
    s_mul_i32 s13, s37, 1280
    s_add_u32 s12, s12, s39
    s_add_u32 s13, s13, s39
    s_mul_i32 s15, s26, 81920
    s_lshl_b32 s37, s25, 10
    s_add_u32 s16, s15, s37
    v_add_u32 v4, s15, v152
    v_add_u32 v5, 1024, v153
    v_add_u32 v5, s15, v5
    v_lshrrev_b32 v6, 4, v1
    v_xor_b32 v6, v6, v2
    v_lshl_add_u32 v6, v1, 1, v6
    v_lshlrev_b32 v6, 4, v6
    v_add_u32 v6, 1280, v6
    v_add_u32 v6, s15, v6
    s_mul_i32 s17, s28, 0
    s_add_u32 s17, s17, s16
    s_add_u32 s4, s15, 81920
    v_mov_b32 v7, 0xdddd
    s_mov_b32 s30, 0xfffff
    s_mov_b32 s31, 0xfffff
    v_cmp_eq_u32 vcc, 20, v1
    v_mov_b32 v10, 0x3f803f80
    v_mov_b32 v121, 0
    v_mov_b32 v123, 0
    v_cndmask_b32 v136, 0, v10, vcc
    v_cndmask_b32 v137, 0, v10, vcc
    v_cndmask_b32 v138, 0, v10, vcc
    v_cndmask_b32 v139, 0, v10, vcc
    v_cndmask_b32 v140, 0, v10, vcc
    v_cndmask_b32 v141, 0, v10, vcc
    v_cndmask_b32 v142, 0, v10, vcc
    v_cndmask_b32 v143, 0, v10, vcc
    v_cndmask_b32 v144, 0, v10, vcc
    v_cndmask_b32 v145, 0, v10, vcc
    v_cndmask_b32 v146, 0, v10, vcc
    v_cndmask_b32 v147, 0, v10, vcc
    v_cndmask_b32 v148, 0, v10, vcc
    v_cndmask_b32 v149, 0, v10, vcc
    v_cndmask_b32 v150, 0, v10, vcc
    v_cndmask_b32 v151, 0, v10, vcc
    v_cmp_eq_u32 s[18:19], 0, v2
    v_mov_b32 v10, 0x3f80
    v_and_b32 v11, 0x13, v0
    v_cndmask_b32 v133, 0, v10, s[18:19]
    v_cndmask_b32 v135, 0, v10, s[18:19]
    v_bfe_u32 v12, v0, 2, 1
    v_lshl_or_b32 v11, v12, 3, v11
    v_bfe_u32 v12, v0, 3, 1
    v_lshl_or_b32 v11, v12, 2, v11
    s_lshl_b32 s36, s14, 5
    v_add_u32 v11, s36, v11
    s_lshl_b32 s36, s27, 14
    s_add_u32 s36, s36, 9961472
    v_lshlrev_b32 v9, 3, v11
    v_add_u32 v9, s36, v9
    v_lshrrev_b32 v12, 4, v11
    v_lshlrev_b32 v12, 14, v12
    v_and_b32 v11, 15, v11
    v_lshl_add_u32 v12, v11, 4, v12
    v_lshl_add_u32 v12, v2, 8, v12
    s_lshl_b32 s36, s27, 9
    s_add_u32 s36, s36, 7864320
    v_add_u32 v8, s36, v12
    v_mov_b32 v80, 0
    v_mov_b32 v81, 0
    v_mov_b32 v82, 0
    v_mov_b32 v83, 0
    v_mov_b32 v84, 0
    v_mov_b32 v85, 0
    v_mov_b32 v86, 0
    v_mov_b32 v87, 0
    v_mov_b32 v88, 0
    v_mov_b32 v89, 0
    v_mov_b32 v90, 0
    v_mov_b32 v91, 0
    v_mov_b32 v92, 0
    v_mov_b32 v93, 0
    v_mov_b32 v94, 0
    v_mov_b32 v95, 0
    v_mov_b32 v96, 0
    v_mov_b32 v97, 0
    v_mov_b32 v98, 0
    v_mov_b32 v99, 0
    v_mov_b32 v100, 0
    v_mov_b32 v101, 0
    v_mov_b32 v102, 0
    v_mov_b32 v103, 0
    v_mov_b32 v104, 0
    v_mov_b32 v105, 0
    v_mov_b32 v106, 0
    v_mov_b32 v107, 0
    v_mov_b32 v108, 0
    v_mov_b32 v109, 0
    v_mov_b32 v110, 0
    v_mov_b32 v111, 0
    s_mul_i32 s36, s25, 3072
    v_lshrrev_b32 v12, 2, v152
    s_lshl_b32 s38, s25, 8
    s_add_u32 s39, s38, 145408
    s_sub_u32 s39, s39, s15
    s_add_u32 s38, s38, 63488
    s_add_u32 s38, s38, s15
    v_add_u32 v13, s39, v12
    v_add_u32 v12, s38, v12
    s_add_u32 s37, s36, 81920
    s_sub_u32 s37, s37, s15
    s_add_u32 s36, s36, s15
    v_add_u32 v10, s36, v152
    v_add_u32 v11, s37, v152
    v_add_u32 v154, 96, v0
    v_lshlrev_b32 v154, 7, v154
    v_add_u32 v154, 26279936, v154
    v_mov_b32 v172, -1
    v_mov_b32 v173, -1
    v_mov_b32 v174, -1
    v_mov_b32 v175, -1
    s_lshl_b32 s40, s2, 2
    s_add_u32 s40, s40, s25
    s_mul_i32 s40, s40, 11392
    s_lshl_b32 s36, s26, 13
    s_add_u32 s40, s40, s36
    s_mov_b32 s6, -1
    s_mov_b32 s7, 1
    s_and_b32 s32, s2, 7
    s_bfe_u32 s33, s2, 0x20003
    s_lshr_b32 s21, s2, 5
    s_lshl_b32 s34, s32, 2
    s_add_u32 s20, s34, s33
    s_lshr_b32 s34, s32, 1
    s_lshl_b32 s34, s34, 2
    s_add_u32 s22, s34, s33
    s_and_b32 s34, s32, 1
    s_lshl_b32 s34, s34, 3
    s_add_u32 s23, s34, s21
    s_and_b32 s24, s3, 3
    s_lshl_b32 s32, s20, 2
    s_add_u32 s32, s32, s24
    v_and_b32 v223, 15, v0
    v_lshrrev_b32 v224, 4, v0
    s_lshl_b32 s33, s32, 4
    v_add_u32 v216, s33, v223
    v_mul_u32_u24 v225, 1280, v216
    s_mul_i32 s33, s21, 160
    v_add_u32 v225, s33, v225
    v_lshl_add_u32 v217, v224, 4, v225
    v_lshl_add_u32 v218, v224, 3, v225
    s_mul_i32 s33, s32, 20480
    s_mul_i32 s34, s21, 2560
    s_add_u32 s33, s33, s34
    s_add_u32 s33, s33, 10485760
    v_lshlrev_b32 v225, 4, v223
    v_add_u32 v225, s33, v225
    v_lshl_add_u32 v219, v224, 8, v225
    v_lshrrev_b32 v220, 1, v224
    v_lshl_add_u32 v220, v220, 8, v225
    v_and_b32 v225, 1, v224
    v_lshl_add_u32 v220, v225, 3, v220
    v_lshlrev_b32 v221, 3, v216
    v_lshl_add_u32 v221, v224, 15, v221
    v_and_b32 v222, 31, v0
    v_lshlrev_b32 v222, 14, v222
    v_lshrrev_b32 v223, 5, v0
    v_lshl_add_u32 v222, v223, 8, v222
    s_lshl_b32 s33, s20, 9
    s_add_u32 s33, s33, 9961472
    v_add_u32 v222, s33, v222
    s_cmp_lt_u32 s3, 4
    s_cbranch_scc0 Ls3_26
    s_mov_b32 s52, s56
    s_mov_b32 s53, s57
    s_mov_b32 s54, 2621440
    s_mov_b32 s55, 0x20000
    buffer_load_dwordx4 v[228:231], v217, s[52:55], 0 offen offset:0
    buffer_load_dwordx4 v[232:235], v217, s[52:55], 0 offen offset:64
    buffer_load_dwordx2 v[236:237], v218, s[52:55], 0 offen offset:128
Ls3_26:
    s_cmp_lt_u32 s3, 4
    s_cbranch_scc0 Lnosig_27
    v_add_u32 v250, s47, v0
    v_lshlrev_b32 v250, 7, v250
    v_add_u32 v250, 26279936, v250
    v_mov_b32 v251, 132608
    v_mov_b32 v252, 1
    s_waitcnt vmcnt(0)
    s_mov_b64 exec, 1
    ds_add_rtn_u32 v252, v251, v252
    s_waitcnt lgkmcnt(0)
    v_readfirstlane_b32 s55, v252
    s_mov_b64 exec, -1
    s_cmp_lg_u32 s55, 3
    s_cbranch_scc1 Lnotlast_28
    v_mov_b32 v251, 1
    s_mov_b64 exec, s[48:49]
    buffer_atomic_add v251, v250, s[76:79], 0 offen sc1
    s_mov_b64 exec, -1
Lnotlast_28:
Lnosig_27:
    s_cmp_lg_u32 s3, 7
    s_cbranch_scc1 Lw1_29
    s_mul_i32 s36, s27, 5
    s_add_u32 s37, s36, 4
    s_lshr_b32 s36, s36, 5
    s_lshr_b32 s37, s37, 5
    s_sub_u32 s36, s37, s36
    s_add_u32 s36, s36, 1
    s_lshl_b32 s36, s36, 4
    v_lshlrev_b32 v156, 5, v0
    v_add_u32 v156, s27, v156
    v_lshlrev_b32 v156, 7, v156
    v_add_u32 v156, 26279936, v156
    s_mov_b64 exec, 0x7
    s_mov_b32 s54, 262144
Lpoll_30:
    buffer_load_dword v157, v156, s[76:79], 0 offen sc1
    s_waitcnt vmcnt(0)
    v_cmp_le_u32 vcc, s36, v157
    s_sub_u32 s54, s54, 1
    s_cbranch_scc1 Lpdone_31
    s_cmp_eq_u64 vcc, exec
    s_cbranch_scc0 Lpoll_30
Lpdone_31:
    s_mov_b64 exec, -1
Lw1_29:
    s_barrier
    buffer_load_dwordx4 v[112:115], v152, s[76:79], s12 offen sc1
    buffer_load_dwordx4 v[116:119], v152, s[76:79], s13 offen sc1
    s_add_u32 m0, s16, 0
    s_nop 0
    buffer_load_dwordx4 v152, s[8:11], s17 offen sc1 lds
    buffer_load_dword v120, v153, s[76:79], s12 offen offset:1024 sc1
    buffer_load_dword v122, v153, s[76:79], s13 offen offset:1024 sc1
    s_add_u32 m0, s16, 4096
    s_add_u32 s17, s17, 4096
    s_cmp_ge_u32 s17, s4
    s_cselect_b32 s5, 81920, 0
    s_sub_u32 s17, s17, s5
    buffer_load_dwordx4 v152, s[8:11], s17 offen sc1 lds
    s_waitcnt vmcnt(1)
    s_barrier
    ds_read_b128 v[124:127], v4 offset:0
    ds_read_b32 v132, v5 offset:0
    ds_read_b128 v[128:131], v4 offset:2560
    ds_read_b32 v134, v5 offset:2560
    s_mov_b64 exec, s[30:31]
    ds_read_b128 v[136:139], v6 offset:0
    ds_read_b128 v[140:143], v6 offset:640
    s_mov_b64 exec, -1
    s_add_u32 m0, s16, 8192
    s_add_u32 s17, s17, 4096
    s_cmp_ge_u32 s17, s4
    s_cselect_b32 s5, 81920, 0
    s_sub_u32 s17, s17, s5
    buffer_load_dwordx4 v152, s[8:11], s17 offen sc1 lds
    s_waitcnt lgkmcnt(4)
    v_mfma_f32_32x32x16_bf16 v[16:31], v[124:127], v[112:115], 0
    v_mfma_f32_32x32x16_bf16 v[48:63], v[124:127], v[116:119], 0
    v_mfma_f32_32x32x8_bf16 v[16:31], v[132:133], v[120:121], v[16:31]
    v_mfma_f32_32x32x8_bf16 v[48:63], v[132:133], v[122:123], v[48:63]
    s_add_u32 m0, s16, 12288
    s_add_u32 s17, s17, 4096
    s_cmp_ge_u32 s17, s4
    s_cselect_b32 s5, 81920, 0
    s_sub_u32 s17, s17, s5
    buffer_load_dwordx4 v152, s[8:11], s17 offen sc1 lds
    s_add_u32 m0, s16, 16384
    s_add_u32 s17, s17, 4096
    s_cmp_ge_u32 s17, s4
    s_cselect_b32 s5, 81920, 0
    s_sub_u32 s17, s17, s5
    buffer_load_dwordx4 v152, s[8:11], s17 offen sc1 lds
    v_max3_f32 v156, v16, v17, v18
    v_max3_f32 v162, v48, v49, v50
    v_max3_f32 v157, v19, v20, v21
    v_max3_f32 v163, v51, v52, v53
    v_max3_f32 v158, v22, v23, v24
    v_max3_f32 v164, v54, v55, v56
    v_max3_f32 v159, v25, v26, v27
    v_max3_f32 v165, v57, v58, v59
    v_max3_f32 v160, v28, v29, v30
    v_max3_f32 v166, v60, v61, v62
    v_max3_f32 v156, v156, v157, v158
    v_max3_f32 v159, v159, v160, v31
    v_max3_f32 v162, v162, v163, v164
    v_max3_f32 v165, v165, v166, v63
    v_max_f32 v156, v156, v159
    v_max_f32 v162, v162, v165
    v_mov_b32 v157, v156
    v_mov_b32 v163, v162
    s_nop 0
    v_permlane32_swap_b32 v156, v157
    v_permlane32_swap_b32 v162, v163
    v_max_f32 v156, v156, v157
    v_max_f32 v162, v162, v163
    v_cvt_pk_bf16_f32 v156, -v156, 0
    v_cvt_pk_bf16_f32 v162, -v162, 0
    v_lshlrev_b32 v170, 16, v156
    v_lshlrev_b32 v171, 16, v162
    v_cndmask_b32 v121, 0, v156, s[18:19]
    v_cndmask_b32 v123, 0, v162, s[18:19]
    v_pk_add_f32 v[16:17], v[16:17], v[170:171] op_sel:[0,0] op_sel_hi:[1,0]
    v_pk_add_f32 v[18:19], v[18:19], v[170:171] op_sel:[0,0] op_sel_hi:[1,0]
    v_pk_add_f32 v[20:21], v[20:21], v[170:171] op_sel:[0,0] op_sel_hi:[1,0]
    v_pk_add_f32 v[22:23], v[22:23], v[170:171] op_sel:[0,0] op_sel_hi:[1,0]
    v_pk_add_f32 v[24:25], v[24:25], v[170:171] op_sel:[0,0] op_sel_hi:[1,0]
    v_pk_add_f32 v[26:27], v[26:27], v[170:171] op_sel:[0,0] op_sel_hi:[1,0]
    v_pk_add_f32 v[28:29], v[28:29], v[170:171] op_sel:[0,0] op_sel_hi:[1,0]
    v_pk_add_f32 v[30:31], v[30:31], v[170:171] op_sel:[0,0] op_sel_hi:[1,0]
    v_pk_add_f32 v[48:49], v[48:49], v[170:171] op_sel:[0,1] op_sel_hi:[1,1]
    v_pk_add_f32 v[50:51], v[50:51], v[170:171] op_sel:[0,1] op_sel_hi:[1,1]
    v_pk_add_f32 v[52:53], v[52:53], v[170:171] op_sel:[0,1] op_sel_hi:[1,1]
    v_pk_add_f32 v[54:55], v[54:55], v[170:171] op_sel:[0,1] op_sel_hi:[1,1]
    v_pk_add_f32 v[56:57], v[56:57], v[170:171] op_sel:[0,1] op_sel_hi:[1,1]
    v_pk_add_f32 v[58:59], v[58:59], v[170:171] op_sel:[0,1] op_sel_hi:[1,1]
    v_pk_add_f32 v[60:61], v[60:61], v[170:171] op_sel:[0,1] op_sel_hi:[1,1]
    v_pk_add_f32 v[62:63], v[62:63], v[170:171] op_sel:[0,1] op_sel_hi:[1,1]
    s_add_u32 m0, s16, 20480
    s_add_u32 s17, s17, 4096
    s_cmp_ge_u32 s17, s4
    s_cselect_b32 s5, 81920, 0
    s_sub_u32 s17, s17, s5
    buffer_load_dwordx4 v152, s[8:11], s17 offen sc1 lds
    s_waitcnt lgkmcnt(0)
    s_cmp_eq_u32 s26, 0
    s_cselect_b64 vcc, 0, -1
    s_waitcnt vmcnt(4)
    s_barrier
    s_cbranch_vccz Lpr_33
    s_setprio 1
Lpr_33:
    v_exp_f32 v16, v16
    v_exp_f32 v17, v17
    v_exp_f32 v18, v18
    v_exp_f32 v19, v19
    ds_read_b128 v[124:127], v4 offset:5120
    ds_read_b32 v132, v5 offset:5120
    s_mov_b64 exec, s[30:31]
    ds_read_b128 v[144:147], v6 offset:2560
    ds_read_b128 v[148:151], v6 offset:3200
    s_mov_b64 exec, -1
    v_exp_f32 v20, v20
    v_exp_f32 v21, v21
    v_exp_f32 v22, v22
    v_exp_f32 v23, v23
    v_mfma_f32_32x32x16_bf16 v[32:47], v[128:131], v[112:115], 0
    s_add_u32 m0, s16, 24576
    s_add_u32 s17, s17, 4096
    s_cmp_ge_u32 s17, s4
    s_cselect_b32 s5, 81920, 0
    s_sub_u32 s17, s17, s5
    buffer_load_dwordx4 v152, s[8:11], s17 offen sc1 lds
    v_exp_f32 v24, v24
    v_exp_f32 v25, v25
    v_exp_f32 v26, v26
    v_exp_f32 v27, v27
    v_mfma_f32_32x32x8_bf16 v[32:47], v[134:135], v[120:121], v[32:47]
    s_add_u32 m0, s16, 28672
    s_add_u32 s17, s17, 4096
    s_cmp_ge_u32 s17, s4
    s_cselect_b32 s5, 81920, 0
    s_sub_u32 s17, s17, s5
    buffer_load_dwordx4 v152, s[8:11], s17 offen sc1 lds
    v_exp_f32 v28, v28
    v_exp_f32 v29, v29
    v_exp_f32 v30, v30
    v_exp_f32 v31, v31
    v_smfmac_f32_32x32x32_bf16 v[80:95], v[136:139], v[16:23], v7
    v_exp_f32 v48, v48
    v_exp_f32 v49, v49
    v_exp_f32 v50, v50
    v_exp_f32 v51, v51
    v_mfma_f32_32x32x16_bf16 v[64:79], v[128:131], v[116:119], 0
    s_add_u32 m0, s16, 32768
    s_add_u32 s17, s17, 4096
    s_cmp_ge_u32 s17, s4
    s_cselect_b32 s5, 81920, 0
    s_sub_u32 s17, s17, s5
    buffer_load_dwordx4 v152, s[8:11], s17 offen sc1 lds
    v_exp_f32 v52, v52
    v_exp_f32 v53, v53
    v_exp_f32 v54, v54
    v_exp_f32 v55, v55
    v_mfma_f32_32x32x8_bf16 v[64:79], v[134:135], v[122:123], v[64:79]
    s_add_u32 m0, s16, 36864
    s_add_u32 s17, s17, 4096
    s_cmp_ge_u32 s17, s4
    s_cselect_b32 s5, 81920, 0
    s_sub_u32 s17, s17, s5
    buffer_load_dwordx4 v152, s[8:11], s17 offen sc1 lds
    v_exp_f32 v56, v56
    v_exp_f32 v57, v57
    v_exp_f32 v58, v58
    v_exp_f32 v59, v59
    v_smfmac_f32_32x32x32_bf16 v[96:111], v[136:139], v[48:55], v7
    v_exp_f32 v60, v60
    v_exp_f32 v61, v61
    v_exp_f32 v62, v62
    v_exp_f32 v63, v63
    s_waitcnt lgkmcnt(0)
    s_waitcnt vmcnt(4)
    s_barrier
    v_smfmac_f32_32x32x32_bf16 v[80:95], v[140:143], v[24:31], v7
    v_exp_f32 v32, v32
    v_exp_f32 v33, v33
    v_exp_f32 v34, v34
    v_exp_f32 v35, v35
    v_smfmac_f32_32x32x32_bf16 v[96:111], v[140:143], v[56:63], v7
    ds_read_b128 v[128:131], v4 offset:7680
    ds_read_b32 v134, v5 offset:7680
    s_mov_b64 exec, s[30:31]
    ds_read_b128 v[136:139], v6 offset:5120
    ds_read_b128 v[140:143], v6 offset:5760
    s_mov_b64 exec, -1
    v_exp_f32 v36, v36
    v_exp_f32 v37, v37
    v_exp_f32 v38, v38
    v_exp_f32 v39, v39
    v_mfma_f32_32x32x16_bf16 v[16:31], v[124:127], v[112:115], 0
    s_add_u32 m0, s16, 40960
    s_add_u32 s17, s17, 4096
    s_cmp_ge_u32 s17, s4
    s_cselect_b32 s5, 81920, 0
    s_sub_u32 s17, s17, s5
    buffer_load_dwordx4 v152, s[8:11], s17 offen sc1 lds
    v_exp_f32 v40, v40
    v_exp_f32 v41, v41
    v_exp_f32 v42, v42
    v_exp_f32 v43, v43
    v_mfma_f32_32x32x8_bf16 v[16:31], v[132:133], v[120:121], v[16:31]
    s_add_u32 m0, s16, 45056
    s_add_u32 s17, s17, 4096
    s_cmp_ge_u32 s17, s4
    s_cselect_b32 s5, 81920, 0
    s_sub_u32 s17, s17, s5
    buffer_load_dwordx4 v152, s[8:11], s17 offen sc1 lds
    v_exp_f32 v44, v44
    v_exp_f32 v45, v45
    v_exp_f32 v46, v46
    v_exp_f32 v47, v47
    v_smfmac_f32_32x32x32_bf16 v[80:95], v[144:147], v[32:39], v7
    v_exp_f32 v64, v64
    v_exp_f32 v65, v65
    v_exp_f32 v66, v66
    v_exp_f32 v67, v67
    v_mfma_f32_32x32x16_bf16 v[48:63], v[124:127], v[116:119], 0
    s_add_u32 m0, s16, 49152
    s_add_u32 s17, s17, 4096
    s_cmp_ge_u32 s17, s4
    s_cselect_b32 s5, 81920, 0
    s_sub_u32 s17, s17, s5
    buffer_load_dwordx4 v152, s[8:11], s17 offen sc1 lds
    v_exp_f32 v68, v68
    v_exp_f32 v69, v69
    v_exp_f32 v70, v70
    v_exp_f32 v71, v71
    v_mfma_f32_32x32x8_bf16 v[48:63], v[132:133], v[122:123], v[48:63]
    s_add_u32 m0, s16, 53248
    s_add_u32 s17, s17, 4096
    s_cmp_ge_u32 s17, s4
    s_cselect_b32 s5, 81920, 0
    s_sub_u32 s17, s17, s5
    buffer_load_dwordx4 v152, s[8:11], s17 offen sc1 lds
    v_exp_f32 v72, v72
    v_exp_f32 v73, v73
    v_exp_f32 v74, v74
    v_exp_f32 v75, v75
    v_smfmac_f32_32x32x32_bf16 v[96:111], v[144:147], v[64:71], v7
    v_exp_f32 v76, v76
    v_exp_f32 v77, v77
    v_exp_f32 v78, v78
    v_exp_f32 v79, v79
    s_waitcnt lgkmcnt(0)
    v_smfmac_f32_32x32x32_bf16 v[80:95], v[148:151], v[40:47], v7
    v_exp_f32 v16, v16
    v_exp_f32 v17, v17
    v_exp_f32 v18, v18
    v_exp_f32 v19, v19
    v_smfmac_f32_32x32x32_bf16 v[96:111], v[148:151], v[72:79], v7
    ds_read_b128 v[124:127], v4 offset:10240
    ds_read_b32 v132, v5 offset:10240
    s_mov_b64 exec, s[30:31]
    ds_read_b128 v[144:147], v6 offset:7680
    ds_read_b128 v[148:151], v6 offset:8320
    s_mov_b64 exec, -1
    v_exp_f32 v20, v20
    v_exp_f32 v21, v21
    v_exp_f32 v22, v22
    v_exp_f32 v23, v23
    v_mfma_f32_32x32x16_bf16 v[32:47], v[128:131], v[112:115], 0
    s_add_u32 m0, s16, 57344
    s_add_u32 s17, s17, 4096
    s_cmp_ge_u32 s17, s4
    s_cselect_b32 s5, 81920, 0
    s_sub_u32 s17, s17, s5
    buffer_load_dwordx4 v152, s[8:11], s17 offen sc1 lds
    v_exp_f32 v24, v24
    v_exp_f32 v25, v25
    v_exp_f32 v26, v26
    v_exp_f32 v27, v27
    v_mfma_f32_32x32x8_bf16 v[32:47], v[134:135], v[120:121], v[32:47]
    s_add_u32 m0, s16, 61440
    s_add_u32 s17, s17, 4096
    s_cmp_ge_u32 s17, s4
    s_cselect_b32 s5, 81920, 0
    s_sub_u32 s17, s17, s5
    buffer_load_dwordx4 v152, s[8:11], s17 offen sc1 lds
    v_exp_f32 v28, v28
    v_exp_f32 v29, v29
    v_exp_f32 v30, v30
    v_exp_f32 v31, v31
    v_smfmac_f32_32x32x32_bf16 v[80:95], v[136:139], v[16:23], v7
    v_exp_f32 v48, v48
    v_exp_f32 v49, v49
    v_exp_f32 v50, v50
    v_exp_f32 v51, v51
    v_mfma_f32_32x32x16_bf16 v[64:79], v[128:131], v[116:119], 0
    s_add_u32 m0, s16, 65536
    s_add_u32 s17, s17, 4096
    s_cmp_ge_u32 s17, s4
    s_cselect_b32 s5, 81920, 0
    s_sub_u32 s17, s17, s5
    buffer_load_dwordx4 v152, s[8:11], s17 offen sc1 lds
    v_exp_f32 v52, v52
    v_exp_f32 v53, v53
    v_exp_f32 v54, v54
    v_exp_f32 v55, v55
    v_mfma_f32_32x32x8_bf16 v[64:79], v[134:135], v[122:123], v[64:79]
    s_add_u32 m0, s16, 69632
    s_add_u32 s17, s17, 4096
    s_cmp_ge_u32 s17, s4
    s_cselect_b32 s5, 81920, 0
    s_sub_u32 s17, s17, s5
    buffer_load_dwordx4 v152, s[8:11], s17 offen sc1 lds
    v_exp_f32 v56, v56
    v_exp_f32 v57, v57
    v_exp_f32 v58, v58
    v_exp_f32 v59, v59
    v_smfmac_f32_32x32x32_bf16 v[96:111], v[136:139], v[48:55], v7
    v_exp_f32 v60, v60
    v_exp_f32 v61, v61
    v_exp_f32 v62, v62
    v_exp_f32 v63, v63
    s_waitcnt lgkmcnt(0)
    v_smfmac_f32_32x32x32_bf16 v[80:95], v[140:143], v[24:31], v7
    v_exp_f32 v32, v32
    v_exp_f32 v33, v33
    v_exp_f32 v34, v34
    v_exp_f32 v35, v35
    v_smfmac_f32_32x32x32_bf16 v[96:111], v[140:143], v[56:63], v7
    ds_read_b128 v[128:131], v4 offset:12800
    ds_read_b32 v134, v5 offset:12800
    s_mov_b64 exec, s[30:31]
    ds_read_b128 v[136:139], v6 offset:10240
    ds_read_b128 v[140:143], v6 offset:10880
    s_mov_b64 exec, -1
    v_exp_f32 v36, v36
    v_exp_f32 v37, v37
    v_exp_f32 v38, v38
    v_exp_f32 v39, v39
    v_mfma_f32_32x32x16_bf16 v[16:31], v[124:127], v[112:115], 0
    s_add_u32 m0, s16, 73728
    s_add_u32 s17, s17, 4096
    s_cmp_ge_u32 s17, s4
    s_cselect_b32 s5, 81920, 0
    s_sub_u32 s17, s17, s5
    buffer_load_dwordx4 v152, s[8:11], s17 offen sc1 lds
    v_exp_f32 v40, v40
    v_exp_f32 v41, v41
    v_exp_f32 v42, v42
    v_exp_f32 v43, v43
    v_mfma_f32_32x32x8_bf16 v[16:31], v[132:133], v[120:121], v[16:31]
    s_add_u32 m0, s16, 77824
    s_add_u32 s17, s17, 4096
    s_cmp_ge_u32 s17, s4
    s_cselect_b32 s5, 81920, 0
    s_sub_u32 s17, s17, s5
    buffer_load_dwordx4 v152, s[8:11], s17 offen sc1 lds
    v_exp_f32 v44, v44
    v_exp_f32 v45, v45
    v_exp_f32 v46, v46
    v_exp_f32 v47, v47
    v_smfmac_f32_32x32x32_bf16 v[80:95], v[144:147], v[32:39], v7
    s_cbranch_vccz Lpr_34
    s_setprio 0
Lpr_34:
    v_exp_f32 v64, v64
    v_exp_f32 v65, v65
    v_exp_f32 v66, v66
    v_exp_f32 v67, v67
    v_mfma_f32_32x32x16_bf16 v[48:63], v[124:127], v[116:119], 0
    v_exp_f32 v68, v68
    v_exp_f32 v69, v69
    v_exp_f32 v70, v70
    v_exp_f32 v71, v71
    v_mfma_f32_32x32x8_bf16 v[48:63], v[132:133], v[122:123], v[48:63]
    v_exp_f32 v72, v72
    v_exp_f32 v73, v73
    v_exp_f32 v74, v74
    v_exp_f32 v75, v75
    v_smfmac_f32_32x32x32_bf16 v[96:111], v[144:147], v[64:71], v7
    v_exp_f32 v76, v76
    v_exp_f32 v77, v77
    v_exp_f32 v78, v78
    v_exp_f32 v79, v79
    s_waitcnt lgkmcnt(0)
    s_mov_b32 s47, s40
    s_cmp_eq_u32 s26, 0
    s_cselect_b32 s40, s40, 0x7ff00000
    s_mov_b32 s29, 0
    s_mov_b32 s53, 0
    s_add_u32 s48, s74, 7864320
    s_addc_u32 s49, s75, 0
    s_mov_b32 s50, 11665408
    s_mov_b32 s51, 0x20000
.p2align 6
L2_loop:
    s_cbranch_vccz Lpr_35
    s_setprio 1
Lpr_35:
    v_smfmac_f32_32x32x32_bf16 v[80:95], v[148:151], v[40:47], v7
    v_exp_f32 v16, v16
    v_exp_f32 v17, v17
    v_exp_f32 v18, v18
    v_exp_f32 v19, v19
    v_smfmac_f32_32x32x32_bf16 v[96:111], v[148:151], v[72:79], v7
    ds_read_b128 v[124:127], v4 offset:15360
    ds_read_b32 v132, v5 offset:15360
    s_mov_b64 exec, s[30:31]
    ds_read_b128 v[144:147], v6 offset:12800
    ds_read_b128 v[148:151], v6 offset:13440
    s_mov_b64 exec, -1
    v_exp_f32 v20, v20
    v_exp_f32 v21, v21
    v_exp_f32 v22, v22
    v_exp_f32 v23, v23
    v_mfma_f32_32x32x16_bf16 v[32:47], v[128:131], v[112:115], 0
    v_exp_f32 v24, v24
    v_exp_f32 v25, v25
    v_exp_f32 v26, v26
    v_exp_f32 v27, v27
    v_mfma_f32_32x32x8_bf16 v[32:47], v[134:135], v[120:121], v[32:47]
    s_cmp_lt_u32 s40, 0x7f000000
    s_cbranch_scc0 Lncl_36
    buffer_store_dwordx4 v[172:175], v152, s[48:51], s40 offen sc1
    s_add_u32 s40, s40, 1024
Lncl_36:
    v_exp_f32 v28, v28
    v_exp_f32 v29, v29
    v_exp_f32 v30, v30
    v_exp_f32 v31, v31
    v_smfmac_f32_32x32x32_bf16 v[80:95], v[136:139], v[16:23], v7
    v_exp_f32 v48, v48
    v_exp_f32 v49, v49
    v_exp_f32 v50, v50
    v_exp_f32 v51, v51
    v_mfma_f32_32x32x16_bf16 v[64:79], v[128:131], v[116:119], 0
    v_exp_f32 v52, v52
    v_exp_f32 v53, v53
    v_exp_f32 v54, v54
    v_exp_f32 v55, v55
    v_mfma_f32_32x32x8_bf16 v[64:79], v[134:135], v[122:123], v[64:79]
    v_exp_f32 v56, v56
    v_exp_f32 v57, v57
    v_exp_f32 v58, v58
    v_exp_f32 v59, v59
    v_smfmac_f32_32x32x32_bf16 v[96:111], v[136:139], v[48:55], v7
    v_exp_f32 v60, v60
    v_exp_f32 v61, v61
    v_exp_f32 v62, v62
    v_exp_f32 v63, v63
    s_waitcnt lgkmcnt(0)
    v_smfmac_f32_32x32x32_bf16 v[80:95], v[140:143], v[24:31], v7
    v_exp_f32 v32, v32
    v_exp_f32 v33, v33
    v_exp_f32 v34, v34
    v_exp_f32 v35, v35
    v_smfmac_f32_32x32x32_bf16 v[96:111], v[140:143], v[56:63], v7
    ds_read_b128 v[128:131], v4 offset:17920
    ds_read_b32 v134, v5 offset:17920
    s_mov_b64 exec, s[30:31]
    ds_read_b128 v[136:139], v6 offset:15360
    ds_read_b128 v[140:143], v6 offset:16000
    s_mov_b64 exec, -1
    v_exp_f32 v36, v36
    v_exp_f32 v37, v37
    v_exp_f32 v38, v38
    v_exp_f32 v39, v39
    v_mfma_f32_32x32x16_bf16 v[16:31], v[124:127], v[112:115], 0
    v_exp_f32 v40, v40
    v_exp_f32 v41, v41
    v_exp_f32 v42, v42
    v_exp_f32 v43, v43
    v_mfma_f32_32x32x8_bf16 v[16:31], v[132:133], v[120:121], v[16:31]
    v_exp_f32 v44, v44
    v_exp_f32 v45, v45
    v_exp_f32 v46, v46
    v_exp_f32 v47, v47
    v_smfmac_f32_32x32x32_bf16 v[80:95], v[144:147], v[32:39], v7
    v_exp_f32 v64, v64
    v_exp_f32 v65, v65
    v_exp_f32 v66, v66
    v_exp_f32 v67, v67
    v_mfma_f32_32x32x16_bf16 v[48:63], v[124:127], v[116:119], 0
    v_exp_f32 v68, v68
    v_exp_f32 v69, v69
    v_exp_f32 v70, v70
    v_exp_f32 v71, v71
    v_mfma_f32_32x32x8_bf16 v[48:63], v[132:133], v[122:123], v[48:63]
    v_exp_f32 v72, v72
    v_exp_f32 v73, v73
    v_exp_f32 v74, v74
    v_exp_f32 v75, v75
    v_smfmac_f32_32x32x32_bf16 v[96:111], v[144:147], v[64:71], v7
    v_exp_f32 v76, v76
    v_exp_f32 v77, v77
    v_exp_f32 v78, v78
    v_exp_f32 v79, v79
    s_waitcnt lgkmcnt(0)
    v_smfmac_f32_32x32x32_bf16 v[80:95], v[148:151], v[40:47], v7
    v_exp_f32 v16, v16
    v_exp_f32 v17, v17
    v_exp_f32 v18, v18
    v_exp_f32 v19, v19
    v_smfmac_f32_32x32x32_bf16 v[96:111], v[148:151], v[72:79], v7
    ds_read_b128 v[124:127], v4 offset:20480
    ds_read_b32 v132, v5 offset:20480
    s_mov_b64 exec, s[30:31]
    ds_read_b128 v[144:147], v6 offset:17920
    ds_read_b128 v[148:151], v6 offset:18560
    s_mov_b64 exec, -1
    v_exp_f32 v20, v20
    v_exp_f32 v21, v21
    v_exp_f32 v22, v22
    v_exp_f32 v23, v23
    v_mfma_f32_32x32x16_bf16 v[32:47], v[128:131], v[112:115], 0
    v_exp_f32 v24, v24
    v_exp_f32 v25, v25
    v_exp_f32 v26, v26
    v_exp_f32 v27, v27
    v_mfma_f32_32x32x8_bf16 v[32:47], v[134:135], v[120:121], v[32:47]
    s_cmp_lt_u32 s40, 0x7f000000
    s_cbranch_scc0 Lncl_37
    buffer_store_dwordx4 v[172:175], v152, s[48:51], s40 offen sc1
    s_add_u32 s40, s40, 1024
Lncl_37:
    v_exp_f32 v28, v28
    v_exp_f32 v29, v29
    v_exp_f32 v30, v30
    v_exp_f32 v31, v31
    v_smfmac_f32_32x32x32_bf16 v[80:95], v[136:139], v[16:23], v7
    v_exp_f32 v48, v48
    v_exp_f32 v49, v49
    v_exp_f32 v50, v50
    v_exp_f32 v51, v51
    v_mfma_f32_32x32x16_bf16 v[64:79], v[128:131], v[116:119], 0
    v_exp_f32 v52, v52
    v_exp_f32 v53, v53
    v_exp_f32 v54, v54
    v_exp_f32 v55, v55
    v_mfma_f32_32x32x8_bf16 v[64:79], v[134:135], v[122:123], v[64:79]
    v_exp_f32 v56, v56
    v_exp_f32 v57, v57
    v_exp_f32 v58, v58
    v_exp_f32 v59, v59
    v_smfmac_f32_32x32x32_bf16 v[96:111], v[136:139], v[48:55], v7
    v_exp_f32 v60, v60
    v_exp_f32 v61, v61
    v_exp_f32 v62, v62
    v_exp_f32 v63, v63
    s_waitcnt lgkmcnt(0)
    v_smfmac_f32_32x32x32_bf16 v[80:95], v[140:143], v[24:31], v7
    v_exp_f32 v32, v32
    v_exp_f32 v33, v33
    v_exp_f32 v34, v34
    v_exp_f32 v35, v35
    v_smfmac_f32_32x32x32_bf16 v[96:111], v[140:143], v[56:63], v7
    ds_read_b128 v[128:131], v4 offset:23040
    ds_read_b32 v134, v5 offset:23040
    s_mov_b64 exec, s[30:31]
    ds_read_b128 v[136:139], v6 offset:20480
    ds_read_b128 v[140:143], v6 offset:21120
    s_mov_b64 exec, -1
    v_exp_f32 v36, v36
    v_exp_f32 v37, v37
    v_exp_f32 v38, v38
    v_exp_f32 v39, v39
    v_mfma_f32_32x32x16_bf16 v[16:31], v[124:127], v[112:115], 0
    v_exp_f32 v40, v40
    v_exp_f32 v41, v41
    v_exp_f32 v42, v42
    v_exp_f32 v43, v43
    v_mfma_f32_32x32x8_bf16 v[16:31], v[132:133], v[120:121], v[16:31]
    v_exp_f32 v44, v44
    v_exp_f32 v45, v45
    v_exp_f32 v46, v46
    v_exp_f32 v47, v47
    v_smfmac_f32_32x32x32_bf16 v[80:95], v[144:147], v[32:39], v7
    s_cbranch_vccz Lpr_38
    s_setprio 0
Lpr_38:
    v_exp_f32 v64, v64
    v_exp_f32 v65, v65
    v_exp_f32 v66, v66
    v_exp_f32 v67, v67
    v_mfma_f32_32x32x16_bf16 v[48:63], v[124:127], v[116:119], 0
    v_exp_f32 v68, v68
    v_exp_f32 v69, v69
    v_exp_f32 v70, v70
    v_exp_f32 v71, v71
    v_mfma_f32_32x32x8_bf16 v[48:63], v[132:133], v[122:123], v[48:63]
    v_exp_f32 v72, v72
    v_exp_f32 v73, v73
    v_exp_f32 v74, v74
    v_exp_f32 v75, v75
    v_smfmac_f32_32x32x32_bf16 v[96:111], v[144:147], v[64:71], v7
    v_exp_f32 v76, v76
    v_exp_f32 v77, v77
    v_exp_f32 v78, v78
    v_exp_f32 v79, v79
    s_waitcnt lgkmcnt(0)
    v_add_u32 v4, 10240, v4
    v_add_u32 v5, 10240, v5
    v_add_u32 v6, 10240, v6
    s_add_u32 s29, s29, 1
    s_bitcmp1_b32 0x3e, s29
    s_cbranch_scc1 L2_hook
    s_branch L2_loop
.p2align 6
L2_loop_c:
    s_cbranch_vccz Lpr_39
    s_setprio 1
Lpr_39:
    v_smfmac_f32_32x32x32_bf16 v[80:95], v[148:151], v[40:47], v7
    v_exp_f32 v16, v16
    v_exp_f32 v17, v17
    v_exp_f32 v18, v18
    v_exp_f32 v19, v19
    v_smfmac_f32_32x32x32_bf16 v[96:111], v[148:151], v[72:79], v7
    ds_read_b128 v[124:127], v4 offset:15360
    ds_read_b32 v132, v5 offset:15360
    s_mov_b64 exec, s[30:31]
    ds_read_b128 v[144:147], v6 offset:12800
    ds_read_b128 v[148:151], v6 offset:13440
    s_mov_b64 exec, -1
    v_exp_f32 v20, v20
    v_exp_f32 v21, v21
    v_exp_f32 v22, v22
    v_exp_f32 v23, v23
    v_mfma_f32_32x32x16_bf16 v[32:47], v[128:131], v[112:115], 0
    s_mov_b32 m0, s41
    s_add_u32 s41, s41, 8192
    s_cmp_eq_u32 s41, s43
    s_cselect_b32 s41, s46, s41
    buffer_load_dwordx4 v152, s[48:51], s42 offen sc1 lds
    s_add_u32 s42, s42, 8192
    v_exp_f32 v24, v24
    v_exp_f32 v25, v25
    v_exp_f32 v26, v26
    v_exp_f32 v27, v27
    v_mfma_f32_32x32x8_bf16 v[32:47], v[134:135], v[120:121], v[32:47]
    v_exp_f32 v28, v28
    v_exp_f32 v29, v29
    v_exp_f32 v30, v30
    v_exp_f32 v31, v31
    v_smfmac_f32_32x32x32_bf16 v[80:95], v[136:139], v[16:23], v7
    v_exp_f32 v48, v48
    v_exp_f32 v49, v49
    v_exp_f32 v50, v50
    v_exp_f32 v51, v51
    v_mfma_f32_32x32x16_bf16 v[64:79], v[128:131], v[116:119], 0
    s_mov_b32 m0, s41
    s_add_u32 s41, s41, 8192
    s_cmp_eq_u32 s41, s43
    s_cselect_b32 s41, s46, s41
    buffer_load_dwordx4 v152, s[48:51], s42 offen sc1 lds
    s_add_u32 s42, s42, 8192
    v_exp_f32 v52, v52
    v_exp_f32 v53, v53
    v_exp_f32 v54, v54
    v_exp_f32 v55, v55
    v_mfma_f32_32x32x8_bf16 v[64:79], v[134:135], v[122:123], v[64:79]
    v_exp_f32 v56, v56
    v_exp_f32 v57, v57
    v_exp_f32 v58, v58
    v_exp_f32 v59, v59
    v_smfmac_f32_32x32x32_bf16 v[96:111], v[136:139], v[48:55], v7
    v_exp_f32 v60, v60
    v_exp_f32 v61, v61
    v_exp_f32 v62, v62
    v_exp_f32 v63, v63
    s_waitcnt lgkmcnt(0)
    v_smfmac_f32_32x32x32_bf16 v[80:95], v[140:143], v[24:31], v7
    v_exp_f32 v32, v32
    v_exp_f32 v33, v33
    v_exp_f32 v34, v34
    v_exp_f32 v35, v35
    v_smfmac_f32_32x32x32_bf16 v[96:111], v[140:143], v[56:63], v7
    ds_read_b128 v[128:131], v4 offset:17920
    ds_read_b32 v134, v5 offset:17920
    s_mov_b64 exec, s[30:31]
    ds_read_b128 v[136:139], v6 offset:15360
    ds_read_b128 v[140:143], v6 offset:16000
    s_mov_b64 exec, -1
    v_exp_f32 v36, v36
    v_exp_f32 v37, v37
    v_exp_f32 v38, v38
    v_exp_f32 v39, v39
    v_mfma_f32_32x32x16_bf16 v[16:31], v[124:127], v[112:115], 0
    s_mov_b32 m0, s41
    s_add_u32 s41, s41, 8192
    s_cmp_eq_u32 s41, s43
    s_cselect_b32 s41, s46, s41
    buffer_load_dwordx4 v152, s[48:51], s42 offen sc1 lds
    s_add_u32 s42, s42, 8192
    v_exp_f32 v40, v40
    v_exp_f32 v41, v41
    v_exp_f32 v42, v42
    v_exp_f32 v43, v43
    v_mfma_f32_32x32x8_bf16 v[16:31], v[132:133], v[120:121], v[16:31]
    v_exp_f32 v44, v44
    v_exp_f32 v45, v45
    v_exp_f32 v46, v46
    v_exp_f32 v47, v47
    v_smfmac_f32_32x32x32_bf16 v[80:95], v[144:147], v[32:39], v7
    v_exp_f32 v64, v64
    v_exp_f32 v65, v65
    v_exp_f32 v66, v66
    v_exp_f32 v67, v67
    v_mfma_f32_32x32x16_bf16 v[48:63], v[124:127], v[116:119], 0
    s_mov_b32 m0, s41
    s_add_u32 s41, s41, 8192
    s_cmp_eq_u32 s41, s43
    s_cselect_b32 s41, s46, s41
    buffer_load_dwordx4 v152, s[48:51], s42 offen sc1 lds
    s_add_u32 s42, s42, 8192
    v_exp_f32 v68, v68
    v_exp_f32 v69, v69
    v_exp_f32 v70, v70
    v_exp_f32 v71, v71
    v_mfma_f32_32x32x8_bf16 v[48:63], v[132:133], v[122:123], v[48:63]
    v_exp_f32 v72, v72
    v_exp_f32 v73, v73
    v_exp_f32 v74, v74
    v_exp_f32 v75, v75
    v_smfmac_f32_32x32x32_bf16 v[96:111], v[144:147], v[64:71], v7
    v_exp_f32 v76, v76
    v_exp_f32 v77, v77
    v_exp_f32 v78, v78
    v_exp_f32 v79, v79
    s_waitcnt lgkmcnt(0)
    v_smfmac_f32_32x32x32_bf16 v[80:95], v[148:151], v[40:47], v7
    v_exp_f32 v16, v16
    v_exp_f32 v17, v17
    v_exp_f32 v18, v18
    v_exp_f32 v19, v19
    v_smfmac_f32_32x32x32_bf16 v[96:111], v[148:151], v[72:79], v7
    ds_read_b128 v[124:127], v4 offset:20480
    ds_read_b32 v132, v5 offset:20480
    s_mov_b64 exec, s[30:31]
    ds_read_b128 v[144:147], v6 offset:17920
    ds_read_b128 v[148:151], v6 offset:18560
    s_mov_b64 exec, -1
    v_exp_f32 v20, v20
    v_exp_f32 v21, v21
    v_exp_f32 v22, v22
    v_exp_f32 v23, v23
    v_mfma_f32_32x32x16_bf16 v[32:47], v[128:131], v[112:115], 0
    s_mov_b32 m0, s41
    s_add_u32 s41, s41, 8192
    s_cmp_eq_u32 s41, s43
    s_cselect_b32 s41, s46, s41
    buffer_load_dwordx4 v152, s[48:51], s42 offen sc1 lds
    s_add_u32 s42, s42, 8192
    v_exp_f32 v24, v24
    v_exp_f32 v25, v25
    v_exp_f32 v26, v26
    v_exp_f32 v27, v27
    v_mfma_f32_32x32x8_bf16 v[32:47], v[134:135], v[120:121], v[32:47]
    v_exp_f32 v28, v28
    v_exp_f32 v29, v29
    v_exp_f32 v30, v30
    v_exp_f32 v31, v31
    v_smfmac_f32_32x32x32_bf16 v[80:95], v[136:139], v[16:23], v7
    v_exp_f32 v48, v48
    v_exp_f32 v49, v49
    v_exp_f32 v50, v50
    v_exp_f32 v51, v51
    v_mfma_f32_32x32x16_bf16 v[64:79], v[128:131], v[116:119], 0
    s_mov_b32 m0, s41
    s_add_u32 s41, s41, 8192
    s_cmp_eq_u32 s41, s43
    s_cselect_b32 s41, s46, s41
    buffer_load_dwordx4 v152, s[48:51], s42 offen sc1 lds
    s_add_u32 s42, s42, 8192
    v_exp_f32 v52, v52
    v_exp_f32 v53, v53
    v_exp_f32 v54, v54
    v_exp_f32 v55, v55
    v_mfma_f32_32x32x8_bf16 v[64:79], v[134:135], v[122:123], v[64:79]
    v_exp_f32 v56, v56
    v_exp_f32 v57, v57
    v_exp_f32 v58, v58
    v_exp_f32 v59, v59
    v_smfmac_f32_32x32x32_bf16 v[96:111], v[136:139], v[48:55], v7
    v_exp_f32 v60, v60
    v_exp_f32 v61, v61
    v_exp_f32 v62, v62
    v_exp_f32 v63, v63
    s_waitcnt lgkmcnt(0)
    v_smfmac_f32_32x32x32_bf16 v[80:95], v[140:143], v[24:31], v7
    v_exp_f32 v32, v32
    v_exp_f32 v33, v33
    v_exp_f32 v34, v34
    v_exp_f32 v35, v35
    v_smfmac_f32_32x32x32_bf16 v[96:111], v[140:143], v[56:63], v7
    ds_read_b128 v[128:131], v4 offset:23040
    ds_read_b32 v134, v5 offset:23040
    s_mov_b64 exec, s[30:31]
    ds_read_b128 v[136:139], v6 offset:20480
    ds_read_b128 v[140:143], v6 offset:21120
    s_mov_b64 exec, -1
    v_exp_f32 v36, v36
    v_exp_f32 v37, v37
    v_exp_f32 v38, v38
    v_exp_f32 v39, v39
    v_mfma_f32_32x32x16_bf16 v[16:31], v[124:127], v[112:115], 0
    v_exp_f32 v40, v40
    v_exp_f32 v41, v41
    v_exp_f32 v42, v42
    v_exp_f32 v43, v43
    v_mfma_f32_32x32x8_bf16 v[16:31], v[132:133], v[120:121], v[16:31]
    v_exp_f32 v44, v44
    v_exp_f32 v45, v45
    v_exp_f32 v46, v46
    v_exp_f32 v47, v47
    v_smfmac_f32_32x32x32_bf16 v[80:95], v[144:147], v[32:39], v7
    s_cbranch_vccz Lpr_40
    s_setprio 0
Lpr_40:
    v_exp_f32 v64, v64
    v_exp_f32 v65, v65
    v_exp_f32 v66, v66
    v_exp_f32 v67, v67
    v_mfma_f32_32x32x16_bf16 v[48:63], v[124:127], v[116:119], 0
    v_exp_f32 v68, v68
    v_exp_f32 v69, v69
    v_exp_f32 v70, v70
    v_exp_f32 v71, v71
    v_mfma_f32_32x32x8_bf16 v[48:63], v[132:133], v[122:123], v[48:63]
    v_exp_f32 v72, v72
    v_exp_f32 v73, v73
    v_exp_f32 v74, v74
    v_exp_f32 v75, v75
    v_smfmac_f32_32x32x32_bf16 v[96:111], v[144:147], v[64:71], v7
    v_exp_f32 v76, v76
    v_exp_f32 v77, v77
    v_exp_f32 v78, v78
    v_exp_f32 v79, v79
    s_waitcnt lgkmcnt(0)
    v_add_u32 v4, 10240, v4
    v_add_u32 v5, 10240, v5
    v_add_u32 v6, 10240, v6
    s_add_u32 s29, s29, 1
    s_bitcmp1_b32 0x40, s29
    s_cbranch_scc1 L2_hook
L2_after:
    s_setprio 0
    v_smfmac_f32_32x32x32_bf16 v[96:111], v[148:151], v[72:79], v7
    v_smfmac_f32_32x32x32_bf16 v[80:95], v[148:151], v[40:47], v7
    s_waitcnt vmcnt(0)
    s_movk_i32 s17, 0x1f8
    ds_write_b32 v12, v171
    s_nop 7
    ds_write_b128 v10, v[96:99] offset:0
    ds_write_b128 v10, v[100:103] offset:1024
    ds_write_b128 v10, v[104:107] offset:2048
    s_cmp_eq_u32 s3, 4
    s_cbranch_scc1 L2_clchk
L2_clback:
    s_waitcnt lgkmcnt(0)
    s_barrier
    ds_read_b32 v171, v13
    ds_read_b128 v[96:99], v11 offset:0
    ds_read_b128 v[100:103], v11 offset:1024
    ds_read_b128 v[104:107], v11 offset:2048
    s_waitcnt lgkmcnt(3)
    v_min_f32 v156, v170, v171
    v_sub_f32 v170, v156, v170
    v_sub_f32 v171, v156, v171
    v_exp_f32 v170, v170
    v_exp_f32 v171, v171
    s_nop 0
    v_pk_mul_f32 v[80:81], v[80:81], v[170:171] op_sel_hi:[1,0]
    v_pk_mul_f32 v[82:83], v[82:83], v[170:171] op_sel_hi:[1,0]
    v_pk_mul_f32 v[84:85], v[84:85], v[170:171] op_sel_hi:[1,0]
    v_pk_mul_f32 v[86:87], v[86:87], v[170:171] op_sel_hi:[1,0]
    v_pk_mul_f32 v[88:89], v[88:89], v[170:171] op_sel_hi:[1,0]
    v_pk_mul_f32 v[90:91], v[90:91], v[170:171] op_sel_hi:[1,0]
    s_waitcnt lgkmcnt(0)
    v_pk_fma_f32 v[80:81], v[96:97], v[170:171], v[80:81] op_sel:[0,1,0] op_sel_hi:[1,1,1]
    v_pk_fma_f32 v[82:83], v[98:99], v[170:171], v[82:83] op_sel:[0,1,0] op_sel_hi:[1,1,1]
    v_pk_fma_f32 v[84:85], v[100:101], v[170:171], v[84:85] op_sel:[0,1,0] op_sel_hi:[1,1,1]
    v_pk_fma_f32 v[86:87], v[102:103], v[170:171], v[86:87] op_sel:[0,1,0] op_sel_hi:[1,1,1]
    v_pk_fma_f32 v[88:89], v[104:105], v[170:171], v[88:89] op_sel:[0,1,0] op_sel_hi:[1,1,1]
    v_pk_fma_f32 v[90:91], v[106:107], v[170:171], v[90:91] op_sel:[0,1,0] op_sel_hi:[1,1,1]
    v_mov_b32 v156, v88
    v_mov_b32 v157, v88
    v_pk_add_f32 v[160:161], v[80:81], v[82:83]
    v_pk_add_f32 v[162:163], v[84:85], v[86:87]
    v_permlane32_swap_b32 v156, v157
    v_rcp_f32 v156, v157
    v_pk_add_f32 v[160:161], v[160:161], v[88:89]
    v_pk_add_f32 v[162:163], v[162:163], v[90:91]
    v_cmp_gt_f32 vcc, 0x71800000, v157
    v_pk_add_f32 v[160:161], v[160:161], v[162:163]
    v_add_f32 v160, v160, v161
    v_cmp_class_f32 s[36:37], v160, s17
    v_pk_mul_f32 v[80:81], v[80:81], v[156:157] op_sel_hi:[1,0]
    v_pk_mul_f32 v[82:83], v[82:83], v[156:157] op_sel_hi:[1,0]
    v_pk_mul_f32 v[84:85], v[84:85], v[156:157] op_sel_hi:[1,0]
    v_pk_mul_f32 v[86:87], v[86:87], v[156:157] op_sel_hi:[1,0]
    v_pk_mul_f32 v[88:89], v[88:89], v[156:157] op_sel_hi:[1,0]
    v_pk_mul_f32 v[90:91], v[90:91], v[156:157] op_sel_hi:[1,0]
    s_and_b64 vcc, vcc, s[36:37]
    s_cmp_eq_u64 vcc, exec
    s_cbranch_scc0 L2_fallback
L2_store:
    v_cvt_pk_bf16_f32 v160, v80, v81
    v_cvt_pk_bf16_f32 v161, v82, v83
    v_cvt_pk_bf16_f32 v162, v84, v85
    v_cvt_pk_bf16_f32 v163, v86, v87
    v_cvt_pk_bf16_f32 v164, v88, v89
    v_cvt_pk_bf16_f32 v165, v90, v91
    v_min_u32 v160, 0xfffffffe, v160
    v_min_u32 v161, 0xfffffffe, v161
    v_min_u32 v162, 0xfffffffe, v162
    v_min_u32 v163, 0xfffffffe, v163
    v_min_u32 v164, 0xfffffffe, v164
    v_min_u32 v165, 0xfffffffe, v165
    buffer_store_dwordx4 v[160:163], v8, s[76:79], 0 offen sc1
    s_mov_b64 exec, 0xffffffff
    buffer_store_dwordx2 v[164:165], v9, s[76:79], 0 offen sc1
    s_mov_b64 exec, -1
    v_lshlrev_b32 v4, 4, v0
    s_cmp_lt_u32 s3, 4
    s_cbranch_scc1 L3_comp
    s_cmp_lg_u32 s24, 0
    s_cbranch_scc1 Lnp_41
    s_mov_b32 s54, 262144
    buffer_load_dword v238, v222, s[76:79], 0 offen sc1
Lpp_42:
    buffer_load_dword v239, v222, s[76:79], 0 offen sc1
    s_waitcnt vmcnt(1)
    v_cmp_ne_u32 vcc, -1, v238
    s_sub_u32 s54, s54, 1
    s_cbranch_scc1 Lppd_43
    s_cmp_eq_u64 vcc, exec
    s_cbranch_scc1 Lppd_43
    buffer_load_dword v238, v222, s[76:79], 0 offen sc1
    s_waitcnt vmcnt(1)
    v_cmp_ne_u32 vcc, -1, v239
    s_sub_u32 s54, s54, 1
    s_cbranch_scc1 Lppd_43
    s_cmp_eq_u64 vcc, exec
    s_cbranch_scc0 Lpp_42
Lppd_43:
    s_mov_b64 exec, -1
Lnp_41:
    s_barrier
    s_lshl_b32 s13, s24, 12
    s_mul_i32 s15, s24, 6144
    s_mul_i32 s16, s23, 245760
    s_add_u32 s16, s16, s15
    s_add_u32 s16, s16, 22315008
    s_mul_i32 s17, s21, 0
    s_lshr_b32 s17, s17, 2
    s_lshl_b32 s25, s22, 3
    s_lshl_b32 s31, s24, 1
    s_add_u32 s25, s25, s31
    s_mul_i32 s25, s25, 20480
    s_add_u32 s25, s25, 10485760
    v_lshrrev_b32 v7, 1, v0
    v_lshlrev_b32 v7, 14, v7
    v_and_b32 v8, 1, v0
    v_lshl_add_u32 v7, v8, 7, v7
    s_lshl_b32 s33, s22, 2
    s_add_u32 s33, s33, s24
    s_lshl_b32 s33, s33, 8
    s_add_u32 s33, s33, 19398656
    v_add_u32 v7, s33, v7
    v_add_u32 v5, s15, v4
    v_add_u32 v6, 49152, v5
    s_barrier
    s_lshl_b32 s27, s24, 10
    s_mul_i32 s26, s21, 245760
    s_add_u32 s26, s26, s27
    s_add_u32 s26, s26, 20348928
    s_add_u32 s30, s16, 0
    buffer_load_dwordx4 v[16:19], v4, s[76:79], s30 offen offset:0 sc1
    buffer_load_dwordx4 v[20:23], v4, s[76:79], s30 offen offset:1024 sc1
    buffer_load_dwordx4 v[24:27], v4, s[76:79], s30 offen offset:2048 sc1
    buffer_load_dwordx4 v[28:31], v4, s[76:79], s30 offen offset:3072 sc1
    s_add_u32 s30, s16, 4096
    buffer_load_dwordx4 v[32:35], v4, s[76:79], s30 offen offset:0 sc1
    buffer_load_dwordx4 v[36:39], v4, s[76:79], s30 offen offset:1024 sc1
    s_add_u32 s30, s16, 24576
    buffer_load_dwordx4 v[40:43], v4, s[76:79], s30 offen offset:0 sc1
    buffer_load_dwordx4 v[44:47], v4, s[76:79], s30 offen offset:1024 sc1
    buffer_load_dwordx4 v[48:51], v4, s[76:79], s30 offen offset:2048 sc1
    buffer_load_dwordx4 v[52:55], v4, s[76:79], s30 offen offset:3072 sc1
    s_add_u32 s30, s16, 28672
    buffer_load_dwordx4 v[56:59], v4, s[76:79], s30 offen offset:0 sc1
    buffer_load_dwordx4 v[60:63], v4, s[76:79], s30 offen offset:1024 sc1
    s_add_u32 s30, s16, 49152
    buffer_load_dwordx4 v[64:67], v4, s[76:79], s30 offen offset:0 sc1
    buffer_load_dwordx4 v[68:71], v4, s[76:79], s30 offen offset:1024 sc1
    buffer_load_dwordx4 v[72:75], v4, s[76:79], s30 offen offset:2048 sc1
    buffer_load_dwordx4 v[76:79], v4, s[76:79], s30 offen offset:3072 sc1
    s_add_u32 s30, s16, 53248
    buffer_load_dwordx4 v[80:83], v4, s[76:79], s30 offen offset:0 sc1
    buffer_load_dwordx4 v[84:87], v4, s[76:79], s30 offen offset:1024 sc1
    s_add_u32 s30, s16, 73728
    buffer_load_dwordx4 v[88:91], v4, s[76:79], s30 offen offset:0 sc1
    buffer_load_dwordx4 v[92:95], v4, s[76:79], s30 offen offset:1024 sc1
    buffer_load_dwordx4 v[96:99], v4, s[76:79], s30 offen offset:2048 sc1
    buffer_load_dwordx4 v[100:103], v4, s[76:79], s30 offen offset:3072 sc1
    s_add_u32 s30, s16, 77824
    buffer_load_dwordx4 v[104:107], v4, s[76:79], s30 offen offset:0 sc1
    buffer_load_dwordx4 v[108:111], v4, s[76:79], s30 offen offset:1024 sc1
    s_barrier
    s_waitcnt vmcnt(18)
    ds_write_b128 v5, v[16:19] offset:0
    ds_write_b128 v5, v[20:23] offset:1024
    ds_write_b128 v5, v[24:27] offset:2048
    ds_write_b128 v5, v[28:31] offset:3072
    ds_write_b128 v5, v[32:35] offset:4096
    ds_write_b128 v5, v[36:39] offset:5120
    s_waitcnt vmcnt(12)
    ds_write_b128 v5, v[40:43] offset:24576
    ds_write_b128 v5, v[44:47] offset:25600
    ds_write_b128 v5, v[48:51] offset:26624
    ds_write_b128 v5, v[52:55] offset:27648
    ds_write_b128 v5, v[56:59] offset:28672
    ds_write_b128 v5, v[60:63] offset:29696
    s_waitcnt vmcnt(6)
    ds_write_b128 v6, v[64:67] offset:0
    ds_write_b128 v6, v[68:71] offset:1024
    ds_write_b128 v6, v[72:75] offset:2048
    ds_write_b128 v6, v[76:79] offset:3072
    ds_write_b128 v6, v[80:83] offset:4096
    ds_write_b128 v6, v[84:87] offset:5120
    s_waitcnt vmcnt(0)
    ds_write_b128 v6, v[88:91] offset:24576
    ds_write_b128 v6, v[92:95] offset:25600
    ds_write_b128 v6, v[96:99] offset:26624
    ds_write_b128 v6, v[100:103] offset:27648
    ds_write_b128 v6, v[104:107] offset:28672
    ds_write_b128 v6, v[108:111] offset:29696
    s_mov_b64 exec, 0xffff
    s_mov_b32 s54, 262144
Lpoll_44:
    buffer_load_dword v8, v7, s[76:79], 0 offen sc1
    s_waitcnt vmcnt(0)
    v_cmp_ne_u32 vcc, -1, v8
    s_sub_u32 s54, s54, 1
    s_cbranch_scc1 Lpdone_45
    s_cmp_eq_u64 vcc, exec
    s_cbranch_scc0 Lpoll_44
Lpdone_45:
    s_mov_b64 exec, -1
    s_add_u32 s31, s17, 0
    s_sub_u32 s29, s31, 10
    s_cselect_b32 s31, s31, s29
    s_mul_i32 s31, s31, 2048
    s_add_u32 s18, s31, s25
    s_add_u32 m0, s13, 98304
    s_add_u32 s30, s18, 0
    buffer_load_dwordx4 v4, s[76:79], s30 offen sc1 lds
    s_add_u32 m0, s13, 99328
    s_add_u32 s30, s18, 1024
    buffer_load_dwordx4 v4, s[76:79], s30 offen sc1 lds
    s_add_u32 m0, s13, 100352
    s_add_u32 s30, s18, 20480
    buffer_load_dwordx4 v4, s[76:79], s30 offen sc1 lds
    s_add_u32 m0, s13, 101376
    s_add_u32 s30, s18, 21504
    buffer_load_dwordx4 v4, s[76:79], s30 offen sc1 lds
    s_add_u32 s31, s17, 1
    s_sub_u32 s29, s31, 10
    s_cselect_b32 s31, s31, s29
    s_mul_i32 s31, s31, 2048
    s_add_u32 s18, s31, s25
    s_add_u32 m0, s13, 114688
    s_add_u32 s30, s18, 0
    buffer_load_dwordx4 v4, s[76:79], s30 offen sc1 lds
    s_add_u32 m0, s13, 115712
    s_add_u32 s30, s18, 1024
    buffer_load_dwordx4 v4, s[76:79], s30 offen sc1 lds
    s_add_u32 m0, s13, 116736
    s_add_u32 s30, s18, 20480
    buffer_load_dwordx4 v4, s[76:79], s30 offen sc1 lds
    s_add_u32 m0, s13, 117760
    s_add_u32 s30, s18, 21504
    buffer_load_dwordx4 v4, s[76:79], s30 offen sc1 lds
    s_waitcnt vmcnt(4) lgkmcnt(0)
    s_barrier
    s_add_u32 s31, s17, 2
    s_sub_u32 s29, s31, 10
    s_cselect_b32 s31, s31, s29
    s_mul_i32 s31, s31, 2048
    s_add_u32 s18, s31, s25
    s_add_u32 m0, s13, 131072
    s_add_u32 s30, s18, 0
    buffer_load_dwordx4 v4, s[76:79], s30 offen sc1 lds
    s_add_u32 m0, s13, 132096
    s_add_u32 s30, s18, 1024
    buffer_load_dwordx4 v4, s[76:79], s30 offen sc1 lds
    s_add_u32 m0, s13, 133120
    s_add_u32 s30, s18, 20480
    buffer_load_dwordx4 v4, s[76:79], s30 offen sc1 lds
    s_add_u32 m0, s13, 134144
    s_add_u32 s30, s18, 21504
    buffer_load_dwordx4 v4, s[76:79], s30 offen sc1 lds
    s_waitcnt vmcnt(4)
    s_barrier
    s_add_u32 s31, s17, 3
    s_sub_u32 s29, s31, 10
    s_cselect_b32 s31, s31, s29
    s_mul_i32 s31, s31, 2048
    s_add_u32 s18, s31, s25
    s_add_u32 m0, s13, 98304
    s_add_u32 s30, s18, 0
    buffer_load_dwordx4 v4, s[76:79], s30 offen sc1 lds
    s_add_u32 m0, s13, 99328
    s_add_u32 s30, s18, 1024
    buffer_load_dwordx4 v4, s[76:79], s30 offen sc1 lds
    s_add_u32 m0, s13, 100352
    s_add_u32 s30, s18, 20480
    buffer_load_dwordx4 v4, s[76:79], s30 offen sc1 lds
    s_add_u32 m0, s13, 101376
    s_add_u32 s30, s18, 21504
    buffer_load_dwordx4 v4, s[76:79], s30 offen sc1 lds
    s_add_u32 s31, s17, 4
    s_sub_u32 s29, s31, 10
    s_cselect_b32 s31, s31, s29
    s_mul_i32 s31, s31, 24576
    s_add_u32 s18, s31, s16
    s_add_u32 m0, s15, 0
    s_add_u32 s30, s18, 0
    buffer_load_dwordx4 v4, s[76:79], s30 offen sc1 lds
    s_add_u32 m0, s15, 1024
    s_add_u32 s30, s18, 1024
    buffer_load_dwordx4 v4, s[76:79], s30 offen sc1 lds
    s_add_u32 m0, s15, 2048
    s_add_u32 s30, s18, 2048
    buffer_load_dwordx4 v4, s[76:79], s30 offen sc1 lds
    s_add_u32 m0, s15, 3072
    s_add_u32 s30, s18, 3072
    buffer_load_dwordx4 v4, s[76:79], s30 offen sc1 lds
    s_add_u32 m0, s15, 4096
    s_add_u32 s30, s18, 4096
    buffer_load_dwordx4 v4, s[76:79], s30 offen sc1 lds
    s_add_u32 m0, s15, 5120
    s_add_u32 s30, s18, 5120
    buffer_load_dwordx4 v4, s[76:79], s30 offen sc1 lds
    s_waitcnt vmcnt(10)
    s_barrier
    s_add_u32 s31, s17, 4
    s_sub_u32 s29, s31, 10
    s_cselect_b32 s31, s31, s29
    s_mul_i32 s31, s31, 2048
    s_add_u32 s18, s31, s25
    s_add_u32 m0, s13, 114688
    s_add_u32 s30, s18, 0
    buffer_load_dwordx4 v4, s[76:79], s30 offen sc1 lds
    s_add_u32 m0, s13, 115712
    s_add_u32 s30, s18, 1024
    buffer_load_dwordx4 v4, s[76:79], s30 offen sc1 lds
    s_add_u32 m0, s13, 116736
    s_add_u32 s30, s18, 20480
    buffer_load_dwordx4 v4, s[76:79], s30 offen sc1 lds
    s_add_u32 m0, s13, 117760
    s_add_u32 s30, s18, 21504
    buffer_load_dwordx4 v4, s[76:79], s30 offen sc1 lds
    s_add_u32 s31, s17, 5
    s_sub_u32 s29, s31, 10
    s_cselect_b32 s31, s31, s29
    s_mul_i32 s31, s31, 24576
    s_add_u32 s18, s31, s16
    s_add_u32 m0, s15, 24576
    s_add_u32 s30, s18, 0
    buffer_load_dwordx4 v4, s[76:79], s30 offen sc1 lds
    s_add_u32 m0, s15, 25600
    s_add_u32 s30, s18, 1024
    buffer_load_dwordx4 v4, s[76:79], s30 offen sc1 lds
    s_add_u32 m0, s15, 26624
    s_add_u32 s30, s18, 2048
    buffer_load_dwordx4 v4, s[76:79], s30 offen sc1 lds
    s_add_u32 m0, s15, 27648
    s_add_u32 s30, s18, 3072
    buffer_load_dwordx4 v4, s[76:79], s30 offen sc1 lds
    s_add_u32 m0, s15, 28672
    s_add_u32 s30, s18, 4096
    buffer_load_dwordx4 v4, s[76:79], s30 offen sc1 lds
    s_add_u32 m0, s15, 29696
    s_add_u32 s30, s18, 5120
    buffer_load_dwordx4 v4, s[76:79], s30 offen sc1 lds
    s_waitcnt vmcnt(16)
    s_barrier
    s_add_u32 s31, s17, 5
    s_sub_u32 s29, s31, 10
    s_cselect_b32 s31, s31, s29
    s_mul_i32 s31, s31, 2048
    s_add_u32 s18, s31, s25
    s_add_u32 m0, s13, 131072
    s_add_u32 s30, s18, 0
    buffer_load_dwordx4 v4, s[76:79], s30 offen sc1 lds
    s_add_u32 m0, s13, 132096
    s_add_u32 s30, s18, 1024
    buffer_load_dwordx4 v4, s[76:79], s30 offen sc1 lds
    s_add_u32 m0, s13, 133120
    s_add_u32 s30, s18, 20480
    buffer_load_dwordx4 v4, s[76:79], s30 offen sc1 lds
    s_add_u32 m0, s13, 134144
    s_add_u32 s30, s18, 21504
    buffer_load_dwordx4 v4, s[76:79], s30 offen sc1 lds
    s_add_u32 s31, s17, 6
    s_sub_u32 s29, s31, 10
    s_cselect_b32 s31, s31, s29
    s_mul_i32 s31, s31, 24576
    s_add_u32 s18, s31, s16
    s_add_u32 m0, s15, 49152
    s_add_u32 s30, s18, 0
    buffer_load_dwordx4 v4, s[76:79], s30 offen sc1 lds
    s_add_u32 m0, s15, 50176
    s_add_u32 s30, s18, 1024
    buffer_load_dwordx4 v4, s[76:79], s30 offen sc1 lds
    s_add_u32 m0, s15, 51200
    s_add_u32 s30, s18, 2048
    buffer_load_dwordx4 v4, s[76:79], s30 offen sc1 lds
    s_add_u32 m0, s15, 52224
    s_add_u32 s30, s18, 3072
    buffer_load_dwordx4 v4, s[76:79], s30 offen sc1 lds
    s_add_u32 m0, s15, 53248
    s_add_u32 s30, s18, 4096
    buffer_load_dwordx4 v4, s[76:79], s30 offen sc1 lds
    s_add_u32 m0, s15, 54272
    s_add_u32 s30, s18, 5120
    buffer_load_dwordx4 v4, s[76:79], s30 offen sc1 lds
    s_waitcnt vmcnt(16)
    s_waitcnt vmcnt(20)
    s_barrier
    s_add_u32 s31, s17, 6
    s_sub_u32 s29, s31, 10
    s_cselect_b32 s31, s31, s29
    s_mul_i32 s31, s31, 2048
    s_add_u32 s18, s31, s25
    s_add_u32 m0, s13, 98304
    s_add_u32 s30, s18, 0
    buffer_load_dwordx4 v4, s[76:79], s30 offen sc1 lds
    s_add_u32 m0, s13, 99328
    s_add_u32 s30, s18, 1024
    buffer_load_dwordx4 v4, s[76:79], s30 offen sc1 lds
    s_add_u32 m0, s13, 100352
    s_add_u32 s30, s18, 20480
    buffer_load_dwordx4 v4, s[76:79], s30 offen sc1 lds
    s_add_u32 m0, s13, 101376
    s_add_u32 s30, s18, 21504
    buffer_load_dwordx4 v4, s[76:79], s30 offen sc1 lds
    s_add_u32 s31, s17, 7
    s_sub_u32 s29, s31, 10
    s_cselect_b32 s31, s31, s29
    s_mul_i32 s31, s31, 24576
    s_add_u32 s18, s31, s16
    s_add_u32 m0, s15, 73728
    s_add_u32 s30, s18, 0
    buffer_load_dwordx4 v4, s[76:79], s30 offen sc1 lds
    s_add_u32 m0, s15, 74752
    s_add_u32 s30, s18, 1024
    buffer_load_dwordx4 v4, s[76:79], s30 offen sc1 lds
    s_add_u32 m0, s15, 75776
    s_add_u32 s30, s18, 2048
    buffer_load_dwordx4 v4, s[76:79], s30 offen sc1 lds
    s_add_u32 m0, s15, 76800
    s_add_u32 s30, s18, 3072
    buffer_load_dwordx4 v4, s[76:79], s30 offen sc1 lds
    s_add_u32 m0, s15, 77824
    s_add_u32 s30, s18, 4096
    buffer_load_dwordx4 v4, s[76:79], s30 offen sc1 lds
    s_add_u32 m0, s15, 78848
    s_add_u32 s30, s18, 5120
    buffer_load_dwordx4 v4, s[76:79], s30 offen sc1 lds
    s_waitcnt vmcnt(16)
    s_waitcnt vmcnt(20)
    s_barrier
    s_add_u32 s31, s17, 7
    s_sub_u32 s29, s31, 10
    s_cselect_b32 s31, s31, s29
    s_mul_i32 s31, s31, 2048
    s_add_u32 s18, s31, s25
    s_add_u32 m0, s13, 114688
    s_add_u32 s30, s18, 0
    buffer_load_dwordx4 v4, s[76:79], s30 offen sc1 lds
    s_add_u32 m0, s13, 115712
    s_add_u32 s30, s18, 1024
    buffer_load_dwordx4 v4, s[76:79], s30 offen sc1 lds
    s_add_u32 m0, s13, 116736
    s_add_u32 s30, s18, 20480
    buffer_load_dwordx4 v4, s[76:79], s30 offen sc1 lds
    s_add_u32 m0, s13, 117760
    s_add_u32 s30, s18, 21504
    buffer_load_dwordx4 v4, s[76:79], s30 offen sc1 lds
    s_add_u32 s31, s17, 8
    s_sub_u32 s29, s31, 10
    s_cselect_b32 s31, s31, s29
    s_mul_i32 s31, s31, 24576
    s_add_u32 s18, s31, s16
    s_add_u32 m0, s15, 0
    s_add_u32 s30, s18, 0
    buffer_load_dwordx4 v4, s[76:79], s30 offen sc1 lds
    s_add_u32 m0, s15, 1024
    s_add_u32 s30, s18, 1024
    buffer_load_dwordx4 v4, s[76:79], s30 offen sc1 lds
    s_add_u32 m0, s15, 2048
    s_add_u32 s30, s18, 2048
    buffer_load_dwordx4 v4, s[76:79], s30 offen sc1 lds
    s_add_u32 m0, s15, 3072
    s_add_u32 s30, s18, 3072
    buffer_load_dwordx4 v4, s[76:79], s30 offen sc1 lds
    s_add_u32 m0, s15, 4096
    s_add_u32 s30, s18, 4096
    buffer_load_dwordx4 v4, s[76:79], s30 offen sc1 lds
    s_add_u32 m0, s15, 5120
    s_add_u32 s30, s18, 5120
    buffer_load_dwordx4 v4, s[76:79], s30 offen sc1 lds
    s_waitcnt vmcnt(16)
    s_waitcnt vmcnt(20)
    s_barrier
    s_add_u32 s31, s17, 8
    s_sub_u32 s29, s31, 10
    s_cselect_b32 s31, s31, s29
    s_mul_i32 s31, s31, 2048
    s_add_u32 s18, s31, s25
    s_add_u32 m0, s13, 131072
    s_add_u32 s30, s18, 0
    buffer_load_dwordx4 v4, s[76:79], s30 offen sc1 lds
    s_add_u32 m0, s13, 132096
    s_add_u32 s30, s18, 1024
    buffer_load_dwordx4 v4, s[76:79], s30 offen sc1 lds
    s_add_u32 m0, s13, 133120
    s_add_u32 s30, s18, 20480
    buffer_load_dwordx4 v4, s[76:79], s30 offen sc1 lds
    s_add_u32 m0, s13, 134144
    s_add_u32 s30, s18, 21504
    buffer_load_dwordx4 v4, s[76:79], s30 offen sc1 lds
    s_add_u32 s31, s17, 9
    s_sub_u32 s29, s31, 10
    s_cselect_b32 s31, s31, s29
    s_mul_i32 s31, s31, 24576
    s_add_u32 s18, s31, s16
    s_add_u32 m0, s15, 24576
    s_add_u32 s30, s18, 0
    buffer_load_dwordx4 v4, s[76:79], s30 offen sc1 lds
    s_add_u32 m0, s15, 25600
    s_add_u32 s30, s18, 1024
    buffer_load_dwordx4 v4, s[76:79], s30 offen sc1 lds
    s_add_u32 m0, s15, 26624
    s_add_u32 s30, s18, 2048
    buffer_load_dwordx4 v4, s[76:79], s30 offen sc1 lds
    s_add_u32 m0, s15, 27648
    s_add_u32 s30, s18, 3072
    buffer_load_dwordx4 v4, s[76:79], s30 offen sc1 lds
    s_add_u32 m0, s15, 28672
    s_add_u32 s30, s18, 4096
    buffer_load_dwordx4 v4, s[76:79], s30 offen sc1 lds
    s_add_u32 m0, s15, 29696
    s_add_u32 s30, s18, 5120
    buffer_load_dwordx4 v4, s[76:79], s30 offen sc1 lds
    s_waitcnt vmcnt(16)
    s_waitcnt vmcnt(20)
    s_barrier
    s_add_u32 s31, s17, 9
    s_sub_u32 s29, s31, 10
    s_cselect_b32 s31, s31, s29
    s_mul_i32 s31, s31, 2048
    s_add_u32 s18, s31, s25
    s_add_u32 m0, s13, 98304
    s_add_u32 s30, s18, 0
    buffer_load_dwordx4 v4, s[76:79], s30 offen sc1 lds
    s_add_u32 m0, s13, 99328
    s_add_u32 s30, s18, 1024
    buffer_load_dwordx4 v4, s[76:79], s30 offen sc1 lds
    s_add_u32 m0, s13, 100352
    s_add_u32 s30, s18, 20480
    buffer_load_dwordx4 v4, s[76:79], s30 offen sc1 lds
    s_add_u32 m0, s13, 101376
    s_add_u32 s30, s18, 21504
    buffer_load_dwordx4 v4, s[76:79], s30 offen sc1 lds
    s_waitcnt vmcnt(0)
    s_waitcnt vmcnt(4)
    s_barrier
    s_lshl_b32 s32, s20, 2
    s_add_u32 s32, s32, s24
    v_and_b32 v223, 15, v0
    v_lshrrev_b32 v224, 4, v0
    s_lshl_b32 s33, s32, 4
    v_add_u32 v216, s33, v223
    v_mul_u32_u24 v225, 1280, v216
    s_mul_i32 s33, s21, 160
    v_add_u32 v225, s33, v225
    v_lshl_add_u32 v217, v224, 4, v225
    v_lshl_add_u32 v218, v224, 3, v225
    s_mul_i32 s33, s32, 20480
    s_mul_i32 s34, s21, 2560
    s_add_u32 s33, s33, s34
    s_add_u32 s33, s33, 10485760
    v_lshlrev_b32 v225, 4, v223
    v_add_u32 v225, s33, v225
    v_lshl_add_u32 v219, v224, 8, v225
    v_lshrrev_b32 v220, 1, v224
    v_lshl_add_u32 v220, v220, 8, v225
    v_and_b32 v225, 1, v224
    v_lshl_add_u32 v220, v225, 3, v220
    buffer_load_dwordx4 v[228:231], v219, s[76:79], 0 offen offset:0 sc1
    buffer_load_dwordx4 v[232:235], v219, s[76:79], 0 offen offset:1024 sc1
    buffer_load_dwordx2 v[236:237], v220, s[76:79], 0 offen offset:2048 sc1
    s_bfe_u32 s19, s2, 0x20003
    s_add_u32 m0, s27, 49152
    s_add_u32 s30, s26, 0
    buffer_load_dwordx4 v4, s[76:79], s30 offen sc1 lds
    s_add_u32 m0, s27, 53248
    s_add_u32 s30, s26, 4096
    buffer_load_dwordx4 v4, s[76:79], s30 offen sc1 lds
    s_add_u32 m0, s27, 57344
    s_add_u32 s30, s26, 8192
    buffer_load_dwordx4 v4, s[76:79], s30 offen sc1 lds
    s_add_u32 m0, s27, 61440
    s_add_u32 s30, s26, 12288
    buffer_load_dwordx4 v4, s[76:79], s30 offen sc1 lds
    s_add_u32 m0, s27, 65536
    s_add_u32 s30, s26, 16384
    buffer_load_dwordx4 v4, s[76:79], s30 offen sc1 lds
    s_add_u32 m0, s27, 69632
    s_add_u32 s30, s26, 20480
    buffer_load_dwordx4 v4, s[76:79], s30 offen sc1 lds
    s_add_u32 m0, s27, 73728
    s_add_u32 s30, s26, 24576
    buffer_load_dwordx4 v4, s[76:79], s30 offen sc1 lds
    s_add_u32 m0, s27, 77824
    s_add_u32 s30, s26, 28672
    buffer_load_dwordx4 v4, s[76:79], s30 offen sc1 lds
    s_add_u32 m0, s27, 81920
    s_add_u32 s30, s26, 32768
    buffer_load_dwordx4 v4, s[76:79], s30 offen sc1 lds
    s_add_u32 m0, s27, 86016
    s_add_u32 s30, s26, 36864
    buffer_load_dwordx4 v4, s[76:79], s30 offen sc1 lds
    s_add_u32 m0, s27, 90112
    s_add_u32 s30, s26, 40960
    buffer_load_dwordx4 v4, s[76:79], s30 offen sc1 lds
    s_add_u32 m0, s27, 94208
    s_add_u32 s30, s26, 45056
    buffer_load_dwordx4 v4, s[76:79], s30 offen sc1 lds
    s_add_u32 m0, s27, 114688
    s_add_u32 s30, s26, 49152
    buffer_load_dwordx4 v4, s[76:79], s30 offen sc1 lds
    s_add_u32 m0, s27, 118784
    s_add_u32 s30, s26, 53248
    buffer_load_dwordx4 v4, s[76:79], s30 offen sc1 lds
    s_add_u32 m0, s27, 122880
    s_add_u32 s30, s26, 57344
    buffer_load_dwordx4 v4, s[76:79], s30 offen sc1 lds
    s_add_u32 m0, s27, 126976
    s_add_u32 s30, s26, 61440
    buffer_load_dwordx4 v4, s[76:79], s30 offen sc1 lds
    s_add_u32 m0, s27, 147456
    s_add_u32 s30, s26, 65536
    buffer_load_dwordx4 v4, s[76:79], s30 offen sc1 lds
    s_add_u32 m0, s27, 151552
    s_add_u32 s30, s26, 69632
    buffer_load_dwordx4 v4, s[76:79], s30 offen sc1 lds
    s_add_u32 m0, s27, 155648
    s_add_u32 s30, s26, 73728
    buffer_load_dwordx4 v4, s[76:79], s30 offen sc1 lds
    s_add_u32 m0, s27, 159744
    s_add_u32 s30, s26, 77824
    buffer_load_dwordx4 v4, s[76:79], s30 offen sc1 lds
    s_barrier
    s_add_u32 m0, s27, 0
    s_add_u32 s30, s26, 81920
    buffer_load_dwordx4 v4, s[76:79], s30 offen sc1 lds
    s_add_u32 m0, s27, 4096
    s_add_u32 s30, s26, 86016
    buffer_load_dwordx4 v4, s[76:79], s30 offen sc1 lds
    s_add_u32 m0, s27, 8192
    s_add_u32 s30, s26, 90112
    buffer_load_dwordx4 v4, s[76:79], s30 offen sc1 lds
    s_add_u32 m0, s27, 12288
    s_add_u32 s30, s26, 94208
    buffer_load_dwordx4 v4, s[76:79], s30 offen sc1 lds
    s_add_u32 m0, s27, 16384
    s_add_u32 s30, s26, 98304
    buffer_load_dwordx4 v4, s[76:79], s30 offen sc1 lds
    s_add_u32 m0, s27, 20480
    s_add_u32 s30, s26, 102400
    buffer_load_dwordx4 v4, s[76:79], s30 offen sc1 lds
    s_add_u32 m0, s27, 24576
    s_add_u32 s30, s26, 106496
    buffer_load_dwordx4 v4, s[76:79], s30 offen sc1 lds
    s_add_u32 m0, s27, 28672
    s_add_u32 s30, s26, 110592
    buffer_load_dwordx4 v4, s[76:79], s30 offen sc1 lds
    s_add_u32 m0, s27, 32768
    s_add_u32 s30, s26, 114688
    buffer_load_dwordx4 v4, s[76:79], s30 offen sc1 lds
    s_add_u32 m0, s27, 36864
    s_add_u32 s30, s26, 118784
    buffer_load_dwordx4 v4, s[76:79], s30 offen sc1 lds
    s_add_u32 m0, s27, 40960
    s_add_u32 s30, s26, 122880
    buffer_load_dwordx4 v4, s[76:79], s30 offen sc1 lds
    s_add_u32 m0, s27, 45056
    s_add_u32 s30, s26, 126976
    buffer_load_dwordx4 v4, s[76:79], s30 offen sc1 lds
    s_add_u32 m0, s27, 98304
    s_add_u32 s30, s26, 131072
    buffer_load_dwordx4 v4, s[76:79], s30 offen sc1 lds
    s_add_u32 m0, s27, 102400
    s_add_u32 s30, s26, 135168
    buffer_load_dwordx4 v4, s[76:79], s30 offen sc1 lds
    s_add_u32 m0, s27, 106496
    s_add_u32 s30, s26, 139264
    buffer_load_dwordx4 v4, s[76:79], s30 offen sc1 lds
    s_add_u32 m0, s27, 110592
    s_add_u32 s30, s26, 143360
    buffer_load_dwordx4 v4, s[76:79], s30 offen sc1 lds
    s_add_u32 m0, s27, 131072
    s_add_u32 s30, s26, 147456
    buffer_load_dwordx4 v4, s[76:79], s30 offen sc1 lds
    s_add_u32 m0, s27, 135168
    s_add_u32 s30, s26, 151552
    buffer_load_dwordx4 v4, s[76:79], s30 offen sc1 lds
    s_add_u32 m0, s27, 139264
    s_add_u32 s30, s26, 155648
    buffer_load_dwordx4 v4, s[76:79], s30 offen sc1 lds
    s_add_u32 m0, s27, 143360
    s_add_u32 s30, s26, 159744
    buffer_load_dwordx4 v4, s[76:79], s30 offen sc1 lds
    v_mov_b32 v5, v4
    v_add_u32 v6, 61440, v4
    v_add_u32 v46, 122880, v4
    s_lshl_b32 s25, s20, 2
    s_add_u32 s25, s25, s24
    s_mul_i32 s25, s25, 49152
    s_add_u32 s25, s25, 13107200
    v_mul_u32_u24 v222, 3072, v0
    s_add_u32 s33, s25, 0
    v_add_u32 v222, s33, v222
    s_mov_b64 exec, 0xffff
    s_mov_b32 s54, 262144
Lpoll_47:
    buffer_load_dword v8, v222, s[76:79], 0 offen sc1
    s_waitcnt vmcnt(0)
    v_cmp_ne_u32 vcc, -1, v8
    s_sub_u32 s54, s54, 1
    s_cbranch_scc1 Lpdone_48
    s_cmp_eq_u64 vcc, exec
    s_cbranch_scc0 Lpoll_47
Lpdone_48:
    s_mov_b64 exec, -1
    s_waitcnt vmcnt(0) lgkmcnt(0)
    v_lshlrev_b32 v16, 16, v228
    v_and_b32 v17, 0xffff0000, v228
    v_lshlrev_b32 v18, 16, v229
    v_and_b32 v19, 0xffff0000, v229
    v_lshlrev_b32 v20, 16, v230
    v_and_b32 v21, 0xffff0000, v230
    v_lshlrev_b32 v22, 16, v231
    v_and_b32 v23, 0xffff0000, v231
    v_lshlrev_b32 v24, 16, v232
    v_and_b32 v25, 0xffff0000, v232
    v_lshlrev_b32 v26, 16, v233
    v_and_b32 v27, 0xffff0000, v233
    v_lshlrev_b32 v28, 16, v234
    v_and_b32 v29, 0xffff0000, v234
    v_lshlrev_b32 v30, 16, v235
    v_and_b32 v31, 0xffff0000, v235
    v_lshlrev_b32 v32, 16, v236
    v_and_b32 v33, 0xffff0000, v236
    v_lshlrev_b32 v34, 16, v237
    v_and_b32 v35, 0xffff0000, v237
    s_barrier
    s_setprio 1
    ds_read_b128 v[48:51], v5 offset:49152
    ds_read_b128 v[52:55], v5 offset:50176
    ds_read_b128 v[56:59], v5 offset:51200
    ds_read_b128 v[60:63], v5 offset:52224
    ds_read_b128 v[64:67], v5 offset:53248
    ds_read_b128 v[68:71], v5 offset:54272
    ds_read_b128 v[72:75], v5 offset:55296
    ds_read_b128 v[76:79], v5 offset:56320
    ds_read_b128 v[80:83], v5 offset:57344
    ds_read_b128 v[84:87], v5 offset:58368
    s_add_u32 s14, s25, 0
    buffer_load_dwordx4 v[108:111], v4, s[76:79], s14 offen sc1
    s_add_u32 s14, s25, 3072
    buffer_load_dwordx4 v[112:115], v4, s[76:79], s14 offen sc1
    s_add_u32 s14, s25, 6144
    buffer_load_dwordx4 v[116:119], v4, s[76:79], s14 offen sc1
    s_add_u32 s14, s25, 9216
    buffer_load_dwordx4 v[120:123], v4, s[76:79], s14 offen sc1
    s_add_u32 s14, s25, 12288
    buffer_load_dwordx4 v[124:127], v4, s[76:79], s14 offen sc1
    s_add_u32 s14, s25, 15360
    buffer_load_dwordx4 v[128:131], v4, s[76:79], s14 offen sc1
    s_waitcnt vmcnt(5) lgkmcnt(5)
    v_mfma_f32_16x16x32_bf16 v[16:19], v[48:51], v[108:111], v[16:19]
    ds_read_b128 v[88:91], v5 offset:59392
    v_mfma_f32_16x16x32_bf16 v[20:23], v[52:55], v[108:111], v[20:23]
    ds_read_b128 v[92:95], v5 offset:60416
    v_mfma_f32_16x16x32_bf16 v[24:27], v[56:59], v[108:111], v[24:27]
    ds_read_b128 v[96:99], v6 offset:0
    v_mfma_f32_16x16x32_bf16 v[28:31], v[60:63], v[108:111], v[28:31]
    ds_read_b128 v[100:103], v6 offset:1024
    v_mfma_f32_16x16x32_bf16 v[32:35], v[64:67], v[108:111], v[32:35]
    ds_read_b128 v[104:107], v6 offset:2048
    s_add_u32 s14, s25, 18432
    buffer_load_dwordx4 v[132:135], v4, s[76:79], s14 offen sc1
    s_waitcnt vmcnt(5) lgkmcnt(5)
    v_mfma_f32_16x16x32_bf16 v[16:19], v[68:71], v[112:115], v[16:19]
    ds_read_b128 v[48:51], v6 offset:3072
    v_mfma_f32_16x16x32_bf16 v[20:23], v[72:75], v[112:115], v[20:23]
    ds_read_b128 v[52:55], v6 offset:4096
    v_mfma_f32_16x16x32_bf16 v[24:27], v[76:79], v[112:115], v[24:27]
    ds_read_b128 v[56:59], v6 offset:5120
    v_mfma_f32_16x16x32_bf16 v[28:31], v[80:83], v[112:115], v[28:31]
    ds_read_b128 v[60:63], v6 offset:6144
    v_mfma_f32_16x16x32_bf16 v[32:35], v[84:87], v[112:115], v[32:35]
    ds_read_b128 v[64:67], v6 offset:7168
    s_add_u32 s14, s25, 21504
    buffer_load_dwordx4 v[136:139], v4, s[76:79], s14 offen sc1
    s_waitcnt vmcnt(5) lgkmcnt(5)
    v_mfma_f32_16x16x32_bf16 v[16:19], v[88:91], v[116:119], v[16:19]
    ds_read_b128 v[68:71], v6 offset:8192
    v_mfma_f32_16x16x32_bf16 v[20:23], v[92:95], v[116:119], v[20:23]
    ds_read_b128 v[72:75], v6 offset:9216
    v_mfma_f32_16x16x32_bf16 v[24:27], v[96:99], v[116:119], v[24:27]
    ds_read_b128 v[76:79], v6 offset:10240
    v_mfma_f32_16x16x32_bf16 v[28:31], v[100:103], v[116:119], v[28:31]
    ds_read_b128 v[80:83], v6 offset:11264
    v_mfma_f32_16x16x32_bf16 v[32:35], v[104:107], v[116:119], v[32:35]
    ds_read_b128 v[84:87], v6 offset:12288
    s_add_u32 s14, s25, 24576
    buffer_load_dwordx4 v[140:143], v4, s[76:79], s14 offen sc1
    s_waitcnt vmcnt(5) lgkmcnt(5)
    v_mfma_f32_16x16x32_bf16 v[16:19], v[48:51], v[120:123], v[16:19]
    ds_read_b128 v[88:91], v6 offset:13312
    v_mfma_f32_16x16x32_bf16 v[20:23], v[52:55], v[120:123], v[20:23]
    ds_read_b128 v[92:95], v6 offset:14336
    v_mfma_f32_16x16x32_bf16 v[24:27], v[56:59], v[120:123], v[24:27]
    ds_read_b128 v[96:99], v6 offset:15360
    v_mfma_f32_16x16x32_bf16 v[28:31], v[60:63], v[120:123], v[28:31]
    ds_read_b128 v[100:103], v6 offset:16384
    v_mfma_f32_16x16x32_bf16 v[32:35], v[64:67], v[120:123], v[32:35]
    ds_read_b128 v[104:107], v6 offset:17408
    s_add_u32 s14, s25, 27648
    buffer_load_dwordx4 v[144:147], v4, s[76:79], s14 offen sc1
    s_waitcnt vmcnt(5) lgkmcnt(5)
    v_mfma_f32_16x16x32_bf16 v[16:19], v[68:71], v[124:127], v[16:19]
    ds_read_b128 v[48:51], v6 offset:18432
    v_mfma_f32_16x16x32_bf16 v[20:23], v[72:75], v[124:127], v[20:23]
    ds_read_b128 v[52:55], v6 offset:19456
    v_mfma_f32_16x16x32_bf16 v[24:27], v[76:79], v[124:127], v[24:27]
    ds_read_b128 v[56:59], v6 offset:20480
    v_mfma_f32_16x16x32_bf16 v[28:31], v[80:83], v[124:127], v[28:31]
    ds_read_b128 v[60:63], v6 offset:21504
    v_mfma_f32_16x16x32_bf16 v[32:35], v[84:87], v[124:127], v[32:35]
    ds_read_b128 v[64:67], v6 offset:22528
    s_add_u32 s14, s25, 30720
    buffer_load_dwordx4 v[148:151], v4, s[76:79], s14 offen sc1
    s_waitcnt vmcnt(5) lgkmcnt(5)
    v_mfma_f32_16x16x32_bf16 v[16:19], v[88:91], v[128:131], v[16:19]
    ds_read_b128 v[68:71], v6 offset:23552
    v_mfma_f32_16x16x32_bf16 v[20:23], v[92:95], v[128:131], v[20:23]
    ds_read_b128 v[72:75], v6 offset:24576
    v_mfma_f32_16x16x32_bf16 v[24:27], v[96:99], v[128:131], v[24:27]
    ds_read_b128 v[76:79], v6 offset:25600
    v_mfma_f32_16x16x32_bf16 v[28:31], v[100:103], v[128:131], v[28:31]
    ds_read_b128 v[80:83], v6 offset:26624
    v_mfma_f32_16x16x32_bf16 v[32:35], v[104:107], v[128:131], v[32:35]
    ds_read_b128 v[84:87], v6 offset:27648
    s_add_u32 s14, s25, 33792
    buffer_load_dwordx4 v[152:155], v4, s[76:79], s14 offen sc1
    s_waitcnt vmcnt(5) lgkmcnt(5)
    v_mfma_f32_16x16x32_bf16 v[16:19], v[48:51], v[132:135], v[16:19]
    ds_read_b128 v[88:91], v6 offset:28672
    v_mfma_f32_16x16x32_bf16 v[20:23], v[52:55], v[132:135], v[20:23]
    ds_read_b128 v[92:95], v6 offset:29696
    v_mfma_f32_16x16x32_bf16 v[24:27], v[56:59], v[132:135], v[24:27]
    ds_read_b128 v[96:99], v6 offset:30720
    v_mfma_f32_16x16x32_bf16 v[28:31], v[60:63], v[132:135], v[28:31]
    ds_read_b128 v[100:103], v6 offset:31744
    v_mfma_f32_16x16x32_bf16 v[32:35], v[64:67], v[132:135], v[32:35]
    ds_read_b128 v[104:107], v6 offset:32768
    s_add_u32 s14, s25, 36864
    buffer_load_dwordx4 v[156:159], v4, s[76:79], s14 offen sc1
    s_waitcnt vmcnt(5) lgkmcnt(5)
    v_mfma_f32_16x16x32_bf16 v[16:19], v[68:71], v[136:139], v[16:19]
    ds_read_b128 v[48:51], v6 offset:33792
    v_mfma_f32_16x16x32_bf16 v[20:23], v[72:75], v[136:139], v[20:23]
    ds_read_b128 v[52:55], v6 offset:34816
    v_mfma_f32_16x16x32_bf16 v[24:27], v[76:79], v[136:139], v[24:27]
    ds_read_b128 v[56:59], v6 offset:35840
    v_mfma_f32_16x16x32_bf16 v[28:31], v[80:83], v[136:139], v[28:31]
    ds_read_b128 v[60:63], v6 offset:53248
    v_mfma_f32_16x16x32_bf16 v[32:35], v[84:87], v[136:139], v[32:35]
    ds_read_b128 v[64:67], v6 offset:54272
    s_add_u32 s14, s25, 39936
    buffer_load_dwordx4 v[160:163], v4, s[76:79], s14 offen sc1
    s_waitcnt vmcnt(5) lgkmcnt(5)
    v_mfma_f32_16x16x32_bf16 v[16:19], v[88:91], v[140:143], v[16:19]
    ds_read_b128 v[68:71], v6 offset:55296
    v_mfma_f32_16x16x32_bf16 v[20:23], v[92:95], v[140:143], v[20:23]
    ds_read_b128 v[72:75], v6 offset:56320
    v_mfma_f32_16x16x32_bf16 v[24:27], v[96:99], v[140:143], v[24:27]
    ds_read_b128 v[76:79], v6 offset:57344
    v_mfma_f32_16x16x32_bf16 v[28:31], v[100:103], v[140:143], v[28:31]
    ds_read_b128 v[80:83], v6 offset:58368
    v_mfma_f32_16x16x32_bf16 v[32:35], v[104:107], v[140:143], v[32:35]
    ds_read_b128 v[84:87], v6 offset:59392
    s_add_u32 s14, s25, 43008
    buffer_load_dwordx4 v[164:167], v4, s[76:79], s14 offen sc1
    s_waitcnt vmcnt(5) lgkmcnt(5)
    v_mfma_f32_16x16x32_bf16 v[16:19], v[48:51], v[144:147], v[16:19]
    ds_read_b128 v[88:91], v6 offset:60416
    v_mfma_f32_16x16x32_bf16 v[20:23], v[52:55], v[144:147], v[20:23]
    ds_read_b128 v[92:95], v46 offset:0
    v_mfma_f32_16x16x32_bf16 v[24:27], v[56:59], v[144:147], v[24:27]
    ds_read_b128 v[96:99], v46 offset:1024
    v_mfma_f32_16x16x32_bf16 v[28:31], v[60:63], v[144:147], v[28:31]
    ds_read_b128 v[100:103], v46 offset:2048
    v_mfma_f32_16x16x32_bf16 v[32:35], v[64:67], v[144:147], v[32:35]
    ds_read_b128 v[104:107], v46 offset:3072
    s_add_u32 s14, s25, 46080
    buffer_load_dwordx4 v[168:171], v4, s[76:79], s14 offen sc1
    s_waitcnt vmcnt(5) lgkmcnt(5)
    v_mfma_f32_16x16x32_bf16 v[16:19], v[68:71], v[148:151], v[16:19]
    ds_read_b128 v[48:51], v46 offset:4096
    v_mfma_f32_16x16x32_bf16 v[20:23], v[72:75], v[148:151], v[20:23]
    ds_read_b128 v[52:55], v46 offset:5120
    v_mfma_f32_16x16x32_bf16 v[24:27], v[76:79], v[148:151], v[24:27]
    ds_read_b128 v[56:59], v46 offset:6144
    v_mfma_f32_16x16x32_bf16 v[28:31], v[80:83], v[148:151], v[28:31]
    ds_read_b128 v[60:63], v46 offset:7168
    v_mfma_f32_16x16x32_bf16 v[32:35], v[84:87], v[148:151], v[32:35]
    ds_read_b128 v[64:67], v46 offset:24576
    s_add_u32 s14, s25, 1024
    buffer_load_dwordx4 v[172:175], v4, s[76:79], s14 offen sc1
    s_waitcnt vmcnt(5) lgkmcnt(5)
    v_mfma_f32_16x16x32_bf16 v[16:19], v[88:91], v[152:155], v[16:19]
    ds_read_b128 v[68:71], v46 offset:25600
    v_mfma_f32_16x16x32_bf16 v[20:23], v[92:95], v[152:155], v[20:23]
    ds_read_b128 v[72:75], v46 offset:26624
    v_mfma_f32_16x16x32_bf16 v[24:27], v[96:99], v[152:155], v[24:27]
    ds_read_b128 v[76:79], v46 offset:27648
    v_mfma_f32_16x16x32_bf16 v[28:31], v[100:103], v[152:155], v[28:31]
    ds_read_b128 v[80:83], v46 offset:28672
    v_mfma_f32_16x16x32_bf16 v[32:35], v[104:107], v[152:155], v[32:35]
    ds_read_b128 v[84:87], v46 offset:29696
    s_add_u32 s14, s25, 4096
    buffer_load_dwordx4 v[176:179], v4, s[76:79], s14 offen sc1
    s_waitcnt vmcnt(5) lgkmcnt(5)
    v_mfma_f32_16x16x32_bf16 v[16:19], v[48:51], v[156:159], v[16:19]
    ds_read_b128 v[88:91], v46 offset:30720
    v_mfma_f32_16x16x32_bf16 v[20:23], v[52:55], v[156:159], v[20:23]
    ds_read_b128 v[92:95], v46 offset:31744
    v_mfma_f32_16x16x32_bf16 v[24:27], v[56:59], v[156:159], v[24:27]
    ds_read_b128 v[96:99], v46 offset:32768
    v_mfma_f32_16x16x32_bf16 v[28:31], v[60:63], v[156:159], v[28:31]
    ds_read_b128 v[100:103], v46 offset:33792
    v_mfma_f32_16x16x32_bf16 v[32:35], v[64:67], v[156:159], v[32:35]
    ds_read_b128 v[104:107], v46 offset:34816
    s_add_u32 s14, s25, 7168
    buffer_load_dwordx4 v[180:183], v4, s[76:79], s14 offen sc1
    s_waitcnt vmcnt(5) lgkmcnt(5)
    v_mfma_f32_16x16x32_bf16 v[16:19], v[68:71], v[160:163], v[16:19]
    ds_read_b128 v[48:51], v46 offset:35840
    v_mfma_f32_16x16x32_bf16 v[20:23], v[72:75], v[160:163], v[20:23]
    ds_read_b128 v[52:55], v46 offset:36864
    v_mfma_f32_16x16x32_bf16 v[24:27], v[76:79], v[160:163], v[24:27]
    ds_read_b128 v[56:59], v46 offset:37888
    v_mfma_f32_16x16x32_bf16 v[28:31], v[80:83], v[160:163], v[28:31]
    ds_read_b128 v[60:63], v46 offset:38912
    v_mfma_f32_16x16x32_bf16 v[32:35], v[84:87], v[160:163], v[32:35]
    ds_read_b128 v[64:67], v46 offset:39936
    s_add_u32 s14, s25, 10240
    buffer_load_dwordx4 v[184:187], v4, s[76:79], s14 offen sc1
    s_waitcnt lgkmcnt(0)
    s_barrier
    s_waitcnt vmcnt(5)
    v_mfma_f32_16x16x32_bf16 v[16:19], v[88:91], v[164:167], v[16:19]
    ds_read_b128 v[68:71], v5 offset:0
    v_mfma_f32_16x16x32_bf16 v[20:23], v[92:95], v[164:167], v[20:23]
    ds_read_b128 v[72:75], v5 offset:1024
    v_mfma_f32_16x16x32_bf16 v[24:27], v[96:99], v[164:167], v[24:27]
    ds_read_b128 v[76:79], v5 offset:2048
    v_mfma_f32_16x16x32_bf16 v[28:31], v[100:103], v[164:167], v[28:31]
    ds_read_b128 v[80:83], v5 offset:3072
    v_mfma_f32_16x16x32_bf16 v[32:35], v[104:107], v[164:167], v[32:35]
    ds_read_b128 v[84:87], v5 offset:4096
    s_add_u32 s14, s25, 13312
    buffer_load_dwordx4 v[188:191], v4, s[76:79], s14 offen sc1
    s_add_u32 m0, s27, 49152
    s_add_u32 s30, s26, 163840
    buffer_load_dwordx4 v4, s[76:79], s30 offen sc1 lds
    s_add_u32 m0, s27, 53248
    s_add_u32 s30, s26, 167936
    buffer_load_dwordx4 v4, s[76:79], s30 offen sc1 lds
    s_add_u32 m0, s27, 57344
    s_add_u32 s30, s26, 172032
    buffer_load_dwordx4 v4, s[76:79], s30 offen sc1 lds
    s_waitcnt vmcnt(8) lgkmcnt(5)
    v_mfma_f32_16x16x32_bf16 v[16:19], v[48:51], v[168:171], v[16:19]
    ds_read_b128 v[88:91], v5 offset:5120
    v_mfma_f32_16x16x32_bf16 v[20:23], v[52:55], v[168:171], v[20:23]
    ds_read_b128 v[92:95], v5 offset:6144
    v_mfma_f32_16x16x32_bf16 v[24:27], v[56:59], v[168:171], v[24:27]
    ds_read_b128 v[96:99], v5 offset:7168
    v_mfma_f32_16x16x32_bf16 v[28:31], v[60:63], v[168:171], v[28:31]
    ds_read_b128 v[100:103], v5 offset:8192
    v_mfma_f32_16x16x32_bf16 v[32:35], v[64:67], v[168:171], v[32:35]
    ds_read_b128 v[104:107], v5 offset:9216
    s_add_u32 s14, s25, 16384
    buffer_load_dwordx4 v[192:195], v4, s[76:79], s14 offen sc1
    s_add_u32 m0, s27, 61440
    s_add_u32 s30, s26, 176128
    buffer_load_dwordx4 v4, s[76:79], s30 offen sc1 lds
    s_add_u32 m0, s27, 65536
    s_add_u32 s30, s26, 180224
    buffer_load_dwordx4 v4, s[76:79], s30 offen sc1 lds
    s_add_u32 m0, s27, 69632
    s_add_u32 s30, s26, 184320
    buffer_load_dwordx4 v4, s[76:79], s30 offen sc1 lds
    s_waitcnt vmcnt(11) lgkmcnt(5)
    v_mfma_f32_16x16x32_bf16 v[16:19], v[68:71], v[172:175], v[16:19]
    ds_read_b128 v[48:51], v5 offset:10240
    v_mfma_f32_16x16x32_bf16 v[20:23], v[72:75], v[172:175], v[20:23]
    ds_read_b128 v[52:55], v5 offset:11264
    v_mfma_f32_16x16x32_bf16 v[24:27], v[76:79], v[172:175], v[24:27]
    ds_read_b128 v[56:59], v5 offset:12288
    v_mfma_f32_16x16x32_bf16 v[28:31], v[80:83], v[172:175], v[28:31]
    ds_read_b128 v[60:63], v5 offset:13312
    v_mfma_f32_16x16x32_bf16 v[32:35], v[84:87], v[172:175], v[32:35]
    ds_read_b128 v[64:67], v5 offset:14336
    s_add_u32 s14, s25, 19456
    buffer_load_dwordx4 v[196:199], v4, s[76:79], s14 offen sc1
    s_add_u32 m0, s27, 73728
    s_add_u32 s30, s26, 188416
    buffer_load_dwordx4 v4, s[76:79], s30 offen sc1 lds
    s_add_u32 m0, s27, 77824
    s_add_u32 s30, s26, 192512
    buffer_load_dwordx4 v4, s[76:79], s30 offen sc1 lds
    s_add_u32 m0, s27, 81920
    s_add_u32 s30, s26, 196608
    buffer_load_dwordx4 v4, s[76:79], s30 offen sc1 lds
    s_waitcnt vmcnt(14) lgkmcnt(5)
    v_mfma_f32_16x16x32_bf16 v[16:19], v[88:91], v[176:179], v[16:19]
    ds_read_b128 v[68:71], v5 offset:15360
    v_mfma_f32_16x16x32_bf16 v[20:23], v[92:95], v[176:179], v[20:23]
    ds_read_b128 v[72:75], v5 offset:16384
    v_mfma_f32_16x16x32_bf16 v[24:27], v[96:99], v[176:179], v[24:27]
    ds_read_b128 v[76:79], v5 offset:17408
    v_mfma_f32_16x16x32_bf16 v[28:31], v[100:103], v[176:179], v[28:31]
    ds_read_b128 v[80:83], v5 offset:18432
    v_mfma_f32_16x16x32_bf16 v[32:35], v[104:107], v[176:179], v[32:35]
    ds_read_b128 v[84:87], v5 offset:19456
    s_add_u32 s14, s25, 22528
    buffer_load_dwordx4 v[200:203], v4, s[76:79], s14 offen sc1
    s_add_u32 m0, s27, 86016
    s_add_u32 s30, s26, 200704
    buffer_load_dwordx4 v4, s[76:79], s30 offen sc1 lds
    s_add_u32 m0, s27, 90112
    s_add_u32 s30, s26, 204800
    buffer_load_dwordx4 v4, s[76:79], s30 offen sc1 lds
    s_add_u32 m0, s27, 94208
    s_add_u32 s30, s26, 208896
    buffer_load_dwordx4 v4, s[76:79], s30 offen sc1 lds
    s_waitcnt vmcnt(17) lgkmcnt(5)
    v_mfma_f32_16x16x32_bf16 v[16:19], v[48:51], v[180:183], v[16:19]
    ds_read_b128 v[88:91], v5 offset:20480
    v_mfma_f32_16x16x32_bf16 v[20:23], v[52:55], v[180:183], v[20:23]
    ds_read_b128 v[92:95], v5 offset:21504
    v_mfma_f32_16x16x32_bf16 v[24:27], v[56:59], v[180:183], v[24:27]
    ds_read_b128 v[96:99], v5 offset:22528
    v_mfma_f32_16x16x32_bf16 v[28:31], v[60:63], v[180:183], v[28:31]
    ds_read_b128 v[100:103], v5 offset:23552
    v_mfma_f32_16x16x32_bf16 v[32:35], v[64:67], v[180:183], v[32:35]
    ds_read_b128 v[104:107], v5 offset:24576
    s_add_u32 m0, s27, 114688
    s_add_u32 s30, s26, 212992
    buffer_load_dwordx4 v4, s[76:79], s30 offen sc1 lds
    s_add_u32 m0, s27, 118784
    s_add_u32 s30, s26, 217088
    buffer_load_dwordx4 v4, s[76:79], s30 offen sc1 lds
    s_add_u32 m0, s27, 122880
    s_add_u32 s30, s26, 221184
    buffer_load_dwordx4 v4, s[76:79], s30 offen sc1 lds
    s_waitcnt vmcnt(19) lgkmcnt(5)
    v_mfma_f32_16x16x32_bf16 v[16:19], v[68:71], v[184:187], v[16:19]
    ds_read_b128 v[48:51], v5 offset:25600
    v_mfma_f32_16x16x32_bf16 v[20:23], v[72:75], v[184:187], v[20:23]
    ds_read_b128 v[52:55], v5 offset:26624
    v_mfma_f32_16x16x32_bf16 v[24:27], v[76:79], v[184:187], v[24:27]
    ds_read_b128 v[56:59], v5 offset:27648
    v_mfma_f32_16x16x32_bf16 v[28:31], v[80:83], v[184:187], v[28:31]
    ds_read_b128 v[60:63], v5 offset:28672
    v_mfma_f32_16x16x32_bf16 v[32:35], v[84:87], v[184:187], v[32:35]
    ds_read_b128 v[64:67], v5 offset:29696
    s_add_u32 m0, s27, 126976
    s_add_u32 s30, s26, 225280
    buffer_load_dwordx4 v4, s[76:79], s30 offen sc1 lds
    s_add_u32 m0, s27, 147456
    s_add_u32 s30, s26, 229376
    buffer_load_dwordx4 v4, s[76:79], s30 offen sc1 lds
    s_add_u32 m0, s27, 151552
    s_add_u32 s30, s26, 233472
    buffer_load_dwordx4 v4, s[76:79], s30 offen sc1 lds
    s_waitcnt vmcnt(21) lgkmcnt(5)
    v_mfma_f32_16x16x32_bf16 v[16:19], v[88:91], v[188:191], v[16:19]
    ds_read_b128 v[68:71], v5 offset:30720
    v_mfma_f32_16x16x32_bf16 v[20:23], v[92:95], v[188:191], v[20:23]
    ds_read_b128 v[72:75], v5 offset:31744
    v_mfma_f32_16x16x32_bf16 v[24:27], v[96:99], v[188:191], v[24:27]
    ds_read_b128 v[76:79], v5 offset:32768
    v_mfma_f32_16x16x32_bf16 v[28:31], v[100:103], v[188:191], v[28:31]
    ds_read_b128 v[80:83], v5 offset:33792
    v_mfma_f32_16x16x32_bf16 v[32:35], v[104:107], v[188:191], v[32:35]
    ds_read_b128 v[84:87], v5 offset:34816
    s_add_u32 m0, s27, 155648
    s_add_u32 s30, s26, 237568
    buffer_load_dwordx4 v4, s[76:79], s30 offen sc1 lds
    s_add_u32 m0, s27, 159744
    s_add_u32 s30, s26, 241664
    buffer_load_dwordx4 v4, s[76:79], s30 offen sc1 lds
    s_waitcnt vmcnt(19) lgkmcnt(5)
    v_mfma_f32_16x16x32_bf16 v[16:19], v[48:51], v[192:195], v[16:19]
    ds_read_b128 v[88:91], v5 offset:35840
    v_mfma_f32_16x16x32_bf16 v[20:23], v[52:55], v[192:195], v[20:23]
    ds_read_b128 v[92:95], v5 offset:36864
    v_mfma_f32_16x16x32_bf16 v[24:27], v[56:59], v[192:195], v[24:27]
    ds_read_b128 v[96:99], v5 offset:37888
    v_mfma_f32_16x16x32_bf16 v[28:31], v[60:63], v[192:195], v[28:31]
    ds_read_b128 v[100:103], v5 offset:38912
    v_mfma_f32_16x16x32_bf16 v[32:35], v[64:67], v[192:195], v[32:35]
    ds_read_b128 v[104:107], v5 offset:39936
    s_waitcnt vmcnt(15) lgkmcnt(5)
    v_mfma_f32_16x16x32_bf16 v[16:19], v[68:71], v[196:199], v[16:19]
    v_mfma_f32_16x16x32_bf16 v[20:23], v[72:75], v[196:199], v[20:23]
    v_mfma_f32_16x16x32_bf16 v[24:27], v[76:79], v[196:199], v[24:27]
    v_mfma_f32_16x16x32_bf16 v[28:31], v[80:83], v[196:199], v[28:31]
    v_mfma_f32_16x16x32_bf16 v[32:35], v[84:87], v[196:199], v[32:35]
    s_waitcnt vmcnt(11) lgkmcnt(0)
    v_mfma_f32_16x16x32_bf16 v[16:19], v[88:91], v[200:203], v[16:19]
    v_mfma_f32_16x16x32_bf16 v[20:23], v[92:95], v[200:203], v[20:23]
    v_mfma_f32_16x16x32_bf16 v[24:27], v[96:99], v[200:203], v[24:27]
    v_mfma_f32_16x16x32_bf16 v[28:31], v[100:103], v[200:203], v[28:31]
    v_mfma_f32_16x16x32_bf16 v[32:35], v[104:107], v[200:203], v[32:35]
    s_mul_i32 s31, s24, 5120
    v_add_u32 v47, s31, v4
    s_nop 1
    v_cmp_u_f32 vcc, v16, v16
    s_nop 1
    s_cmp_eq_u64 vcc, 0
    s_cbranch_scc0 L5k1_redo
L5k1_back:
    s_waitcnt vmcnt(10)
    s_barrier
    s_waitcnt vmcnt(0)
    s_barrier
    ds_write_b128 v47, v[16:19] offset:0
    ds_write_b128 v47, v[20:23] offset:1024
    ds_write_b128 v47, v[24:27] offset:2048
    ds_write_b128 v47, v[28:31] offset:3072
    ds_write_b128 v47, v[32:35] offset:4096
    s_waitcnt lgkmcnt(0)
    s_setprio 0
    s_barrier
    s_branch L_fin
L3_comp:
    v_mov_b32 v5, v4
    v_add_u32 v6, 61440, v4
    v_add_u32 v46, 122880, v4
    s_lshl_b32 s25, s20, 2
    s_add_u32 s25, s25, s24
    s_lshl_b32 s25, s25, 14
    s_add_u32 s25, s25, 7864320
    v_lshlrev_b32 v16, 16, v228
    v_and_b32 v17, 0xffff0000, v228
    v_lshlrev_b32 v18, 16, v229
    v_and_b32 v19, 0xffff0000, v229
    v_lshlrev_b32 v20, 16, v230
    v_and_b32 v21, 0xffff0000, v230
    v_lshlrev_b32 v22, 16, v231
    v_and_b32 v23, 0xffff0000, v231
    v_lshlrev_b32 v24, 16, v232
    v_and_b32 v25, 0xffff0000, v232
    v_lshlrev_b32 v26, 16, v233
    v_and_b32 v27, 0xffff0000, v233
    v_lshlrev_b32 v28, 16, v234
    v_and_b32 v29, 0xffff0000, v234
    v_lshlrev_b32 v30, 16, v235
    v_and_b32 v31, 0xffff0000, v235
    v_lshlrev_b32 v32, 16, v236
    v_and_b32 v33, 0xffff0000, v236
    v_lshlrev_b32 v34, 16, v237
    v_and_b32 v35, 0xffff0000, v237
    s_barrier
    ds_read_b128 v[48:51], v5 offset:12288
    ds_read_b128 v[52:55], v5 offset:13312
    ds_read_b128 v[56:59], v5 offset:14336
    ds_read_b128 v[60:63], v5 offset:15360
    ds_read_b128 v[64:67], v5 offset:16384
    ds_read_b128 v[68:71], v5 offset:17408
    ds_read_b128 v[72:75], v5 offset:18432
    ds_read_b128 v[76:79], v5 offset:19456
    ds_read_b128 v[80:83], v5 offset:20480
    ds_read_b128 v[84:87], v5 offset:21504
    s_add_u32 s14, s25, 0
    buffer_load_dwordx4 v[108:111], v4, s[76:79], s14 offen offset:0 sc1
    buffer_load_dwordx4 v[112:115], v4, s[76:79], s14 offen offset:1024 sc1
    buffer_load_dwordx4 v[116:119], v4, s[76:79], s14 offen offset:2048 sc1
    buffer_load_dwordx4 v[120:123], v4, s[76:79], s14 offen offset:3072 sc1
    s_add_u32 s14, s25, 4096
    buffer_load_dwordx4 v[124:127], v4, s[76:79], s14 offen offset:0 sc1
    buffer_load_dwordx4 v[128:131], v4, s[76:79], s14 offen offset:1024 sc1
    buffer_load_dwordx4 v[132:135], v4, s[76:79], s14 offen offset:2048 sc1
    buffer_load_dwordx4 v[136:139], v4, s[76:79], s14 offen offset:3072 sc1
    s_add_u32 s14, s25, 8192
    buffer_load_dwordx4 v[140:143], v4, s[76:79], s14 offen offset:0 sc1
    buffer_load_dwordx4 v[144:147], v4, s[76:79], s14 offen offset:1024 sc1
    buffer_load_dwordx4 v[148:151], v4, s[76:79], s14 offen offset:2048 sc1
    buffer_load_dwordx4 v[152:155], v4, s[76:79], s14 offen offset:3072 sc1
    s_add_u32 s14, s25, 12288
    buffer_load_dwordx4 v[156:159], v4, s[76:79], s14 offen offset:0 sc1
    buffer_load_dwordx4 v[160:163], v4, s[76:79], s14 offen offset:1024 sc1
    buffer_load_dwordx4 v[164:167], v4, s[76:79], s14 offen offset:2048 sc1
    buffer_load_dwordx4 v[168:171], v4, s[76:79], s14 offen offset:3072 sc1
    s_waitcnt lgkmcnt(0)
    s_barrier
    s_waitcnt vmcnt(15)
    v_mfma_f32_16x16x32_bf16 v[16:19], v[48:51], v[108:111], v[16:19]
    ds_read_b128 v[88:91], v5 offset:22528
    v_mfma_f32_16x16x32_bf16 v[20:23], v[52:55], v[108:111], v[20:23]
    ds_read_b128 v[92:95], v5 offset:23552
    v_mfma_f32_16x16x32_bf16 v[24:27], v[56:59], v[108:111], v[24:27]
    ds_read_b128 v[96:99], v5 offset:24576
    v_mfma_f32_16x16x32_bf16 v[28:31], v[60:63], v[108:111], v[28:31]
    ds_read_b128 v[100:103], v5 offset:25600
    v_mfma_f32_16x16x32_bf16 v[32:35], v[64:67], v[108:111], v[32:35]
    ds_read_b128 v[104:107], v5 offset:26624
    s_mov_b32 s15, 9961472
    buffer_load_dwordx2 v[172:173], v221, s[76:79], s15 offen sc1
    s_waitcnt vmcnt(15) lgkmcnt(5)
    v_mfma_f32_16x16x32_bf16 v[16:19], v[68:71], v[112:115], v[16:19]
    ds_read_b128 v[48:51], v5 offset:27648
    v_mfma_f32_16x16x32_bf16 v[20:23], v[72:75], v[112:115], v[20:23]
    ds_read_b128 v[52:55], v5 offset:28672
    v_mfma_f32_16x16x32_bf16 v[24:27], v[76:79], v[112:115], v[24:27]
    ds_read_b128 v[56:59], v5 offset:29696
    v_mfma_f32_16x16x32_bf16 v[28:31], v[80:83], v[112:115], v[28:31]
    ds_read_b128 v[60:63], v5 offset:30720
    v_mfma_f32_16x16x32_bf16 v[32:35], v[84:87], v[112:115], v[32:35]
    ds_read_b128 v[64:67], v5 offset:31744
    s_mov_b32 s15, 9977856
    buffer_load_dwordx2 v[174:175], v221, s[76:79], s15 offen sc1
    s_waitcnt vmcnt(15) lgkmcnt(5)
    v_mfma_f32_16x16x32_bf16 v[16:19], v[88:91], v[116:119], v[16:19]
    ds_read_b128 v[68:71], v5 offset:32768
    v_mfma_f32_16x16x32_bf16 v[20:23], v[92:95], v[116:119], v[20:23]
    ds_read_b128 v[72:75], v5 offset:33792
    v_mfma_f32_16x16x32_bf16 v[24:27], v[96:99], v[116:119], v[24:27]
    ds_read_b128 v[76:79], v5 offset:34816
    v_mfma_f32_16x16x32_bf16 v[28:31], v[100:103], v[116:119], v[28:31]
    ds_read_b128 v[80:83], v5 offset:35840
    v_mfma_f32_16x16x32_bf16 v[32:35], v[104:107], v[116:119], v[32:35]
    ds_read_b128 v[84:87], v5 offset:36864
    s_mov_b32 s15, 10092544
    buffer_load_dwordx2 v[176:177], v221, s[76:79], s15 offen sc1
    s_waitcnt vmcnt(15) lgkmcnt(5)
    v_mfma_f32_16x16x32_bf16 v[16:19], v[48:51], v[120:123], v[16:19]
    ds_read_b128 v[88:91], v5 offset:37888
    v_mfma_f32_16x16x32_bf16 v[20:23], v[52:55], v[120:123], v[20:23]
    ds_read_b128 v[92:95], v5 offset:38912
    v_mfma_f32_16x16x32_bf16 v[24:27], v[56:59], v[120:123], v[24:27]
    ds_read_b128 v[96:99], v5 offset:39936
    v_mfma_f32_16x16x32_bf16 v[28:31], v[60:63], v[120:123], v[28:31]
    ds_read_b128 v[100:103], v5 offset:40960
    v_mfma_f32_16x16x32_bf16 v[32:35], v[64:67], v[120:123], v[32:35]
    ds_read_b128 v[104:107], v5 offset:41984
    s_mov_b32 s15, 10108928
    buffer_load_dwordx2 v[178:179], v221, s[76:79], s15 offen sc1
    s_waitcnt vmcnt(15) lgkmcnt(5)
    v_mfma_f32_16x16x32_bf16 v[16:19], v[68:71], v[124:127], v[16:19]
    ds_read_b128 v[48:51], v5 offset:43008
    v_mfma_f32_16x16x32_bf16 v[20:23], v[72:75], v[124:127], v[20:23]
    ds_read_b128 v[52:55], v5 offset:44032
    v_mfma_f32_16x16x32_bf16 v[24:27], v[76:79], v[124:127], v[24:27]
    ds_read_b128 v[56:59], v5 offset:45056
    v_mfma_f32_16x16x32_bf16 v[28:31], v[80:83], v[124:127], v[28:31]
    ds_read_b128 v[60:63], v5 offset:46080
    v_mfma_f32_16x16x32_bf16 v[32:35], v[84:87], v[124:127], v[32:35]
    ds_read_b128 v[64:67], v5 offset:47104
    s_mov_b32 s15, 10223616
    buffer_load_dwordx2 v[180:181], v221, s[76:79], s15 offen sc1
    s_waitcnt vmcnt(15) lgkmcnt(5)
    v_mfma_f32_16x16x32_bf16 v[16:19], v[88:91], v[128:131], v[16:19]
    ds_read_b128 v[68:71], v5 offset:48128
    v_mfma_f32_16x16x32_bf16 v[20:23], v[92:95], v[128:131], v[20:23]
    ds_read_b128 v[72:75], v5 offset:49152
    v_mfma_f32_16x16x32_bf16 v[24:27], v[96:99], v[128:131], v[24:27]
    ds_read_b128 v[76:79], v5 offset:50176
    v_mfma_f32_16x16x32_bf16 v[28:31], v[100:103], v[128:131], v[28:31]
    ds_read_b128 v[80:83], v5 offset:51200
    v_mfma_f32_16x16x32_bf16 v[32:35], v[104:107], v[128:131], v[32:35]
    ds_read_b128 v[84:87], v5 offset:52224
    s_mov_b32 s15, 10240000
    buffer_load_dwordx2 v[182:183], v221, s[76:79], s15 offen sc1
    s_waitcnt vmcnt(15) lgkmcnt(5)
    v_mfma_f32_16x16x32_bf16 v[16:19], v[48:51], v[132:135], v[16:19]
    ds_read_b128 v[88:91], v5 offset:53248
    v_mfma_f32_16x16x32_bf16 v[20:23], v[52:55], v[132:135], v[20:23]
    ds_read_b128 v[92:95], v5 offset:54272
    v_mfma_f32_16x16x32_bf16 v[24:27], v[56:59], v[132:135], v[24:27]
    ds_read_b128 v[96:99], v5 offset:55296
    v_mfma_f32_16x16x32_bf16 v[28:31], v[60:63], v[132:135], v[28:31]
    ds_read_b128 v[100:103], v5 offset:56320
    v_mfma_f32_16x16x32_bf16 v[32:35], v[64:67], v[132:135], v[32:35]
    ds_read_b128 v[104:107], v5 offset:57344
    s_mov_b32 s15, 10354688
    buffer_load_dwordx2 v[184:185], v221, s[76:79], s15 offen sc1
    s_waitcnt vmcnt(15) lgkmcnt(5)
    v_mfma_f32_16x16x32_bf16 v[16:19], v[68:71], v[136:139], v[16:19]
    ds_read_b128 v[48:51], v5 offset:58368
    v_mfma_f32_16x16x32_bf16 v[20:23], v[72:75], v[136:139], v[20:23]
    ds_read_b128 v[52:55], v5 offset:59392
    v_mfma_f32_16x16x32_bf16 v[24:27], v[76:79], v[136:139], v[24:27]
    ds_read_b128 v[56:59], v5 offset:60416
    v_mfma_f32_16x16x32_bf16 v[28:31], v[80:83], v[136:139], v[28:31]
    ds_read_b128 v[60:63], v6 offset:0
    v_mfma_f32_16x16x32_bf16 v[32:35], v[84:87], v[136:139], v[32:35]
    ds_read_b128 v[64:67], v6 offset:1024
    s_mov_b32 s15, 10371072
    buffer_load_dwordx2 v[186:187], v221, s[76:79], s15 offen sc1
    s_waitcnt vmcnt(15) lgkmcnt(5)
    v_mfma_f32_16x16x32_bf16 v[16:19], v[88:91], v[140:143], v[16:19]
    ds_read_b128 v[68:71], v6 offset:32768
    v_mfma_f32_16x16x32_bf16 v[20:23], v[92:95], v[140:143], v[20:23]
    ds_read_b128 v[72:75], v6 offset:33792
    v_mfma_f32_16x16x32_bf16 v[24:27], v[96:99], v[140:143], v[24:27]
    ds_read_b128 v[76:79], v6 offset:34816
    v_mfma_f32_16x16x32_bf16 v[28:31], v[100:103], v[140:143], v[28:31]
    ds_read_b128 v[80:83], v6 offset:35840
    v_mfma_f32_16x16x32_bf16 v[32:35], v[104:107], v[140:143], v[32:35]
    ds_read_b128 v[84:87], v6 offset:36864
    s_waitcnt vmcnt(14) lgkmcnt(5)
    v_mfma_f32_16x16x32_bf16 v[16:19], v[48:51], v[144:147], v[16:19]
    ds_read_b128 v[88:91], v6 offset:37888
    v_mfma_f32_16x16x32_bf16 v[20:23], v[52:55], v[144:147], v[20:23]
    ds_read_b128 v[92:95], v6 offset:38912
    v_mfma_f32_16x16x32_bf16 v[24:27], v[56:59], v[144:147], v[24:27]
    ds_read_b128 v[96:99], v6 offset:39936
    v_mfma_f32_16x16x32_bf16 v[28:31], v[60:63], v[144:147], v[28:31]
    ds_read_b128 v[100:103], v6 offset:40960
    v_mfma_f32_16x16x32_bf16 v[32:35], v[64:67], v[144:147], v[32:35]
    ds_read_b128 v[104:107], v6 offset:41984
    s_waitcnt vmcnt(13) lgkmcnt(5)
    v_mfma_f32_16x16x32_bf16 v[16:19], v[68:71], v[148:151], v[16:19]
    ds_read_b128 v[48:51], v6 offset:43008
    v_mfma_f32_16x16x32_bf16 v[20:23], v[72:75], v[148:151], v[20:23]
    ds_read_b128 v[52:55], v6 offset:44032
    v_mfma_f32_16x16x32_bf16 v[24:27], v[76:79], v[148:151], v[24:27]
    ds_read_b128 v[56:59], v6 offset:45056
    v_mfma_f32_16x16x32_bf16 v[28:31], v[80:83], v[148:151], v[28:31]
    ds_read_b128 v[60:63], v6 offset:46080
    v_mfma_f32_16x16x32_bf16 v[32:35], v[84:87], v[148:151], v[32:35]
    ds_read_b128 v[64:67], v6 offset:47104
    s_waitcnt vmcnt(12) lgkmcnt(5)
    v_mfma_f32_16x16x32_bf16 v[16:19], v[88:91], v[152:155], v[16:19]
    ds_read_b128 v[68:71], v6 offset:48128
    v_mfma_f32_16x16x32_bf16 v[20:23], v[92:95], v[152:155], v[20:23]
    ds_read_b128 v[72:75], v6 offset:49152
    v_mfma_f32_16x16x32_bf16 v[24:27], v[96:99], v[152:155], v[24:27]
    ds_read_b128 v[76:79], v6 offset:50176
    v_mfma_f32_16x16x32_bf16 v[28:31], v[100:103], v[152:155], v[28:31]
    ds_read_b128 v[80:83], v6 offset:51200
    v_mfma_f32_16x16x32_bf16 v[32:35], v[104:107], v[152:155], v[32:35]
    ds_read_b128 v[84:87], v6 offset:52224
    s_waitcnt vmcnt(11) lgkmcnt(5)
    v_mfma_f32_16x16x32_bf16 v[16:19], v[48:51], v[156:159], v[16:19]
    ds_read_b128 v[88:91], v6 offset:53248
    v_mfma_f32_16x16x32_bf16 v[20:23], v[52:55], v[156:159], v[20:23]
    ds_read_b128 v[92:95], v6 offset:54272
    v_mfma_f32_16x16x32_bf16 v[24:27], v[56:59], v[156:159], v[24:27]
    ds_read_b128 v[96:99], v6 offset:55296
    v_mfma_f32_16x16x32_bf16 v[28:31], v[60:63], v[156:159], v[28:31]
    ds_read_b128 v[100:103], v6 offset:56320
    v_mfma_f32_16x16x32_bf16 v[32:35], v[64:67], v[156:159], v[32:35]
    ds_read_b128 v[104:107], v6 offset:57344
    s_waitcnt vmcnt(10) lgkmcnt(5)
    v_mfma_f32_16x16x32_bf16 v[16:19], v[68:71], v[160:163], v[16:19]
    ds_read_b128 v[48:51], v6 offset:58368
    v_mfma_f32_16x16x32_bf16 v[20:23], v[72:75], v[160:163], v[20:23]
    ds_read_b128 v[52:55], v6 offset:59392
    v_mfma_f32_16x16x32_bf16 v[24:27], v[76:79], v[160:163], v[24:27]
    ds_read_b128 v[56:59], v6 offset:60416
    v_mfma_f32_16x16x32_bf16 v[28:31], v[80:83], v[160:163], v[28:31]
    ds_read_b128 v[60:63], v46 offset:0
    v_mfma_f32_16x16x32_bf16 v[32:35], v[84:87], v[160:163], v[32:35]
    ds_read_b128 v[64:67], v46 offset:1024
    s_waitcnt vmcnt(9) lgkmcnt(5)
    v_mfma_f32_16x16x32_bf16 v[16:19], v[88:91], v[164:167], v[16:19]
    ds_read_b128 v[68:71], v46 offset:2048
    v_mfma_f32_16x16x32_bf16 v[20:23], v[92:95], v[164:167], v[20:23]
    ds_read_b128 v[72:75], v46 offset:3072
    v_mfma_f32_16x16x32_bf16 v[24:27], v[96:99], v[164:167], v[24:27]
    ds_read_b128 v[76:79], v46 offset:4096
    v_mfma_f32_16x16x32_bf16 v[28:31], v[100:103], v[164:167], v[28:31]
    ds_read_b128 v[80:83], v46 offset:5120
    v_mfma_f32_16x16x32_bf16 v[32:35], v[104:107], v[164:167], v[32:35]
    ds_read_b128 v[84:87], v46 offset:6144
    s_waitcnt vmcnt(8) lgkmcnt(5)
    v_mfma_f32_16x16x32_bf16 v[16:19], v[48:51], v[168:171], v[16:19]
    ds_read_b128 v[88:91], v46 offset:7168
    v_mfma_f32_16x16x32_bf16 v[20:23], v[52:55], v[168:171], v[20:23]
    ds_read_b128 v[92:95], v46 offset:8192
    v_mfma_f32_16x16x32_bf16 v[24:27], v[56:59], v[168:171], v[24:27]
    ds_read_b128 v[96:99], v46 offset:9216
    v_mfma_f32_16x16x32_bf16 v[28:31], v[60:63], v[168:171], v[28:31]
    ds_read_b128 v[100:103], v46 offset:10240
    v_mfma_f32_16x16x32_bf16 v[32:35], v[64:67], v[168:171], v[32:35]
    ds_read_b128 v[104:107], v46 offset:11264
    s_waitcnt vmcnt(6) lgkmcnt(5)
    v_mfma_f32_16x16x32_bf16 v[16:19], v[68:71], v[172:175], v[16:19]
    ds_read_b128 v[48:51], v46 offset:12288
    v_mfma_f32_16x16x32_bf16 v[20:23], v[72:75], v[172:175], v[20:23]
    ds_read_b128 v[52:55], v46 offset:13312
    v_mfma_f32_16x16x32_bf16 v[24:27], v[76:79], v[172:175], v[24:27]
    ds_read_b128 v[56:59], v46 offset:14336
    v_mfma_f32_16x16x32_bf16 v[28:31], v[80:83], v[172:175], v[28:31]
    ds_read_b128 v[60:63], v46 offset:15360
    v_mfma_f32_16x16x32_bf16 v[32:35], v[84:87], v[172:175], v[32:35]
    ds_read_b128 v[64:67], v46 offset:16384
    s_waitcnt vmcnt(4) lgkmcnt(5)
    v_mfma_f32_16x16x32_bf16 v[16:19], v[88:91], v[176:179], v[16:19]
    ds_read_b128 v[68:71], v46 offset:17408
    v_mfma_f32_16x16x32_bf16 v[20:23], v[92:95], v[176:179], v[20:23]
    ds_read_b128 v[72:75], v46 offset:18432
    v_mfma_f32_16x16x32_bf16 v[24:27], v[96:99], v[176:179], v[24:27]
    ds_read_b128 v[76:79], v46 offset:19456
    v_mfma_f32_16x16x32_bf16 v[28:31], v[100:103], v[176:179], v[28:31]
    ds_read_b128 v[80:83], v46 offset:20480
    v_mfma_f32_16x16x32_bf16 v[32:35], v[104:107], v[176:179], v[32:35]
    ds_read_b128 v[84:87], v46 offset:21504
    s_waitcnt vmcnt(2) lgkmcnt(5)
    v_mfma_f32_16x16x32_bf16 v[16:19], v[48:51], v[180:183], v[16:19]
    v_mfma_f32_16x16x32_bf16 v[20:23], v[52:55], v[180:183], v[20:23]
    v_mfma_f32_16x16x32_bf16 v[24:27], v[56:59], v[180:183], v[24:27]
    v_mfma_f32_16x16x32_bf16 v[28:31], v[60:63], v[180:183], v[28:31]
    v_mfma_f32_16x16x32_bf16 v[32:35], v[64:67], v[180:183], v[32:35]
    s_waitcnt vmcnt(0) lgkmcnt(0)
    v_mfma_f32_16x16x32_bf16 v[16:19], v[68:71], v[184:187], v[16:19]
    v_mfma_f32_16x16x32_bf16 v[20:23], v[72:75], v[184:187], v[20:23]
    v_mfma_f32_16x16x32_bf16 v[24:27], v[76:79], v[184:187], v[24:27]
    v_mfma_f32_16x16x32_bf16 v[28:31], v[80:83], v[184:187], v[28:31]
    v_mfma_f32_16x16x32_bf16 v[32:35], v[84:87], v[184:187], v[32:35]
    s_nop 3
    v_cmp_u_f32 vcc, v16, v16
    s_nop 1
    s_cmp_eq_u64 vcc, 0
    s_cbranch_scc0 L3_redo
L3_back:
    v_cvt_pk_bf16_f32 v36, v16, v17
    v_cvt_pk_bf16_f32 v37, v18, v19
    v_cvt_pk_bf16_f32 v38, v20, v21
    v_cvt_pk_bf16_f32 v39, v22, v23
    v_cvt_pk_bf16_f32 v40, v24, v25
    v_cvt_pk_bf16_f32 v41, v26, v27
    v_cvt_pk_bf16_f32 v42, v28, v29
    v_cvt_pk_bf16_f32 v43, v30, v31
    v_cvt_pk_bf16_f32 v44, v32, v33
    v_cvt_pk_bf16_f32 v45, v34, v35
    v_min_u32 v36, 0xfffffffe, v36
    v_min_u32 v37, 0xfffffffe, v37
    v_min_u32 v38, 0xfffffffe, v38
    v_min_u32 v39, 0xfffffffe, v39
    v_min_u32 v40, 0xfffffffe, v40
    v_min_u32 v41, 0xfffffffe, v41
    v_min_u32 v42, 0xfffffffe, v42
    v_min_u32 v43, 0xfffffffe, v43
    v_min_u32 v44, 0xfffffffe, v44
    v_min_u32 v45, 0xfffffffe, v45
    buffer_store_dwordx4 v[36:39], v219, s[76:79], 0 offen offset:0 sc1
    buffer_store_dwordx4 v[40:43], v219, s[76:79], 0 offen offset:1024 sc1
    buffer_store_dwordx2 v[44:45], v220, s[76:79], 0 offen offset:2048 sc1
    v_pk_mul_f32 v[50:51], v[16:17], v[16:17]
    v_pk_add_f32 v[48:49], v[16:17], v[18:19]
    v_pk_fma_f32 v[50:51], v[18:19], v[18:19], v[50:51]
    v_pk_add_f32 v[48:49], v[48:49], v[20:21]
    v_pk_fma_f32 v[50:51], v[20:21], v[20:21], v[50:51]
    v_pk_add_f32 v[48:49], v[48:49], v[22:23]
    v_pk_fma_f32 v[50:51], v[22:23], v[22:23], v[50:51]
    v_pk_add_f32 v[48:49], v[48:49], v[24:25]
    v_pk_fma_f32 v[50:51], v[24:25], v[24:25], v[50:51]
    v_pk_add_f32 v[48:49], v[48:49], v[26:27]
    v_pk_fma_f32 v[50:51], v[26:27], v[26:27], v[50:51]
    v_pk_add_f32 v[48:49], v[48:49], v[28:29]
    v_pk_fma_f32 v[50:51], v[28:29], v[28:29], v[50:51]
    v_pk_add_f32 v[48:49], v[48:49], v[30:31]
    v_pk_fma_f32 v[50:51], v[30:31], v[30:31], v[50:51]
    v_pk_add_f32 v[48:49], v[48:49], v[32:33]
    v_pk_fma_f32 v[50:51], v[32:33], v[32:33], v[50:51]
    v_pk_add_f32 v[48:49], v[48:49], v[34:35]
    v_pk_fma_f32 v[50:51], v[34:35], v[34:35], v[50:51]
    v_add_f32 v48, v48, v49
    v_add_f32 v49, v50, v51
    v_mov_b32 v50, v48
    v_mov_b32 v51, v49
    s_nop 1
    v_permlane32_swap_b32 v48, v50
    v_permlane32_swap_b32 v49, v51
    v_add_f32 v48, v48, v50
    v_add_f32 v49, v49, v51
    v_mov_b32 v50, v48
    v_mov_b32 v51, v49
    s_nop 1
    v_permlane16_swap_b32 v48, v50
    v_permlane16_swap_b32 v49, v51
    v_add_f32 v48, v48, v50
    v_add_f32 v49, v49, v51
    v_min_u32 v48, 0xfffffffe, v48
    v_min_u32 v49, 0xfffffffe, v49
    v_lshlrev_b32 v3, 3, v216
    s_mul_i32 s31, s21, 16384
    s_add_u32 s31, s31, 19398656
    s_mov_b64 exec, 0xffff
    buffer_store_dwordx2 v[48:49], v3, s[76:79], s31 offen sc1
    s_mov_b64 exec, -1
    s_barrier
    s_lshl_b32 s28, s22, 2
    s_add_u32 s28, s28, s24
    v_and_b32 v1, 15, v0
    v_lshrrev_b32 v2, 4, v0
    v_lshlrev_b32 v3, 3, v1
    v_lshl_add_u32 v3, v2, 15, v3
    s_lshl_b32 s29, s28, 8
    s_add_u32 s29, s29, 19398656
    s_add_u32 s33, s29, 16384
    v_lshlrev_b32 v9, 5, v2
    s_mul_i32 s34, s23, 384
    s_add_u32 s34, s34, 26247168
    s_add_u32 s35, s34, 6144
    v_mov_b32 v5, v4
    v_add_u32 v6, 49152, v4
    s_lshl_b32 s31, s24, 12
    s_add_u32 s31, s31, 98304
    v_add_u32 v10, s31, v4
    buffer_load_dwordx4 v[200:203], v9, s[76:79], s34 offen offset:0 sc1
    buffer_load_dwordx4 v[204:207], v9, s[76:79], s35 offen offset:0 sc1
    buffer_load_dwordx4 v[208:211], v9, s[76:79], s34 offen offset:16 sc1
    buffer_load_dwordx4 v[212:215], v9, s[76:79], s35 offen offset:16 sc1
    buffer_load_dwordx4 v[216:219], v9, s[76:79], s34 offen offset:128 sc1
    buffer_load_dwordx4 v[220:223], v9, s[76:79], s35 offen offset:128 sc1
    buffer_load_dwordx4 v[224:227], v9, s[76:79], s34 offen offset:144 sc1
    buffer_load_dwordx4 v[228:231], v9, s[76:79], s35 offen offset:144 sc1
    buffer_load_dwordx4 v[232:235], v9, s[76:79], s34 offen offset:256 sc1
    buffer_load_dwordx4 v[236:239], v9, s[76:79], s35 offen offset:256 sc1
    buffer_load_dwordx4 v[240:243], v9, s[76:79], s34 offen offset:272 sc1
    buffer_load_dwordx4 v[244:247], v9, s[76:79], s35 offen offset:272 sc1
    s_mov_b32 s54, 262144
L4_stats:
    buffer_load_dwordx2 v[112:113], v3, s[76:79], s29 offen offset:0 sc1
    buffer_load_dwordx2 v[116:117], v3, s[76:79], s33 offen offset:0 sc1
    buffer_load_dwordx2 v[114:115], v3, s[76:79], s29 offen offset:128 sc1
    buffer_load_dwordx2 v[118:119], v3, s[76:79], s33 offen offset:128 sc1
    s_waitcnt vmcnt(0)
    v_max3_u32 v120, v112, v113, v114
    v_max3_u32 v121, v115, v116, v117
    v_max3_u32 v120, v120, v118, v119
    v_max_u32 v120, v120, v121
    v_cmp_ne_u32 vcc, -1, v120
    s_sub_u32 s54, s54, 1
    s_cbranch_scc1 L4_stats_ok
    s_cmp_eq_u64 vcc, exec
    s_cbranch_scc0 L4_stats
L4_stats_ok:
    s_mov_b32 s29, 0x3acccccd
    v_pk_add_f32 v[112:113], v[112:113], v[116:117]
    v_pk_add_f32 v[114:115], v[114:115], v[118:119]
    v_mov_b32 v116, v112
    v_mov_b32 v117, v113
    v_mov_b32 v118, v114
    v_mov_b32 v119, v115
    s_nop 1
    v_permlane32_swap_b32 v112, v116
    v_permlane32_swap_b32 v113, v117
    v_permlane32_swap_b32 v114, v118
    v_permlane32_swap_b32 v115, v119
    v_add_f32 v112, v112, v116
    v_add_f32 v113, v113, v117
    v_add_f32 v114, v114, v118
    v_add_f32 v115, v115, v119
    v_mov_b32 v116, v112
    v_mov_b32 v117, v113
    v_mov_b32 v118, v114
    v_mov_b32 v119, v115
    s_nop 1
    v_permlane16_swap_b32 v112, v116
    v_permlane16_swap_b32 v113, v117
    v_permlane16_swap_b32 v114, v118
    v_permlane16_swap_b32 v115, v119
    v_add_f32 v112, v112, v116
    v_add_f32 v113, v113, v117
    v_add_f32 v114, v114, v118
    v_add_f32 v115, v115, v119
    v_mul_f32 v248, 0xbacccccd, v112
    v_mul_f32 v120, v248, v248
    v_fma_f32 v254, v113, s29, -v120
    v_max_f32 v254, 0, v254
    v_add_f32 v254, 0x3727c5ac, v254
    v_rsq_f32 v120, v254
    s_nop 0
    v_mul_f32 v250, 0xc0135761, v120
    v_mul_f32 v121, v120, v120
    v_mul_f32 v121, v121, v120
    v_mul_f32 v252, 0xbdd2d3e8, v121
    v_mul_f32 v249, 0xbacccccd, v114
    v_mul_f32 v120, v249, v249
    v_fma_f32 v255, v115, s29, -v120
    v_max_f32 v255, 0, v255
    v_add_f32 v255, 0x3727c5ac, v255
    v_rsq_f32 v120, v255
    s_nop 0
    v_mul_f32 v251, 0xc0135761, v120
    v_mul_f32 v121, v120, v120
    v_mul_f32 v121, v121, v120
    v_mul_f32 v253, 0xbdd2d3e8, v121
    v_pk_mul_f32 v[16:17], v[200:201], v[248:249] op_sel:[0,0] op_sel_hi:[1,0]
    v_pk_mul_f32 v[18:19], v[202:203], v[248:249] op_sel:[0,0] op_sel_hi:[1,0]
    v_pk_mul_f32 v[20:21], v[204:205], v[248:249] op_sel:[0,0] op_sel_hi:[1,0]
    v_pk_mul_f32 v[22:23], v[206:207], v[248:249] op_sel:[0,0] op_sel_hi:[1,0]
    v_pk_mul_f32 v[24:25], v[208:209], v[248:249] op_sel:[0,0] op_sel_hi:[1,0]
    v_pk_mul_f32 v[26:27], v[210:211], v[248:249] op_sel:[0,0] op_sel_hi:[1,0]
    v_pk_mul_f32 v[28:29], v[212:213], v[248:249] op_sel:[0,0] op_sel_hi:[1,0]
    v_pk_mul_f32 v[30:31], v[214:215], v[248:249] op_sel:[0,0] op_sel_hi:[1,0]
    v_pk_mul_f32 v[32:33], v[216:217], v[248:249] op_sel:[0,0] op_sel_hi:[1,0]
    v_pk_mul_f32 v[34:35], v[218:219], v[248:249] op_sel:[0,0] op_sel_hi:[1,0]
    v_pk_mul_f32 v[36:37], v[220:221], v[248:249] op_sel:[0,0] op_sel_hi:[1,0]
    v_pk_mul_f32 v[38:39], v[222:223], v[248:249] op_sel:[0,0] op_sel_hi:[1,0]
    v_pk_mul_f32 v[40:41], v[224:225], v[248:249] op_sel:[0,0] op_sel_hi:[1,0]
    v_pk_mul_f32 v[42:43], v[226:227], v[248:249] op_sel:[0,0] op_sel_hi:[1,0]
    v_pk_mul_f32 v[44:45], v[228:229], v[248:249] op_sel:[0,0] op_sel_hi:[1,0]
    v_pk_mul_f32 v[46:47], v[230:231], v[248:249] op_sel:[0,0] op_sel_hi:[1,0]
    v_pk_mul_f32 v[48:49], v[232:233], v[248:249] op_sel:[0,0] op_sel_hi:[1,0]
    v_pk_mul_f32 v[50:51], v[234:235], v[248:249] op_sel:[0,0] op_sel_hi:[1,0]
    v_pk_mul_f32 v[52:53], v[236:237], v[248:249] op_sel:[0,0] op_sel_hi:[1,0]
    v_pk_mul_f32 v[54:55], v[238:239], v[248:249] op_sel:[0,0] op_sel_hi:[1,0]
    v_pk_mul_f32 v[56:57], v[240:241], v[248:249] op_sel:[0,0] op_sel_hi:[1,0]
    v_pk_mul_f32 v[58:59], v[242:243], v[248:249] op_sel:[0,0] op_sel_hi:[1,0]
    v_pk_mul_f32 v[60:61], v[244:245], v[248:249] op_sel:[0,0] op_sel_hi:[1,0]
    v_pk_mul_f32 v[62:63], v[246:247], v[248:249] op_sel:[0,0] op_sel_hi:[1,0]
    v_pk_mul_f32 v[64:65], v[200:201], v[248:249] op_sel:[0,1] op_sel_hi:[1,1]
    v_pk_mul_f32 v[66:67], v[202:203], v[248:249] op_sel:[0,1] op_sel_hi:[1,1]
    v_pk_mul_f32 v[68:69], v[204:205], v[248:249] op_sel:[0,1] op_sel_hi:[1,1]
    v_pk_mul_f32 v[70:71], v[206:207], v[248:249] op_sel:[0,1] op_sel_hi:[1,1]
    v_pk_mul_f32 v[72:73], v[208:209], v[248:249] op_sel:[0,1] op_sel_hi:[1,1]
    v_pk_mul_f32 v[74:75], v[210:211], v[248:249] op_sel:[0,1] op_sel_hi:[1,1]
    v_pk_mul_f32 v[76:77], v[212:213], v[248:249] op_sel:[0,1] op_sel_hi:[1,1]
    v_pk_mul_f32 v[78:79], v[214:215], v[248:249] op_sel:[0,1] op_sel_hi:[1,1]
    v_pk_mul_f32 v[80:81], v[216:217], v[248:249] op_sel:[0,1] op_sel_hi:[1,1]
    v_pk_mul_f32 v[82:83], v[218:219], v[248:249] op_sel:[0,1] op_sel_hi:[1,1]
    v_pk_mul_f32 v[84:85], v[220:221], v[248:249] op_sel:[0,1] op_sel_hi:[1,1]
    v_pk_mul_f32 v[86:87], v[222:223], v[248:249] op_sel:[0,1] op_sel_hi:[1,1]
    v_pk_mul_f32 v[88:89], v[224:225], v[248:249] op_sel:[0,1] op_sel_hi:[1,1]
    v_pk_mul_f32 v[90:91], v[226:227], v[248:249] op_sel:[0,1] op_sel_hi:[1,1]
    v_pk_mul_f32 v[92:93], v[228:229], v[248:249] op_sel:[0,1] op_sel_hi:[1,1]
    v_pk_mul_f32 v[94:95], v[230:231], v[248:249] op_sel:[0,1] op_sel_hi:[1,1]
    v_pk_mul_f32 v[96:97], v[232:233], v[248:249] op_sel:[0,1] op_sel_hi:[1,1]
    v_pk_mul_f32 v[98:99], v[234:235], v[248:249] op_sel:[0,1] op_sel_hi:[1,1]
    v_pk_mul_f32 v[100:101], v[236:237], v[248:249] op_sel:[0,1] op_sel_hi:[1,1]
    v_pk_mul_f32 v[102:103], v[238:239], v[248:249] op_sel:[0,1] op_sel_hi:[1,1]
    v_pk_mul_f32 v[104:105], v[240:241], v[248:249] op_sel:[0,1] op_sel_hi:[1,1]
    v_pk_mul_f32 v[106:107], v[242:243], v[248:249] op_sel:[0,1] op_sel_hi:[1,1]
    v_pk_mul_f32 v[108:109], v[244:245], v[248:249] op_sel:[0,1] op_sel_hi:[1,1]
    v_pk_mul_f32 v[110:111], v[246:247], v[248:249] op_sel:[0,1] op_sel_hi:[1,1]
    s_barrier
    ds_read_b128 v[184:187], v10 offset:0
    ds_read_b128 v[188:191], v10 offset:2048
    ds_read_b128 v[112:115], v5 offset:0
    ds_read_b128 v[116:119], v5 offset:1024
    ds_read_b128 v[120:123], v5 offset:2048
    ds_read_b128 v[124:127], v5 offset:3072
    ds_read_b128 v[128:131], v5 offset:4096
    ds_read_b128 v[132:135], v5 offset:5120
    ds_read_b128 v[136:139], v5 offset:6144
    ds_read_b128 v[140:143], v5 offset:7168
    ds_read_b128 v[144:147], v5 offset:8192
    ds_read_b128 v[148:151], v5 offset:9216
    ds_read_b128 v[152:155], v5 offset:10240
    ds_read_b128 v[156:159], v5 offset:11264
    s_waitcnt lgkmcnt(6)
    v_mfma_f32_16x16x32_bf16 v[16:19], v[112:115], v[184:187], v[16:19]
    ds_read_b128 v[192:195], v10 offset:1024
    v_mfma_f32_16x16x32_bf16 v[64:67], v[112:115], v[188:191], v[64:67]
    ds_read_b128 v[196:199], v10 offset:3072
    v_mfma_f32_16x16x32_bf16 v[20:23], v[116:119], v[184:187], v[20:23]
    ds_read_b128 v[160:163], v5 offset:12288
    v_mfma_f32_16x16x32_bf16 v[68:71], v[116:119], v[188:191], v[68:71]
    ds_read_b128 v[164:167], v5 offset:13312
    v_mfma_f32_16x16x32_bf16 v[24:27], v[120:123], v[184:187], v[24:27]
    ds_read_b128 v[168:171], v5 offset:14336
    v_mfma_f32_16x16x32_bf16 v[72:75], v[120:123], v[188:191], v[72:75]
    ds_read_b128 v[172:175], v5 offset:15360
    v_mfma_f32_16x16x32_bf16 v[28:31], v[124:127], v[184:187], v[28:31]
    ds_read_b128 v[176:179], v5 offset:16384
    v_mfma_f32_16x16x32_bf16 v[76:79], v[124:127], v[188:191], v[76:79]
    ds_read_b128 v[180:183], v5 offset:17408
    v_mfma_f32_16x16x32_bf16 v[32:35], v[128:131], v[184:187], v[32:35]
    v_mfma_f32_16x16x32_bf16 v[80:83], v[128:131], v[188:191], v[80:83]
    v_mfma_f32_16x16x32_bf16 v[36:39], v[132:135], v[184:187], v[36:39]
    v_mfma_f32_16x16x32_bf16 v[84:87], v[132:135], v[188:191], v[84:87]
    s_waitcnt lgkmcnt(8)
    v_mfma_f32_16x16x32_bf16 v[40:43], v[136:139], v[184:187], v[40:43]
    ds_read_b128 v[112:115], v5 offset:18432
    v_mfma_f32_16x16x32_bf16 v[88:91], v[136:139], v[188:191], v[88:91]
    ds_read_b128 v[116:119], v5 offset:19456
    v_mfma_f32_16x16x32_bf16 v[44:47], v[140:143], v[184:187], v[44:47]
    ds_read_b128 v[120:123], v5 offset:20480
    v_mfma_f32_16x16x32_bf16 v[92:95], v[140:143], v[188:191], v[92:95]
    ds_read_b128 v[124:127], v5 offset:21504
    v_mfma_f32_16x16x32_bf16 v[48:51], v[144:147], v[184:187], v[48:51]
    ds_read_b128 v[128:131], v5 offset:22528
    v_mfma_f32_16x16x32_bf16 v[96:99], v[144:147], v[188:191], v[96:99]
    ds_read_b128 v[132:135], v5 offset:23552
    v_mfma_f32_16x16x32_bf16 v[52:55], v[148:151], v[184:187], v[52:55]
    v_mfma_f32_16x16x32_bf16 v[100:103], v[148:151], v[188:191], v[100:103]
    v_mfma_f32_16x16x32_bf16 v[56:59], v[152:155], v[184:187], v[56:59]
    v_mfma_f32_16x16x32_bf16 v[104:107], v[152:155], v[188:191], v[104:107]
    v_mfma_f32_16x16x32_bf16 v[60:63], v[156:159], v[184:187], v[60:63]
    v_mfma_f32_16x16x32_bf16 v[108:111], v[156:159], v[188:191], v[108:111]
    s_waitcnt lgkmcnt(0)
    s_barrier
    v_mfma_f32_16x16x32_bf16 v[16:19], v[160:163], v[192:195], v[16:19]
    ds_read_b128 v[184:187], v10 offset:16384
    v_mfma_f32_16x16x32_bf16 v[64:67], v[160:163], v[196:199], v[64:67]
    ds_read_b128 v[188:191], v10 offset:18432
    v_mfma_f32_16x16x32_bf16 v[20:23], v[164:167], v[192:195], v[20:23]
    ds_read_b128 v[136:139], v5 offset:24576
    v_mfma_f32_16x16x32_bf16 v[68:71], v[164:167], v[196:199], v[68:71]
    ds_read_b128 v[140:143], v5 offset:25600
    v_mfma_f32_16x16x32_bf16 v[24:27], v[168:171], v[192:195], v[24:27]
    ds_read_b128 v[144:147], v5 offset:26624
    v_mfma_f32_16x16x32_bf16 v[72:75], v[168:171], v[196:199], v[72:75]
    ds_read_b128 v[148:151], v5 offset:27648
    v_mfma_f32_16x16x32_bf16 v[28:31], v[172:175], v[192:195], v[28:31]
    ds_read_b128 v[152:155], v5 offset:28672
    v_mfma_f32_16x16x32_bf16 v[76:79], v[172:175], v[196:199], v[76:79]
    ds_read_b128 v[156:159], v5 offset:29696
    v_mfma_f32_16x16x32_bf16 v[32:35], v[176:179], v[192:195], v[32:35]
    v_mfma_f32_16x16x32_bf16 v[80:83], v[176:179], v[196:199], v[80:83]
    v_mfma_f32_16x16x32_bf16 v[36:39], v[180:183], v[192:195], v[36:39]
    v_mfma_f32_16x16x32_bf16 v[84:87], v[180:183], v[196:199], v[84:87]
    v_mfma_f32_16x16x32_bf16 v[40:43], v[112:115], v[192:195], v[40:43]
    ds_read_b128 v[160:163], v5 offset:30720
    v_mfma_f32_16x16x32_bf16 v[88:91], v[112:115], v[196:199], v[88:91]
    ds_read_b128 v[164:167], v5 offset:31744
    v_mfma_f32_16x16x32_bf16 v[44:47], v[116:119], v[192:195], v[44:47]
    ds_read_b128 v[168:171], v5 offset:32768
    v_mfma_f32_16x16x32_bf16 v[92:95], v[116:119], v[196:199], v[92:95]
    ds_read_b128 v[172:175], v5 offset:33792
    v_mfma_f32_16x16x32_bf16 v[48:51], v[120:123], v[192:195], v[48:51]
    ds_read_b128 v[176:179], v5 offset:34816
    v_mfma_f32_16x16x32_bf16 v[96:99], v[120:123], v[196:199], v[96:99]
    ds_read_b128 v[180:183], v5 offset:35840
    v_mfma_f32_16x16x32_bf16 v[52:55], v[124:127], v[192:195], v[52:55]
    v_mfma_f32_16x16x32_bf16 v[100:103], v[124:127], v[196:199], v[100:103]
    v_mfma_f32_16x16x32_bf16 v[56:59], v[128:131], v[192:195], v[56:59]
    v_mfma_f32_16x16x32_bf16 v[104:107], v[128:131], v[196:199], v[104:107]
    v_mfma_f32_16x16x32_bf16 v[60:63], v[132:135], v[192:195], v[60:63]
    v_mfma_f32_16x16x32_bf16 v[108:111], v[132:135], v[196:199], v[108:111]
    s_waitcnt lgkmcnt(6)
    v_mfma_f32_16x16x32_bf16 v[16:19], v[136:139], v[184:187], v[16:19]
    ds_read_b128 v[192:195], v10 offset:17408
    v_mfma_f32_16x16x32_bf16 v[64:67], v[136:139], v[188:191], v[64:67]
    ds_read_b128 v[196:199], v10 offset:19456
    v_mfma_f32_16x16x32_bf16 v[20:23], v[140:143], v[184:187], v[20:23]
    ds_read_b128 v[112:115], v5 offset:36864
    v_mfma_f32_16x16x32_bf16 v[68:71], v[140:143], v[188:191], v[68:71]
    ds_read_b128 v[116:119], v5 offset:37888
    v_mfma_f32_16x16x32_bf16 v[24:27], v[144:147], v[184:187], v[24:27]
    ds_read_b128 v[120:123], v5 offset:38912
    v_mfma_f32_16x16x32_bf16 v[72:75], v[144:147], v[188:191], v[72:75]
    ds_read_b128 v[124:127], v5 offset:39936
    v_mfma_f32_16x16x32_bf16 v[28:31], v[148:151], v[184:187], v[28:31]
    ds_read_b128 v[128:131], v5 offset:40960
    v_mfma_f32_16x16x32_bf16 v[76:79], v[148:151], v[188:191], v[76:79]
    ds_read_b128 v[132:135], v5 offset:41984
    v_mfma_f32_16x16x32_bf16 v[32:35], v[152:155], v[184:187], v[32:35]
    v_mfma_f32_16x16x32_bf16 v[80:83], v[152:155], v[188:191], v[80:83]
    v_mfma_f32_16x16x32_bf16 v[36:39], v[156:159], v[184:187], v[36:39]
    v_mfma_f32_16x16x32_bf16 v[84:87], v[156:159], v[188:191], v[84:87]
    s_waitcnt lgkmcnt(8)
    v_mfma_f32_16x16x32_bf16 v[40:43], v[160:163], v[184:187], v[40:43]
    ds_read_b128 v[136:139], v5 offset:43008
    v_mfma_f32_16x16x32_bf16 v[88:91], v[160:163], v[188:191], v[88:91]
    ds_read_b128 v[140:143], v5 offset:44032
    v_mfma_f32_16x16x32_bf16 v[44:47], v[164:167], v[184:187], v[44:47]
    ds_read_b128 v[144:147], v5 offset:45056
    v_mfma_f32_16x16x32_bf16 v[92:95], v[164:167], v[188:191], v[92:95]
    ds_read_b128 v[148:151], v5 offset:46080
    v_mfma_f32_16x16x32_bf16 v[48:51], v[168:171], v[184:187], v[48:51]
    ds_read_b128 v[152:155], v5 offset:47104
    v_mfma_f32_16x16x32_bf16 v[96:99], v[168:171], v[188:191], v[96:99]
    ds_read_b128 v[156:159], v5 offset:48128
    v_mfma_f32_16x16x32_bf16 v[52:55], v[172:175], v[184:187], v[52:55]
    v_mfma_f32_16x16x32_bf16 v[100:103], v[172:175], v[188:191], v[100:103]
    v_mfma_f32_16x16x32_bf16 v[56:59], v[176:179], v[184:187], v[56:59]
    v_mfma_f32_16x16x32_bf16 v[104:107], v[176:179], v[188:191], v[104:107]
    v_mfma_f32_16x16x32_bf16 v[60:63], v[180:183], v[184:187], v[60:63]
    v_mfma_f32_16x16x32_bf16 v[108:111], v[180:183], v[188:191], v[108:111]
    s_waitcnt lgkmcnt(0)
    s_barrier
    v_mfma_f32_16x16x32_bf16 v[16:19], v[112:115], v[192:195], v[16:19]
    ds_read_b128 v[184:187], v10 offset:32768
    v_mfma_f32_16x16x32_bf16 v[64:67], v[112:115], v[196:199], v[64:67]
    ds_read_b128 v[188:191], v10 offset:34816
    v_mfma_f32_16x16x32_bf16 v[20:23], v[116:119], v[192:195], v[20:23]
    ds_read_b128 v[160:163], v6 offset:0
    v_mfma_f32_16x16x32_bf16 v[68:71], v[116:119], v[196:199], v[68:71]
    ds_read_b128 v[164:167], v6 offset:1024
    v_mfma_f32_16x16x32_bf16 v[24:27], v[120:123], v[192:195], v[24:27]
    ds_read_b128 v[168:171], v6 offset:2048
    v_mfma_f32_16x16x32_bf16 v[72:75], v[120:123], v[196:199], v[72:75]
    ds_read_b128 v[172:175], v6 offset:3072
    v_mfma_f32_16x16x32_bf16 v[28:31], v[124:127], v[192:195], v[28:31]
    ds_read_b128 v[176:179], v6 offset:4096
    v_mfma_f32_16x16x32_bf16 v[76:79], v[124:127], v[196:199], v[76:79]
    ds_read_b128 v[180:183], v6 offset:5120
    v_mfma_f32_16x16x32_bf16 v[32:35], v[128:131], v[192:195], v[32:35]
    v_mfma_f32_16x16x32_bf16 v[80:83], v[128:131], v[196:199], v[80:83]
    v_mfma_f32_16x16x32_bf16 v[36:39], v[132:135], v[192:195], v[36:39]
    v_mfma_f32_16x16x32_bf16 v[84:87], v[132:135], v[196:199], v[84:87]
    v_mfma_f32_16x16x32_bf16 v[40:43], v[136:139], v[192:195], v[40:43]
    ds_read_b128 v[112:115], v6 offset:6144
    v_mfma_f32_16x16x32_bf16 v[88:91], v[136:139], v[196:199], v[88:91]
    ds_read_b128 v[116:119], v6 offset:7168
    v_mfma_f32_16x16x32_bf16 v[44:47], v[140:143], v[192:195], v[44:47]
    ds_read_b128 v[120:123], v6 offset:8192
    v_mfma_f32_16x16x32_bf16 v[92:95], v[140:143], v[196:199], v[92:95]
    ds_read_b128 v[124:127], v6 offset:9216
    v_mfma_f32_16x16x32_bf16 v[48:51], v[144:147], v[192:195], v[48:51]
    ds_read_b128 v[128:131], v6 offset:10240
    v_mfma_f32_16x16x32_bf16 v[96:99], v[144:147], v[196:199], v[96:99]
    ds_read_b128 v[132:135], v6 offset:11264
    v_mfma_f32_16x16x32_bf16 v[52:55], v[148:151], v[192:195], v[52:55]
    v_mfma_f32_16x16x32_bf16 v[100:103], v[148:151], v[196:199], v[100:103]
    v_mfma_f32_16x16x32_bf16 v[56:59], v[152:155], v[192:195], v[56:59]
    v_mfma_f32_16x16x32_bf16 v[104:107], v[152:155], v[196:199], v[104:107]
    v_mfma_f32_16x16x32_bf16 v[60:63], v[156:159], v[192:195], v[60:63]
    v_mfma_f32_16x16x32_bf16 v[108:111], v[156:159], v[196:199], v[108:111]
    s_waitcnt lgkmcnt(6)
    v_mfma_f32_16x16x32_bf16 v[16:19], v[160:163], v[184:187], v[16:19]
    ds_read_b128 v[192:195], v10 offset:33792
    v_mfma_f32_16x16x32_bf16 v[64:67], v[160:163], v[188:191], v[64:67]
    ds_read_b128 v[196:199], v10 offset:35840
    v_mfma_f32_16x16x32_bf16 v[20:23], v[164:167], v[184:187], v[20:23]
    ds_read_b128 v[136:139], v6 offset:12288
    v_mfma_f32_16x16x32_bf16 v[68:71], v[164:167], v[188:191], v[68:71]
    ds_read_b128 v[140:143], v6 offset:13312
    v_mfma_f32_16x16x32_bf16 v[24:27], v[168:171], v[184:187], v[24:27]
    ds_read_b128 v[144:147], v6 offset:14336
    v_mfma_f32_16x16x32_bf16 v[72:75], v[168:171], v[188:191], v[72:75]
    ds_read_b128 v[148:151], v6 offset:15360
    v_mfma_f32_16x16x32_bf16 v[28:31], v[172:175], v[184:187], v[28:31]
    ds_read_b128 v[152:155], v6 offset:16384
    v_mfma_f32_16x16x32_bf16 v[76:79], v[172:175], v[188:191], v[76:79]
    ds_read_b128 v[156:159], v6 offset:17408
    v_mfma_f32_16x16x32_bf16 v[32:35], v[176:179], v[184:187], v[32:35]
    v_mfma_f32_16x16x32_bf16 v[80:83], v[176:179], v[188:191], v[80:83]
    v_mfma_f32_16x16x32_bf16 v[36:39], v[180:183], v[184:187], v[36:39]
    v_mfma_f32_16x16x32_bf16 v[84:87], v[180:183], v[188:191], v[84:87]
    s_waitcnt lgkmcnt(8)
    v_mfma_f32_16x16x32_bf16 v[40:43], v[112:115], v[184:187], v[40:43]
    ds_read_b128 v[160:163], v6 offset:18432
    v_mfma_f32_16x16x32_bf16 v[88:91], v[112:115], v[188:191], v[88:91]
    ds_read_b128 v[164:167], v6 offset:19456
    v_mfma_f32_16x16x32_bf16 v[44:47], v[116:119], v[184:187], v[44:47]
    ds_read_b128 v[168:171], v6 offset:20480
    v_mfma_f32_16x16x32_bf16 v[92:95], v[116:119], v[188:191], v[92:95]
    ds_read_b128 v[172:175], v6 offset:21504
    v_mfma_f32_16x16x32_bf16 v[48:51], v[120:123], v[184:187], v[48:51]
    ds_read_b128 v[176:179], v6 offset:22528
    v_mfma_f32_16x16x32_bf16 v[96:99], v[120:123], v[188:191], v[96:99]
    ds_read_b128 v[180:183], v6 offset:23552
    v_mfma_f32_16x16x32_bf16 v[52:55], v[124:127], v[184:187], v[52:55]
    v_mfma_f32_16x16x32_bf16 v[100:103], v[124:127], v[188:191], v[100:103]
    v_mfma_f32_16x16x32_bf16 v[56:59], v[128:131], v[184:187], v[56:59]
    v_mfma_f32_16x16x32_bf16 v[104:107], v[128:131], v[188:191], v[104:107]
    v_mfma_f32_16x16x32_bf16 v[60:63], v[132:135], v[184:187], v[60:63]
    v_mfma_f32_16x16x32_bf16 v[108:111], v[132:135], v[188:191], v[108:111]
    s_waitcnt lgkmcnt(0)
    s_barrier
    v_mfma_f32_16x16x32_bf16 v[16:19], v[136:139], v[192:195], v[16:19]
    ds_read_b128 v[184:187], v10 offset:0
    v_mfma_f32_16x16x32_bf16 v[64:67], v[136:139], v[196:199], v[64:67]
    ds_read_b128 v[188:191], v10 offset:2048
    v_mfma_f32_16x16x32_bf16 v[20:23], v[140:143], v[192:195], v[20:23]
    ds_read_b128 v[112:115], v6 offset:24576
    v_mfma_f32_16x16x32_bf16 v[68:71], v[140:143], v[196:199], v[68:71]
    ds_read_b128 v[116:119], v6 offset:25600
    v_mfma_f32_16x16x32_bf16 v[24:27], v[144:147], v[192:195], v[24:27]
    ds_read_b128 v[120:123], v6 offset:26624
    v_mfma_f32_16x16x32_bf16 v[72:75], v[144:147], v[196:199], v[72:75]
    ds_read_b128 v[124:127], v6 offset:27648
    v_mfma_f32_16x16x32_bf16 v[28:31], v[148:151], v[192:195], v[28:31]
    ds_read_b128 v[128:131], v6 offset:28672
    v_mfma_f32_16x16x32_bf16 v[76:79], v[148:151], v[196:199], v[76:79]
    ds_read_b128 v[132:135], v6 offset:29696
    v_mfma_f32_16x16x32_bf16 v[32:35], v[152:155], v[192:195], v[32:35]
    v_mfma_f32_16x16x32_bf16 v[80:83], v[152:155], v[196:199], v[80:83]
    v_mfma_f32_16x16x32_bf16 v[36:39], v[156:159], v[192:195], v[36:39]
    v_mfma_f32_16x16x32_bf16 v[84:87], v[156:159], v[196:199], v[84:87]
    v_mfma_f32_16x16x32_bf16 v[40:43], v[160:163], v[192:195], v[40:43]
    ds_read_b128 v[136:139], v6 offset:30720
    v_mfma_f32_16x16x32_bf16 v[88:91], v[160:163], v[196:199], v[88:91]
    ds_read_b128 v[140:143], v6 offset:31744
    v_mfma_f32_16x16x32_bf16 v[44:47], v[164:167], v[192:195], v[44:47]
    ds_read_b128 v[144:147], v6 offset:32768
    v_mfma_f32_16x16x32_bf16 v[92:95], v[164:167], v[196:199], v[92:95]
    ds_read_b128 v[148:151], v6 offset:33792
    v_mfma_f32_16x16x32_bf16 v[48:51], v[168:171], v[192:195], v[48:51]
    ds_read_b128 v[152:155], v6 offset:34816
    v_mfma_f32_16x16x32_bf16 v[96:99], v[168:171], v[196:199], v[96:99]
    ds_read_b128 v[156:159], v6 offset:35840
    v_mfma_f32_16x16x32_bf16 v[52:55], v[172:175], v[192:195], v[52:55]
    v_mfma_f32_16x16x32_bf16 v[100:103], v[172:175], v[196:199], v[100:103]
    v_mfma_f32_16x16x32_bf16 v[56:59], v[176:179], v[192:195], v[56:59]
    v_mfma_f32_16x16x32_bf16 v[104:107], v[176:179], v[196:199], v[104:107]
    v_mfma_f32_16x16x32_bf16 v[60:63], v[180:183], v[192:195], v[60:63]
    v_mfma_f32_16x16x32_bf16 v[108:111], v[180:183], v[196:199], v[108:111]
    s_waitcnt lgkmcnt(6)
    v_mfma_f32_16x16x32_bf16 v[16:19], v[112:115], v[184:187], v[16:19]
    ds_read_b128 v[192:195], v10 offset:1024
    v_mfma_f32_16x16x32_bf16 v[64:67], v[112:115], v[188:191], v[64:67]
    ds_read_b128 v[196:199], v10 offset:3072
    v_mfma_f32_16x16x32_bf16 v[20:23], v[116:119], v[184:187], v[20:23]
    ds_read_b128 v[160:163], v6 offset:36864
    v_mfma_f32_16x16x32_bf16 v[68:71], v[116:119], v[188:191], v[68:71]
    ds_read_b128 v[164:167], v6 offset:37888
    v_mfma_f32_16x16x32_bf16 v[24:27], v[120:123], v[184:187], v[24:27]
    ds_read_b128 v[168:171], v6 offset:38912
    v_mfma_f32_16x16x32_bf16 v[72:75], v[120:123], v[188:191], v[72:75]
    ds_read_b128 v[172:175], v6 offset:39936
    v_mfma_f32_16x16x32_bf16 v[28:31], v[124:127], v[184:187], v[28:31]
    ds_read_b128 v[176:179], v6 offset:40960
    v_mfma_f32_16x16x32_bf16 v[76:79], v[124:127], v[188:191], v[76:79]
    ds_read_b128 v[180:183], v6 offset:41984
    v_mfma_f32_16x16x32_bf16 v[32:35], v[128:131], v[184:187], v[32:35]
    v_mfma_f32_16x16x32_bf16 v[80:83], v[128:131], v[188:191], v[80:83]
    v_mfma_f32_16x16x32_bf16 v[36:39], v[132:135], v[184:187], v[36:39]
    v_mfma_f32_16x16x32_bf16 v[84:87], v[132:135], v[188:191], v[84:87]
    s_waitcnt lgkmcnt(8)
    v_mfma_f32_16x16x32_bf16 v[40:43], v[136:139], v[184:187], v[40:43]
    ds_read_b128 v[112:115], v6 offset:43008
    v_mfma_f32_16x16x32_bf16 v[88:91], v[136:139], v[188:191], v[88:91]
    ds_read_b128 v[116:119], v6 offset:44032
    v_mfma_f32_16x16x32_bf16 v[44:47], v[140:143], v[184:187], v[44:47]
    ds_read_b128 v[120:123], v6 offset:45056
    v_mfma_f32_16x16x32_bf16 v[92:95], v[140:143], v[188:191], v[92:95]
    ds_read_b128 v[124:127], v6 offset:46080
    v_mfma_f32_16x16x32_bf16 v[48:51], v[144:147], v[184:187], v[48:51]
    ds_read_b128 v[128:131], v6 offset:47104
    v_mfma_f32_16x16x32_bf16 v[96:99], v[144:147], v[188:191], v[96:99]
    ds_read_b128 v[132:135], v6 offset:48128
    v_mfma_f32_16x16x32_bf16 v[52:55], v[148:151], v[184:187], v[52:55]
    v_mfma_f32_16x16x32_bf16 v[100:103], v[148:151], v[188:191], v[100:103]
    v_mfma_f32_16x16x32_bf16 v[56:59], v[152:155], v[184:187], v[56:59]
    v_mfma_f32_16x16x32_bf16 v[104:107], v[152:155], v[188:191], v[104:107]
    v_mfma_f32_16x16x32_bf16 v[60:63], v[156:159], v[184:187], v[60:63]
    v_mfma_f32_16x16x32_bf16 v[108:111], v[156:159], v[188:191], v[108:111]
    s_waitcnt lgkmcnt(0)
    s_barrier
    v_mfma_f32_16x16x32_bf16 v[16:19], v[160:163], v[192:195], v[16:19]
    ds_read_b128 v[184:187], v10 offset:16384
    v_mfma_f32_16x16x32_bf16 v[64:67], v[160:163], v[196:199], v[64:67]
    ds_read_b128 v[188:191], v10 offset:18432
    v_mfma_f32_16x16x32_bf16 v[20:23], v[164:167], v[192:195], v[20:23]
    ds_read_b128 v[136:139], v5 offset:0
    v_mfma_f32_16x16x32_bf16 v[68:71], v[164:167], v[196:199], v[68:71]
    ds_read_b128 v[140:143], v5 offset:1024
    v_mfma_f32_16x16x32_bf16 v[24:27], v[168:171], v[192:195], v[24:27]
    ds_read_b128 v[144:147], v5 offset:2048
    v_mfma_f32_16x16x32_bf16 v[72:75], v[168:171], v[196:199], v[72:75]
    ds_read_b128 v[148:151], v5 offset:3072
    v_mfma_f32_16x16x32_bf16 v[28:31], v[172:175], v[192:195], v[28:31]
    ds_read_b128 v[152:155], v5 offset:4096
    v_mfma_f32_16x16x32_bf16 v[76:79], v[172:175], v[196:199], v[76:79]
    ds_read_b128 v[156:159], v5 offset:5120
    v_mfma_f32_16x16x32_bf16 v[32:35], v[176:179], v[192:195], v[32:35]
    v_mfma_f32_16x16x32_bf16 v[80:83], v[176:179], v[196:199], v[80:83]
    v_mfma_f32_16x16x32_bf16 v[36:39], v[180:183], v[192:195], v[36:39]
    v_mfma_f32_16x16x32_bf16 v[84:87], v[180:183], v[196:199], v[84:87]
    v_mfma_f32_16x16x32_bf16 v[40:43], v[112:115], v[192:195], v[40:43]
    ds_read_b128 v[160:163], v5 offset:6144
    v_mfma_f32_16x16x32_bf16 v[88:91], v[112:115], v[196:199], v[88:91]
    ds_read_b128 v[164:167], v5 offset:7168
    v_mfma_f32_16x16x32_bf16 v[44:47], v[116:119], v[192:195], v[44:47]
    ds_read_b128 v[168:171], v5 offset:8192
    v_mfma_f32_16x16x32_bf16 v[92:95], v[116:119], v[196:199], v[92:95]
    ds_read_b128 v[172:175], v5 offset:9216
    v_mfma_f32_16x16x32_bf16 v[48:51], v[120:123], v[192:195], v[48:51]
    ds_read_b128 v[176:179], v5 offset:10240
    v_mfma_f32_16x16x32_bf16 v[96:99], v[120:123], v[196:199], v[96:99]
    ds_read_b128 v[180:183], v5 offset:11264
    v_mfma_f32_16x16x32_bf16 v[52:55], v[124:127], v[192:195], v[52:55]
    v_mfma_f32_16x16x32_bf16 v[100:103], v[124:127], v[196:199], v[100:103]
    v_mfma_f32_16x16x32_bf16 v[56:59], v[128:131], v[192:195], v[56:59]
    v_mfma_f32_16x16x32_bf16 v[104:107], v[128:131], v[196:199], v[104:107]
    v_mfma_f32_16x16x32_bf16 v[60:63], v[132:135], v[192:195], v[60:63]
    v_mfma_f32_16x16x32_bf16 v[108:111], v[132:135], v[196:199], v[108:111]
    s_waitcnt lgkmcnt(6)
    v_mfma_f32_16x16x32_bf16 v[16:19], v[136:139], v[184:187], v[16:19]
    ds_read_b128 v[192:195], v10 offset:17408
    v_mfma_f32_16x16x32_bf16 v[64:67], v[136:139], v[188:191], v[64:67]
    ds_read_b128 v[196:199], v10 offset:19456
    v_mfma_f32_16x16x32_bf16 v[20:23], v[140:143], v[184:187], v[20:23]
    ds_read_b128 v[112:115], v5 offset:12288
    v_mfma_f32_16x16x32_bf16 v[68:71], v[140:143], v[188:191], v[68:71]
    ds_read_b128 v[116:119], v5 offset:13312
    v_mfma_f32_16x16x32_bf16 v[24:27], v[144:147], v[184:187], v[24:27]
    ds_read_b128 v[120:123], v5 offset:14336
    v_mfma_f32_16x16x32_bf16 v[72:75], v[144:147], v[188:191], v[72:75]
    ds_read_b128 v[124:127], v5 offset:15360
    v_mfma_f32_16x16x32_bf16 v[28:31], v[148:151], v[184:187], v[28:31]
    ds_read_b128 v[128:131], v5 offset:16384
    v_mfma_f32_16x16x32_bf16 v[76:79], v[148:151], v[188:191], v[76:79]
    ds_read_b128 v[132:135], v5 offset:17408
    v_mfma_f32_16x16x32_bf16 v[32:35], v[152:155], v[184:187], v[32:35]
    v_mfma_f32_16x16x32_bf16 v[80:83], v[152:155], v[188:191], v[80:83]
    v_mfma_f32_16x16x32_bf16 v[36:39], v[156:159], v[184:187], v[36:39]
    v_mfma_f32_16x16x32_bf16 v[84:87], v[156:159], v[188:191], v[84:87]
    s_waitcnt lgkmcnt(8)
    v_mfma_f32_16x16x32_bf16 v[40:43], v[160:163], v[184:187], v[40:43]
    ds_read_b128 v[136:139], v5 offset:18432
    v_mfma_f32_16x16x32_bf16 v[88:91], v[160:163], v[188:191], v[88:91]
    ds_read_b128 v[140:143], v5 offset:19456
    v_mfma_f32_16x16x32_bf16 v[44:47], v[164:167], v[184:187], v[44:47]
    ds_read_b128 v[144:147], v5 offset:20480
    v_mfma_f32_16x16x32_bf16 v[92:95], v[164:167], v[188:191], v[92:95]
    ds_read_b128 v[148:151], v5 offset:21504
    v_mfma_f32_16x16x32_bf16 v[48:51], v[168:171], v[184:187], v[48:51]
    ds_read_b128 v[152:155], v5 offset:22528
    v_mfma_f32_16x16x32_bf16 v[96:99], v[168:171], v[188:191], v[96:99]
    ds_read_b128 v[156:159], v5 offset:23552
    v_mfma_f32_16x16x32_bf16 v[52:55], v[172:175], v[184:187], v[52:55]
    v_mfma_f32_16x16x32_bf16 v[100:103], v[172:175], v[188:191], v[100:103]
    v_mfma_f32_16x16x32_bf16 v[56:59], v[176:179], v[184:187], v[56:59]
    v_mfma_f32_16x16x32_bf16 v[104:107], v[176:179], v[188:191], v[104:107]
    v_mfma_f32_16x16x32_bf16 v[60:63], v[180:183], v[184:187], v[60:63]
    v_mfma_f32_16x16x32_bf16 v[108:111], v[180:183], v[188:191], v[108:111]
    s_waitcnt lgkmcnt(0)
    s_barrier
    v_mfma_f32_16x16x32_bf16 v[16:19], v[112:115], v[192:195], v[16:19]
    ds_read_b128 v[184:187], v10 offset:32768
    v_mfma_f32_16x16x32_bf16 v[64:67], v[112:115], v[196:199], v[64:67]
    ds_read_b128 v[188:191], v10 offset:34816
    v_mfma_f32_16x16x32_bf16 v[20:23], v[116:119], v[192:195], v[20:23]
    ds_read_b128 v[160:163], v5 offset:24576
    v_mfma_f32_16x16x32_bf16 v[68:71], v[116:119], v[196:199], v[68:71]
    ds_read_b128 v[164:167], v5 offset:25600
    v_mfma_f32_16x16x32_bf16 v[24:27], v[120:123], v[192:195], v[24:27]
    ds_read_b128 v[168:171], v5 offset:26624
    v_mfma_f32_16x16x32_bf16 v[72:75], v[120:123], v[196:199], v[72:75]
    ds_read_b128 v[172:175], v5 offset:27648
    v_mfma_f32_16x16x32_bf16 v[28:31], v[124:127], v[192:195], v[28:31]
    ds_read_b128 v[176:179], v5 offset:28672
    v_mfma_f32_16x16x32_bf16 v[76:79], v[124:127], v[196:199], v[76:79]
    ds_read_b128 v[180:183], v5 offset:29696
    v_mfma_f32_16x16x32_bf16 v[32:35], v[128:131], v[192:195], v[32:35]
    v_mfma_f32_16x16x32_bf16 v[80:83], v[128:131], v[196:199], v[80:83]
    v_mfma_f32_16x16x32_bf16 v[36:39], v[132:135], v[192:195], v[36:39]
    v_mfma_f32_16x16x32_bf16 v[84:87], v[132:135], v[196:199], v[84:87]
    v_mfma_f32_16x16x32_bf16 v[40:43], v[136:139], v[192:195], v[40:43]
    ds_read_b128 v[112:115], v5 offset:30720
    v_mfma_f32_16x16x32_bf16 v[88:91], v[136:139], v[196:199], v[88:91]
    ds_read_b128 v[116:119], v5 offset:31744
    v_mfma_f32_16x16x32_bf16 v[44:47], v[140:143], v[192:195], v[44:47]
    ds_read_b128 v[120:123], v5 offset:32768
    v_mfma_f32_16x16x32_bf16 v[92:95], v[140:143], v[196:199], v[92:95]
    ds_read_b128 v[124:127], v5 offset:33792
    v_mfma_f32_16x16x32_bf16 v[48:51], v[144:147], v[192:195], v[48:51]
    ds_read_b128 v[128:131], v5 offset:34816
    v_mfma_f32_16x16x32_bf16 v[96:99], v[144:147], v[196:199], v[96:99]
    ds_read_b128 v[132:135], v5 offset:35840
    v_mfma_f32_16x16x32_bf16 v[52:55], v[148:151], v[192:195], v[52:55]
    v_mfma_f32_16x16x32_bf16 v[100:103], v[148:151], v[196:199], v[100:103]
    v_mfma_f32_16x16x32_bf16 v[56:59], v[152:155], v[192:195], v[56:59]
    v_mfma_f32_16x16x32_bf16 v[104:107], v[152:155], v[196:199], v[104:107]
    v_mfma_f32_16x16x32_bf16 v[60:63], v[156:159], v[192:195], v[60:63]
    v_mfma_f32_16x16x32_bf16 v[108:111], v[156:159], v[196:199], v[108:111]
    s_waitcnt lgkmcnt(6)
    v_mfma_f32_16x16x32_bf16 v[16:19], v[160:163], v[184:187], v[16:19]
    ds_read_b128 v[192:195], v10 offset:33792
    v_mfma_f32_16x16x32_bf16 v[64:67], v[160:163], v[188:191], v[64:67]
    ds_read_b128 v[196:199], v10 offset:35840
    v_mfma_f32_16x16x32_bf16 v[20:23], v[164:167], v[184:187], v[20:23]
    ds_read_b128 v[136:139], v5 offset:36864
    v_mfma_f32_16x16x32_bf16 v[68:71], v[164:167], v[188:191], v[68:71]
    ds_read_b128 v[140:143], v5 offset:37888
    v_mfma_f32_16x16x32_bf16 v[24:27], v[168:171], v[184:187], v[24:27]
    ds_read_b128 v[144:147], v5 offset:38912
    v_mfma_f32_16x16x32_bf16 v[72:75], v[168:171], v[188:191], v[72:75]
    ds_read_b128 v[148:151], v5 offset:39936
    v_mfma_f32_16x16x32_bf16 v[28:31], v[172:175], v[184:187], v[28:31]
    ds_read_b128 v[152:155], v5 offset:40960
    v_mfma_f32_16x16x32_bf16 v[76:79], v[172:175], v[188:191], v[76:79]
    ds_read_b128 v[156:159], v5 offset:41984
    v_mfma_f32_16x16x32_bf16 v[32:35], v[176:179], v[184:187], v[32:35]
    v_mfma_f32_16x16x32_bf16 v[80:83], v[176:179], v[188:191], v[80:83]
    v_mfma_f32_16x16x32_bf16 v[36:39], v[180:183], v[184:187], v[36:39]
    v_mfma_f32_16x16x32_bf16 v[84:87], v[180:183], v[188:191], v[84:87]
    s_waitcnt lgkmcnt(8)
    v_mfma_f32_16x16x32_bf16 v[40:43], v[112:115], v[184:187], v[40:43]
    ds_read_b128 v[160:163], v5 offset:43008
    v_mfma_f32_16x16x32_bf16 v[88:91], v[112:115], v[188:191], v[88:91]
    ds_read_b128 v[164:167], v5 offset:44032
    v_mfma_f32_16x16x32_bf16 v[44:47], v[116:119], v[184:187], v[44:47]
    ds_read_b128 v[168:171], v5 offset:45056
    v_mfma_f32_16x16x32_bf16 v[92:95], v[116:119], v[188:191], v[92:95]
    ds_read_b128 v[172:175], v5 offset:46080
    v_mfma_f32_16x16x32_bf16 v[48:51], v[120:123], v[184:187], v[48:51]
    ds_read_b128 v[176:179], v5 offset:47104
    v_mfma_f32_16x16x32_bf16 v[96:99], v[120:123], v[188:191], v[96:99]
    ds_read_b128 v[180:183], v5 offset:48128
    v_mfma_f32_16x16x32_bf16 v[52:55], v[124:127], v[184:187], v[52:55]
    v_mfma_f32_16x16x32_bf16 v[100:103], v[124:127], v[188:191], v[100:103]
    v_mfma_f32_16x16x32_bf16 v[56:59], v[128:131], v[184:187], v[56:59]
    v_mfma_f32_16x16x32_bf16 v[104:107], v[128:131], v[188:191], v[104:107]
    v_mfma_f32_16x16x32_bf16 v[60:63], v[132:135], v[184:187], v[60:63]
    v_mfma_f32_16x16x32_bf16 v[108:111], v[132:135], v[188:191], v[108:111]
    s_waitcnt lgkmcnt(0)
    s_barrier
    v_mfma_f32_16x16x32_bf16 v[16:19], v[136:139], v[192:195], v[16:19]
    ds_read_b128 v[184:187], v10 offset:0
    v_mfma_f32_16x16x32_bf16 v[64:67], v[136:139], v[196:199], v[64:67]
    ds_read_b128 v[188:191], v10 offset:2048
    v_mfma_f32_16x16x32_bf16 v[20:23], v[140:143], v[192:195], v[20:23]
    ds_read_b128 v[112:115], v6 offset:0
    v_mfma_f32_16x16x32_bf16 v[68:71], v[140:143], v[196:199], v[68:71]
    ds_read_b128 v[116:119], v6 offset:1024
    v_mfma_f32_16x16x32_bf16 v[24:27], v[144:147], v[192:195], v[24:27]
    ds_read_b128 v[120:123], v6 offset:2048
    v_mfma_f32_16x16x32_bf16 v[72:75], v[144:147], v[196:199], v[72:75]
    ds_read_b128 v[124:127], v6 offset:3072
    v_mfma_f32_16x16x32_bf16 v[28:31], v[148:151], v[192:195], v[28:31]
    ds_read_b128 v[128:131], v6 offset:4096
    v_mfma_f32_16x16x32_bf16 v[76:79], v[148:151], v[196:199], v[76:79]
    ds_read_b128 v[132:135], v6 offset:5120
    v_mfma_f32_16x16x32_bf16 v[32:35], v[152:155], v[192:195], v[32:35]
    v_mfma_f32_16x16x32_bf16 v[80:83], v[152:155], v[196:199], v[80:83]
    v_mfma_f32_16x16x32_bf16 v[36:39], v[156:159], v[192:195], v[36:39]
    v_mfma_f32_16x16x32_bf16 v[84:87], v[156:159], v[196:199], v[84:87]
    v_mfma_f32_16x16x32_bf16 v[40:43], v[160:163], v[192:195], v[40:43]
    ds_read_b128 v[136:139], v6 offset:6144
    v_mfma_f32_16x16x32_bf16 v[88:91], v[160:163], v[196:199], v[88:91]
    ds_read_b128 v[140:143], v6 offset:7168
    v_mfma_f32_16x16x32_bf16 v[44:47], v[164:167], v[192:195], v[44:47]
    ds_read_b128 v[144:147], v6 offset:8192
    v_mfma_f32_16x16x32_bf16 v[92:95], v[164:167], v[196:199], v[92:95]
    ds_read_b128 v[148:151], v6 offset:9216
    v_mfma_f32_16x16x32_bf16 v[48:51], v[168:171], v[192:195], v[48:51]
    ds_read_b128 v[152:155], v6 offset:10240
    v_mfma_f32_16x16x32_bf16 v[96:99], v[168:171], v[196:199], v[96:99]
    ds_read_b128 v[156:159], v6 offset:11264
    v_mfma_f32_16x16x32_bf16 v[52:55], v[172:175], v[192:195], v[52:55]
    v_mfma_f32_16x16x32_bf16 v[100:103], v[172:175], v[196:199], v[100:103]
    v_mfma_f32_16x16x32_bf16 v[56:59], v[176:179], v[192:195], v[56:59]
    v_mfma_f32_16x16x32_bf16 v[104:107], v[176:179], v[196:199], v[104:107]
    v_mfma_f32_16x16x32_bf16 v[60:63], v[180:183], v[192:195], v[60:63]
    v_mfma_f32_16x16x32_bf16 v[108:111], v[180:183], v[196:199], v[108:111]
    s_waitcnt lgkmcnt(6)
    v_mfma_f32_16x16x32_bf16 v[16:19], v[112:115], v[184:187], v[16:19]
    ds_read_b128 v[192:195], v10 offset:1024
    v_mfma_f32_16x16x32_bf16 v[64:67], v[112:115], v[188:191], v[64:67]
    ds_read_b128 v[196:199], v10 offset:3072
    v_mfma_f32_16x16x32_bf16 v[20:23], v[116:119], v[184:187], v[20:23]
    ds_read_b128 v[160:163], v6 offset:12288
    v_mfma_f32_16x16x32_bf16 v[68:71], v[116:119], v[188:191], v[68:71]
    ds_read_b128 v[164:167], v6 offset:13312
    v_mfma_f32_16x16x32_bf16 v[24:27], v[120:123], v[184:187], v[24:27]
    ds_read_b128 v[168:171], v6 offset:14336
    v_mfma_f32_16x16x32_bf16 v[72:75], v[120:123], v[188:191], v[72:75]
    ds_read_b128 v[172:175], v6 offset:15360
    v_mfma_f32_16x16x32_bf16 v[28:31], v[124:127], v[184:187], v[28:31]
    ds_read_b128 v[176:179], v6 offset:16384
    v_mfma_f32_16x16x32_bf16 v[76:79], v[124:127], v[188:191], v[76:79]
    ds_read_b128 v[180:183], v6 offset:17408
    v_mfma_f32_16x16x32_bf16 v[32:35], v[128:131], v[184:187], v[32:35]
    v_mfma_f32_16x16x32_bf16 v[80:83], v[128:131], v[188:191], v[80:83]
    v_mfma_f32_16x16x32_bf16 v[36:39], v[132:135], v[184:187], v[36:39]
    v_mfma_f32_16x16x32_bf16 v[84:87], v[132:135], v[188:191], v[84:87]
    s_waitcnt lgkmcnt(8)
    v_mfma_f32_16x16x32_bf16 v[40:43], v[136:139], v[184:187], v[40:43]
    ds_read_b128 v[112:115], v6 offset:18432
    v_mfma_f32_16x16x32_bf16 v[88:91], v[136:139], v[188:191], v[88:91]
    ds_read_b128 v[116:119], v6 offset:19456
    v_mfma_f32_16x16x32_bf16 v[44:47], v[140:143], v[184:187], v[44:47]
    ds_read_b128 v[120:123], v6 offset:20480
    v_mfma_f32_16x16x32_bf16 v[92:95], v[140:143], v[188:191], v[92:95]
    ds_read_b128 v[124:127], v6 offset:21504
    v_mfma_f32_16x16x32_bf16 v[48:51], v[144:147], v[184:187], v[48:51]
    ds_read_b128 v[128:131], v6 offset:22528
    v_mfma_f32_16x16x32_bf16 v[96:99], v[144:147], v[188:191], v[96:99]
    ds_read_b128 v[132:135], v6 offset:23552
    v_mfma_f32_16x16x32_bf16 v[52:55], v[148:151], v[184:187], v[52:55]
    v_mfma_f32_16x16x32_bf16 v[100:103], v[148:151], v[188:191], v[100:103]
    v_mfma_f32_16x16x32_bf16 v[56:59], v[152:155], v[184:187], v[56:59]
    v_mfma_f32_16x16x32_bf16 v[104:107], v[152:155], v[188:191], v[104:107]
    v_mfma_f32_16x16x32_bf16 v[60:63], v[156:159], v[184:187], v[60:63]
    v_mfma_f32_16x16x32_bf16 v[108:111], v[156:159], v[188:191], v[108:111]
    s_waitcnt lgkmcnt(0)
    s_barrier
    v_mfma_f32_16x16x32_bf16 v[16:19], v[160:163], v[192:195], v[16:19]
    ds_read_b128 v[184:187], v10 offset:16384
    v_mfma_f32_16x16x32_bf16 v[64:67], v[160:163], v[196:199], v[64:67]
    ds_read_b128 v[188:191], v10 offset:18432
    v_mfma_f32_16x16x32_bf16 v[20:23], v[164:167], v[192:195], v[20:23]
    ds_read_b128 v[136:139], v6 offset:24576
    v_mfma_f32_16x16x32_bf16 v[68:71], v[164:167], v[196:199], v[68:71]
    ds_read_b128 v[140:143], v6 offset:25600
    v_mfma_f32_16x16x32_bf16 v[24:27], v[168:171], v[192:195], v[24:27]
    ds_read_b128 v[144:147], v6 offset:26624
    v_mfma_f32_16x16x32_bf16 v[72:75], v[168:171], v[196:199], v[72:75]
    ds_read_b128 v[148:151], v6 offset:27648
    v_mfma_f32_16x16x32_bf16 v[28:31], v[172:175], v[192:195], v[28:31]
    ds_read_b128 v[152:155], v6 offset:28672
    v_mfma_f32_16x16x32_bf16 v[76:79], v[172:175], v[196:199], v[76:79]
    ds_read_b128 v[156:159], v6 offset:29696
    v_mfma_f32_16x16x32_bf16 v[32:35], v[176:179], v[192:195], v[32:35]
    v_mfma_f32_16x16x32_bf16 v[80:83], v[176:179], v[196:199], v[80:83]
    v_mfma_f32_16x16x32_bf16 v[36:39], v[180:183], v[192:195], v[36:39]
    v_mfma_f32_16x16x32_bf16 v[84:87], v[180:183], v[196:199], v[84:87]
    v_mfma_f32_16x16x32_bf16 v[40:43], v[112:115], v[192:195], v[40:43]
    ds_read_b128 v[160:163], v6 offset:30720
    v_mfma_f32_16x16x32_bf16 v[88:91], v[112:115], v[196:199], v[88:91]
    ds_read_b128 v[164:167], v6 offset:31744
    v_mfma_f32_16x16x32_bf16 v[44:47], v[116:119], v[192:195], v[44:47]
    ds_read_b128 v[168:171], v6 offset:32768
    v_mfma_f32_16x16x32_bf16 v[92:95], v[116:119], v[196:199], v[92:95]
    ds_read_b128 v[172:175], v6 offset:33792
    v_mfma_f32_16x16x32_bf16 v[48:51], v[120:123], v[192:195], v[48:51]
    ds_read_b128 v[176:179], v6 offset:34816
    v_mfma_f32_16x16x32_bf16 v[96:99], v[120:123], v[196:199], v[96:99]
    ds_read_b128 v[180:183], v6 offset:35840
    v_mfma_f32_16x16x32_bf16 v[52:55], v[124:127], v[192:195], v[52:55]
    v_mfma_f32_16x16x32_bf16 v[100:103], v[124:127], v[196:199], v[100:103]
    v_mfma_f32_16x16x32_bf16 v[56:59], v[128:131], v[192:195], v[56:59]
    v_mfma_f32_16x16x32_bf16 v[104:107], v[128:131], v[196:199], v[104:107]
    v_mfma_f32_16x16x32_bf16 v[60:63], v[132:135], v[192:195], v[60:63]
    v_mfma_f32_16x16x32_bf16 v[108:111], v[132:135], v[196:199], v[108:111]
    s_waitcnt lgkmcnt(6)
    v_mfma_f32_16x16x32_bf16 v[16:19], v[136:139], v[184:187], v[16:19]
    ds_read_b128 v[192:195], v10 offset:17408
    v_mfma_f32_16x16x32_bf16 v[64:67], v[136:139], v[188:191], v[64:67]
    ds_read_b128 v[196:199], v10 offset:19456
    v_mfma_f32_16x16x32_bf16 v[20:23], v[140:143], v[184:187], v[20:23]
    ds_read_b128 v[112:115], v6 offset:36864
    v_mfma_f32_16x16x32_bf16 v[68:71], v[140:143], v[188:191], v[68:71]
    ds_read_b128 v[116:119], v6 offset:37888
    v_mfma_f32_16x16x32_bf16 v[24:27], v[144:147], v[184:187], v[24:27]
    ds_read_b128 v[120:123], v6 offset:38912
    v_mfma_f32_16x16x32_bf16 v[72:75], v[144:147], v[188:191], v[72:75]
    ds_read_b128 v[124:127], v6 offset:39936
    v_mfma_f32_16x16x32_bf16 v[28:31], v[148:151], v[184:187], v[28:31]
    ds_read_b128 v[128:131], v6 offset:40960
    v_mfma_f32_16x16x32_bf16 v[76:79], v[148:151], v[188:191], v[76:79]
    ds_read_b128 v[132:135], v6 offset:41984
    v_mfma_f32_16x16x32_bf16 v[32:35], v[152:155], v[184:187], v[32:35]
    v_mfma_f32_16x16x32_bf16 v[80:83], v[152:155], v[188:191], v[80:83]
    v_mfma_f32_16x16x32_bf16 v[36:39], v[156:159], v[184:187], v[36:39]
    v_mfma_f32_16x16x32_bf16 v[84:87], v[156:159], v[188:191], v[84:87]
    s_waitcnt lgkmcnt(8)
    v_mfma_f32_16x16x32_bf16 v[40:43], v[160:163], v[184:187], v[40:43]
    ds_read_b128 v[136:139], v6 offset:43008
    v_mfma_f32_16x16x32_bf16 v[88:91], v[160:163], v[188:191], v[88:91]
    ds_read_b128 v[140:143], v6 offset:44032
    v_mfma_f32_16x16x32_bf16 v[44:47], v[164:167], v[184:187], v[44:47]
    ds_read_b128 v[144:147], v6 offset:45056
    v_mfma_f32_16x16x32_bf16 v[92:95], v[164:167], v[188:191], v[92:95]
    ds_read_b128 v[148:151], v6 offset:46080
    v_mfma_f32_16x16x32_bf16 v[48:51], v[168:171], v[184:187], v[48:51]
    ds_read_b128 v[152:155], v6 offset:47104
    v_mfma_f32_16x16x32_bf16 v[96:99], v[168:171], v[188:191], v[96:99]
    ds_read_b128 v[156:159], v6 offset:48128
    v_mfma_f32_16x16x32_bf16 v[52:55], v[172:175], v[184:187], v[52:55]
    v_mfma_f32_16x16x32_bf16 v[100:103], v[172:175], v[188:191], v[100:103]
    v_mfma_f32_16x16x32_bf16 v[56:59], v[176:179], v[184:187], v[56:59]
    v_mfma_f32_16x16x32_bf16 v[104:107], v[176:179], v[188:191], v[104:107]
    v_mfma_f32_16x16x32_bf16 v[60:63], v[180:183], v[184:187], v[60:63]
    v_mfma_f32_16x16x32_bf16 v[108:111], v[180:183], v[188:191], v[108:111]
    s_waitcnt lgkmcnt(0)
    s_barrier
    v_mfma_f32_16x16x32_bf16 v[16:19], v[112:115], v[192:195], v[16:19]
    ds_read_b128 v[184:187], v10 offset:32768
    v_mfma_f32_16x16x32_bf16 v[64:67], v[112:115], v[196:199], v[64:67]
    ds_read_b128 v[188:191], v10 offset:34816
    v_mfma_f32_16x16x32_bf16 v[20:23], v[116:119], v[192:195], v[20:23]
    ds_read_b128 v[160:163], v5 offset:0
    v_mfma_f32_16x16x32_bf16 v[68:71], v[116:119], v[196:199], v[68:71]
    ds_read_b128 v[164:167], v5 offset:1024
    v_mfma_f32_16x16x32_bf16 v[24:27], v[120:123], v[192:195], v[24:27]
    ds_read_b128 v[168:171], v5 offset:2048
    v_mfma_f32_16x16x32_bf16 v[72:75], v[120:123], v[196:199], v[72:75]
    ds_read_b128 v[172:175], v5 offset:3072
    v_mfma_f32_16x16x32_bf16 v[28:31], v[124:127], v[192:195], v[28:31]
    ds_read_b128 v[176:179], v5 offset:4096
    v_mfma_f32_16x16x32_bf16 v[76:79], v[124:127], v[196:199], v[76:79]
    ds_read_b128 v[180:183], v5 offset:5120
    v_mfma_f32_16x16x32_bf16 v[32:35], v[128:131], v[192:195], v[32:35]
    v_mfma_f32_16x16x32_bf16 v[80:83], v[128:131], v[196:199], v[80:83]
    v_mfma_f32_16x16x32_bf16 v[36:39], v[132:135], v[192:195], v[36:39]
    v_mfma_f32_16x16x32_bf16 v[84:87], v[132:135], v[196:199], v[84:87]
    v_mfma_f32_16x16x32_bf16 v[40:43], v[136:139], v[192:195], v[40:43]
    ds_read_b128 v[112:115], v5 offset:6144
    v_mfma_f32_16x16x32_bf16 v[88:91], v[136:139], v[196:199], v[88:91]
    ds_read_b128 v[116:119], v5 offset:7168
    v_mfma_f32_16x16x32_bf16 v[44:47], v[140:143], v[192:195], v[44:47]
    ds_read_b128 v[120:123], v5 offset:8192
    v_mfma_f32_16x16x32_bf16 v[92:95], v[140:143], v[196:199], v[92:95]
    ds_read_b128 v[124:127], v5 offset:9216
    v_mfma_f32_16x16x32_bf16 v[48:51], v[144:147], v[192:195], v[48:51]
    ds_read_b128 v[128:131], v5 offset:10240
    v_mfma_f32_16x16x32_bf16 v[96:99], v[144:147], v[196:199], v[96:99]
    ds_read_b128 v[132:135], v5 offset:11264
    v_mfma_f32_16x16x32_bf16 v[52:55], v[148:151], v[192:195], v[52:55]
    v_mfma_f32_16x16x32_bf16 v[100:103], v[148:151], v[196:199], v[100:103]
    v_mfma_f32_16x16x32_bf16 v[56:59], v[152:155], v[192:195], v[56:59]
    v_mfma_f32_16x16x32_bf16 v[104:107], v[152:155], v[196:199], v[104:107]
    v_mfma_f32_16x16x32_bf16 v[60:63], v[156:159], v[192:195], v[60:63]
    v_mfma_f32_16x16x32_bf16 v[108:111], v[156:159], v[196:199], v[108:111]
    s_waitcnt lgkmcnt(6)
    v_mfma_f32_16x16x32_bf16 v[16:19], v[160:163], v[184:187], v[16:19]
    ds_read_b128 v[192:195], v10 offset:33792
    v_mfma_f32_16x16x32_bf16 v[64:67], v[160:163], v[188:191], v[64:67]
    ds_read_b128 v[196:199], v10 offset:35840
    v_mfma_f32_16x16x32_bf16 v[20:23], v[164:167], v[184:187], v[20:23]
    ds_read_b128 v[136:139], v5 offset:12288
    v_mfma_f32_16x16x32_bf16 v[68:71], v[164:167], v[188:191], v[68:71]
    ds_read_b128 v[140:143], v5 offset:13312
    v_mfma_f32_16x16x32_bf16 v[24:27], v[168:171], v[184:187], v[24:27]
    ds_read_b128 v[144:147], v5 offset:14336
    v_mfma_f32_16x16x32_bf16 v[72:75], v[168:171], v[188:191], v[72:75]
    ds_read_b128 v[148:151], v5 offset:15360
    v_mfma_f32_16x16x32_bf16 v[28:31], v[172:175], v[184:187], v[28:31]
    ds_read_b128 v[152:155], v5 offset:16384
    v_mfma_f32_16x16x32_bf16 v[76:79], v[172:175], v[188:191], v[76:79]
    ds_read_b128 v[156:159], v5 offset:17408
    v_mfma_f32_16x16x32_bf16 v[32:35], v[176:179], v[184:187], v[32:35]
    v_mfma_f32_16x16x32_bf16 v[80:83], v[176:179], v[188:191], v[80:83]
    v_mfma_f32_16x16x32_bf16 v[36:39], v[180:183], v[184:187], v[36:39]
    v_mfma_f32_16x16x32_bf16 v[84:87], v[180:183], v[188:191], v[84:87]
    s_waitcnt lgkmcnt(8)
    v_mfma_f32_16x16x32_bf16 v[40:43], v[112:115], v[184:187], v[40:43]
    ds_read_b128 v[160:163], v5 offset:18432
    v_mfma_f32_16x16x32_bf16 v[88:91], v[112:115], v[188:191], v[88:91]
    ds_read_b128 v[164:167], v5 offset:19456
    v_mfma_f32_16x16x32_bf16 v[44:47], v[116:119], v[184:187], v[44:47]
    ds_read_b128 v[168:171], v5 offset:20480
    v_mfma_f32_16x16x32_bf16 v[92:95], v[116:119], v[188:191], v[92:95]
    ds_read_b128 v[172:175], v5 offset:21504
    v_mfma_f32_16x16x32_bf16 v[48:51], v[120:123], v[184:187], v[48:51]
    ds_read_b128 v[176:179], v5 offset:22528
    v_mfma_f32_16x16x32_bf16 v[96:99], v[120:123], v[188:191], v[96:99]
    ds_read_b128 v[180:183], v5 offset:23552
    v_mfma_f32_16x16x32_bf16 v[52:55], v[124:127], v[184:187], v[52:55]
    v_mfma_f32_16x16x32_bf16 v[100:103], v[124:127], v[188:191], v[100:103]
    v_mfma_f32_16x16x32_bf16 v[56:59], v[128:131], v[184:187], v[56:59]
    v_mfma_f32_16x16x32_bf16 v[104:107], v[128:131], v[188:191], v[104:107]
    v_mfma_f32_16x16x32_bf16 v[60:63], v[132:135], v[184:187], v[60:63]
    v_mfma_f32_16x16x32_bf16 v[108:111], v[132:135], v[188:191], v[108:111]
    s_waitcnt lgkmcnt(6)
    v_mfma_f32_16x16x32_bf16 v[16:19], v[136:139], v[192:195], v[16:19]
    ds_read_b128 v[184:187], v10 offset:0
    v_mfma_f32_16x16x32_bf16 v[64:67], v[136:139], v[196:199], v[64:67]
    ds_read_b128 v[188:191], v10 offset:2048
    v_mfma_f32_16x16x32_bf16 v[20:23], v[140:143], v[192:195], v[20:23]
    ds_read_b128 v[112:115], v5 offset:24576
    v_mfma_f32_16x16x32_bf16 v[68:71], v[140:143], v[196:199], v[68:71]
    ds_read_b128 v[116:119], v5 offset:25600
    v_mfma_f32_16x16x32_bf16 v[24:27], v[144:147], v[192:195], v[24:27]
    ds_read_b128 v[120:123], v5 offset:26624
    v_mfma_f32_16x16x32_bf16 v[72:75], v[144:147], v[196:199], v[72:75]
    ds_read_b128 v[124:127], v5 offset:27648
    v_mfma_f32_16x16x32_bf16 v[28:31], v[148:151], v[192:195], v[28:31]
    ds_read_b128 v[128:131], v5 offset:28672
    v_mfma_f32_16x16x32_bf16 v[76:79], v[148:151], v[196:199], v[76:79]
    ds_read_b128 v[132:135], v5 offset:29696
    v_mfma_f32_16x16x32_bf16 v[32:35], v[152:155], v[192:195], v[32:35]
    v_mfma_f32_16x16x32_bf16 v[80:83], v[152:155], v[196:199], v[80:83]
    v_mfma_f32_16x16x32_bf16 v[36:39], v[156:159], v[192:195], v[36:39]
    v_mfma_f32_16x16x32_bf16 v[84:87], v[156:159], v[196:199], v[84:87]
    s_waitcnt lgkmcnt(8)
    v_mfma_f32_16x16x32_bf16 v[40:43], v[160:163], v[192:195], v[40:43]
    ds_read_b128 v[136:139], v5 offset:30720
    v_mfma_f32_16x16x32_bf16 v[88:91], v[160:163], v[196:199], v[88:91]
    ds_read_b128 v[140:143], v5 offset:31744
    v_mfma_f32_16x16x32_bf16 v[44:47], v[164:167], v[192:195], v[44:47]
    ds_read_b128 v[144:147], v5 offset:32768
    v_mfma_f32_16x16x32_bf16 v[92:95], v[164:167], v[196:199], v[92:95]
    ds_read_b128 v[148:151], v5 offset:33792
    v_mfma_f32_16x16x32_bf16 v[48:51], v[168:171], v[192:195], v[48:51]
    ds_read_b128 v[152:155], v5 offset:34816
    v_mfma_f32_16x16x32_bf16 v[96:99], v[168:171], v[196:199], v[96:99]
    ds_read_b128 v[156:159], v5 offset:35840
    v_mfma_f32_16x16x32_bf16 v[52:55], v[172:175], v[192:195], v[52:55]
    v_mfma_f32_16x16x32_bf16 v[100:103], v[172:175], v[196:199], v[100:103]
    v_mfma_f32_16x16x32_bf16 v[56:59], v[176:179], v[192:195], v[56:59]
    v_mfma_f32_16x16x32_bf16 v[104:107], v[176:179], v[196:199], v[104:107]
    v_mfma_f32_16x16x32_bf16 v[60:63], v[180:183], v[192:195], v[60:63]
    v_mfma_f32_16x16x32_bf16 v[108:111], v[180:183], v[196:199], v[108:111]
    s_waitcnt lgkmcnt(6)
    v_mfma_f32_16x16x32_bf16 v[16:19], v[112:115], v[184:187], v[16:19]
    ds_read_b128 v[192:195], v10 offset:1024
    v_mfma_f32_16x16x32_bf16 v[64:67], v[112:115], v[188:191], v[64:67]
    ds_read_b128 v[196:199], v10 offset:3072
    v_mfma_f32_16x16x32_bf16 v[20:23], v[116:119], v[184:187], v[20:23]
    ds_read_b128 v[160:163], v5 offset:36864
    v_mfma_f32_16x16x32_bf16 v[68:71], v[116:119], v[188:191], v[68:71]
    ds_read_b128 v[164:167], v5 offset:37888
    v_mfma_f32_16x16x32_bf16 v[24:27], v[120:123], v[184:187], v[24:27]
    ds_read_b128 v[168:171], v5 offset:38912
    v_mfma_f32_16x16x32_bf16 v[72:75], v[120:123], v[188:191], v[72:75]
    ds_read_b128 v[172:175], v5 offset:39936
    v_mfma_f32_16x16x32_bf16 v[28:31], v[124:127], v[184:187], v[28:31]
    ds_read_b128 v[176:179], v5 offset:40960
    v_mfma_f32_16x16x32_bf16 v[76:79], v[124:127], v[188:191], v[76:79]
    ds_read_b128 v[180:183], v5 offset:41984
    v_mfma_f32_16x16x32_bf16 v[32:35], v[128:131], v[184:187], v[32:35]
    v_mfma_f32_16x16x32_bf16 v[80:83], v[128:131], v[188:191], v[80:83]
    v_mfma_f32_16x16x32_bf16 v[36:39], v[132:135], v[184:187], v[36:39]
    v_mfma_f32_16x16x32_bf16 v[84:87], v[132:135], v[188:191], v[84:87]
    s_waitcnt lgkmcnt(8)
    v_mfma_f32_16x16x32_bf16 v[40:43], v[136:139], v[184:187], v[40:43]
    ds_read_b128 v[112:115], v5 offset:43008
    v_mfma_f32_16x16x32_bf16 v[88:91], v[136:139], v[188:191], v[88:91]
    ds_read_b128 v[116:119], v5 offset:44032
    v_mfma_f32_16x16x32_bf16 v[44:47], v[140:143], v[184:187], v[44:47]
    ds_read_b128 v[120:123], v5 offset:45056
    v_mfma_f32_16x16x32_bf16 v[92:95], v[140:143], v[188:191], v[92:95]
    ds_read_b128 v[124:127], v5 offset:46080
    v_mfma_f32_16x16x32_bf16 v[48:51], v[144:147], v[184:187], v[48:51]
    ds_read_b128 v[128:131], v5 offset:47104
    v_mfma_f32_16x16x32_bf16 v[96:99], v[144:147], v[188:191], v[96:99]
    ds_read_b128 v[132:135], v5 offset:48128
    v_mfma_f32_16x16x32_bf16 v[52:55], v[148:151], v[184:187], v[52:55]
    v_mfma_f32_16x16x32_bf16 v[100:103], v[148:151], v[188:191], v[100:103]
    v_mfma_f32_16x16x32_bf16 v[56:59], v[152:155], v[184:187], v[56:59]
    v_mfma_f32_16x16x32_bf16 v[104:107], v[152:155], v[188:191], v[104:107]
    v_mfma_f32_16x16x32_bf16 v[60:63], v[156:159], v[184:187], v[60:63]
    v_mfma_f32_16x16x32_bf16 v[108:111], v[156:159], v[188:191], v[108:111]
    s_waitcnt lgkmcnt(6)
    v_mfma_f32_16x16x32_bf16 v[16:19], v[160:163], v[192:195], v[16:19]
    v_mfma_f32_16x16x32_bf16 v[64:67], v[160:163], v[196:199], v[64:67]
    v_mfma_f32_16x16x32_bf16 v[20:23], v[164:167], v[192:195], v[20:23]
    v_mfma_f32_16x16x32_bf16 v[68:71], v[164:167], v[196:199], v[68:71]
    v_mfma_f32_16x16x32_bf16 v[24:27], v[168:171], v[192:195], v[24:27]
    v_mfma_f32_16x16x32_bf16 v[72:75], v[168:171], v[196:199], v[72:75]
    v_mfma_f32_16x16x32_bf16 v[28:31], v[172:175], v[192:195], v[28:31]
    v_mfma_f32_16x16x32_bf16 v[76:79], v[172:175], v[196:199], v[76:79]
    v_mfma_f32_16x16x32_bf16 v[32:35], v[176:179], v[192:195], v[32:35]
    v_mfma_f32_16x16x32_bf16 v[80:83], v[176:179], v[196:199], v[80:83]
    v_mfma_f32_16x16x32_bf16 v[36:39], v[180:183], v[192:195], v[36:39]
    v_mfma_f32_16x16x32_bf16 v[84:87], v[180:183], v[196:199], v[84:87]
    s_waitcnt lgkmcnt(0)
    v_mfma_f32_16x16x32_bf16 v[40:43], v[112:115], v[192:195], v[40:43]
    v_mfma_f32_16x16x32_bf16 v[88:91], v[112:115], v[196:199], v[88:91]
    v_mfma_f32_16x16x32_bf16 v[44:47], v[116:119], v[192:195], v[44:47]
    v_mfma_f32_16x16x32_bf16 v[92:95], v[116:119], v[196:199], v[92:95]
    v_mfma_f32_16x16x32_bf16 v[48:51], v[120:123], v[192:195], v[48:51]
    v_mfma_f32_16x16x32_bf16 v[96:99], v[120:123], v[196:199], v[96:99]
    v_mfma_f32_16x16x32_bf16 v[52:55], v[124:127], v[192:195], v[52:55]
    v_mfma_f32_16x16x32_bf16 v[100:103], v[124:127], v[196:199], v[100:103]
    v_mfma_f32_16x16x32_bf16 v[56:59], v[128:131], v[192:195], v[56:59]
    v_mfma_f32_16x16x32_bf16 v[104:107], v[128:131], v[196:199], v[104:107]
    v_mfma_f32_16x16x32_bf16 v[60:63], v[132:135], v[192:195], v[60:63]
    v_mfma_f32_16x16x32_bf16 v[108:111], v[132:135], v[196:199], v[108:111]
    s_barrier
    s_lshl_b32 s29, s28, 1
    s_mul_i32 s29, s29, 49152
    s_mul_i32 s31, s23, 3072
    s_add_u32 s29, s29, s31
    s_add_u32 s29, s29, 13107200
    s_add_u32 s33, s29, 49152
    v_cmp_u_f32 vcc, v16, v64
    s_nop 1
    s_cmp_eq_u64 vcc, 0
    s_cbranch_scc0 L4_redo
L4_back:
    v_pk_mul_f32 v[112:113], v[16:17], v[16:17]
    v_pk_mul_f32 v[114:115], v[18:19], v[18:19]
    v_pk_mul_f32 v[116:117], v[24:25], v[24:25]
    v_pk_mul_f32 v[118:119], v[26:27], v[26:27]
    v_pk_fma_f32 v[112:113], v[112:113], v[252:253], v[250:251] op_sel:[0,0,0] op_sel_hi:[1,0,0]
    v_pk_fma_f32 v[114:115], v[114:115], v[252:253], v[250:251] op_sel:[0,0,0] op_sel_hi:[1,0,0]
    v_pk_fma_f32 v[116:117], v[116:117], v[252:253], v[250:251] op_sel:[0,0,0] op_sel_hi:[1,0,0]
    v_pk_fma_f32 v[118:119], v[118:119], v[252:253], v[250:251] op_sel:[0,0,0] op_sel_hi:[1,0,0]
    v_pk_mul_f32 v[112:113], v[112:113], v[16:17]
    v_pk_mul_f32 v[114:115], v[114:115], v[18:19]
    v_pk_mul_f32 v[116:117], v[116:117], v[24:25]
    v_pk_mul_f32 v[118:119], v[118:119], v[26:27]
    v_exp_f32 v112, v112
    v_exp_f32 v113, v113
    v_exp_f32 v114, v114
    v_exp_f32 v115, v115
    v_exp_f32 v116, v116
    v_exp_f32 v117, v117
    v_exp_f32 v118, v118
    v_exp_f32 v119, v119
    v_pk_mul_f32 v[120:121], v[16:17], v[20:21]
    v_pk_mul_f32 v[122:123], v[18:19], v[22:23]
    v_pk_mul_f32 v[124:125], v[24:25], v[28:29]
    v_pk_mul_f32 v[126:127], v[26:27], v[30:31]
    v_pk_fma_f32 v[112:113], v[112:113], v[254:255], v[254:255] op_sel:[0,0,0] op_sel_hi:[1,0,0]
    v_pk_fma_f32 v[114:115], v[114:115], v[254:255], v[254:255] op_sel:[0,0,0] op_sel_hi:[1,0,0]
    v_pk_fma_f32 v[116:117], v[116:117], v[254:255], v[254:255] op_sel:[0,0,0] op_sel_hi:[1,0,0]
    v_pk_fma_f32 v[118:119], v[118:119], v[254:255], v[254:255] op_sel:[0,0,0] op_sel_hi:[1,0,0]
    v_rcp_f32 v112, v112
    v_rcp_f32 v113, v113
    v_rcp_f32 v114, v114
    v_rcp_f32 v115, v115
    v_rcp_f32 v116, v116
    v_rcp_f32 v117, v117
    v_rcp_f32 v118, v118
    v_rcp_f32 v119, v119
    s_nop 0
    v_pk_mul_f32 v[112:113], v[112:113], v[120:121]
    v_pk_mul_f32 v[114:115], v[114:115], v[122:123]
    v_pk_mul_f32 v[116:117], v[116:117], v[124:125]
    v_pk_mul_f32 v[118:119], v[118:119], v[126:127]
    v_cvt_pk_bf16_f32 v128, v112, v113
    v_cvt_pk_bf16_f32 v129, v114, v115
    v_cvt_pk_bf16_f32 v130, v116, v117
    v_cvt_pk_bf16_f32 v131, v118, v119
    v_min_u32 v128, 0xfffffffe, v128
    v_min_u32 v129, 0xfffffffe, v129
    v_min_u32 v130, 0xfffffffe, v130
    v_min_u32 v131, 0xfffffffe, v131
    buffer_store_dwordx4 v[128:131], v4, s[76:79], s29 offen offset:0 sc1
    v_pk_mul_f32 v[132:133], v[64:65], v[64:65]
    v_pk_mul_f32 v[134:135], v[66:67], v[66:67]
    v_pk_mul_f32 v[136:137], v[72:73], v[72:73]
    v_pk_mul_f32 v[138:139], v[74:75], v[74:75]
    v_pk_fma_f32 v[132:133], v[132:133], v[252:253], v[250:251] op_sel:[0,1,1] op_sel_hi:[1,1,1]
    v_pk_fma_f32 v[134:135], v[134:135], v[252:253], v[250:251] op_sel:[0,1,1] op_sel_hi:[1,1,1]
    v_pk_fma_f32 v[136:137], v[136:137], v[252:253], v[250:251] op_sel:[0,1,1] op_sel_hi:[1,1,1]
    v_pk_fma_f32 v[138:139], v[138:139], v[252:253], v[250:251] op_sel:[0,1,1] op_sel_hi:[1,1,1]
    v_pk_mul_f32 v[132:133], v[132:133], v[64:65]
    v_pk_mul_f32 v[134:135], v[134:135], v[66:67]
    v_pk_mul_f32 v[136:137], v[136:137], v[72:73]
    v_pk_mul_f32 v[138:139], v[138:139], v[74:75]
    v_exp_f32 v132, v132
    v_exp_f32 v133, v133
    v_exp_f32 v134, v134
    v_exp_f32 v135, v135
    v_exp_f32 v136, v136
    v_exp_f32 v137, v137
    v_exp_f32 v138, v138
    v_exp_f32 v139, v139
    v_pk_mul_f32 v[140:141], v[64:65], v[68:69]
    v_pk_mul_f32 v[142:143], v[66:67], v[70:71]
    v_pk_mul_f32 v[144:145], v[72:73], v[76:77]
    v_pk_mul_f32 v[146:147], v[74:75], v[78:79]
    v_pk_fma_f32 v[132:133], v[132:133], v[254:255], v[254:255] op_sel:[0,1,1] op_sel_hi:[1,1,1]
    v_pk_fma_f32 v[134:135], v[134:135], v[254:255], v[254:255] op_sel:[0,1,1] op_sel_hi:[1,1,1]
    v_pk_fma_f32 v[136:137], v[136:137], v[254:255], v[254:255] op_sel:[0,1,1] op_sel_hi:[1,1,1]
    v_pk_fma_f32 v[138:139], v[138:139], v[254:255], v[254:255] op_sel:[0,1,1] op_sel_hi:[1,1,1]
    v_rcp_f32 v132, v132
    v_rcp_f32 v133, v133
    v_rcp_f32 v134, v134
    v_rcp_f32 v135, v135
    v_rcp_f32 v136, v136
    v_rcp_f32 v137, v137
    v_rcp_f32 v138, v138
    v_rcp_f32 v139, v139
    s_nop 0
    v_pk_mul_f32 v[132:133], v[132:133], v[140:141]
    v_pk_mul_f32 v[134:135], v[134:135], v[142:143]
    v_pk_mul_f32 v[136:137], v[136:137], v[144:145]
    v_pk_mul_f32 v[138:139], v[138:139], v[146:147]
    v_cvt_pk_bf16_f32 v148, v132, v133
    v_cvt_pk_bf16_f32 v149, v134, v135
    v_cvt_pk_bf16_f32 v150, v136, v137
    v_cvt_pk_bf16_f32 v151, v138, v139
    v_min_u32 v148, 0xfffffffe, v148
    v_min_u32 v149, 0xfffffffe, v149
    v_min_u32 v150, 0xfffffffe, v150
    v_min_u32 v151, 0xfffffffe, v151
    buffer_store_dwordx4 v[148:151], v4, s[76:79], s33 offen offset:0 sc1
    v_pk_mul_f32 v[112:113], v[32:33], v[32:33]
    v_pk_mul_f32 v[114:115], v[34:35], v[34:35]
    v_pk_mul_f32 v[116:117], v[40:41], v[40:41]
    v_pk_mul_f32 v[118:119], v[42:43], v[42:43]
    v_pk_fma_f32 v[112:113], v[112:113], v[252:253], v[250:251] op_sel:[0,0,0] op_sel_hi:[1,0,0]
    v_pk_fma_f32 v[114:115], v[114:115], v[252:253], v[250:251] op_sel:[0,0,0] op_sel_hi:[1,0,0]
    v_pk_fma_f32 v[116:117], v[116:117], v[252:253], v[250:251] op_sel:[0,0,0] op_sel_hi:[1,0,0]
    v_pk_fma_f32 v[118:119], v[118:119], v[252:253], v[250:251] op_sel:[0,0,0] op_sel_hi:[1,0,0]
    v_pk_mul_f32 v[112:113], v[112:113], v[32:33]
    v_pk_mul_f32 v[114:115], v[114:115], v[34:35]
    v_pk_mul_f32 v[116:117], v[116:117], v[40:41]
    v_pk_mul_f32 v[118:119], v[118:119], v[42:43]
    v_exp_f32 v112, v112
    v_exp_f32 v113, v113
    v_exp_f32 v114, v114
    v_exp_f32 v115, v115
    v_exp_f32 v116, v116
    v_exp_f32 v117, v117
    v_exp_f32 v118, v118
    v_exp_f32 v119, v119
    v_pk_mul_f32 v[120:121], v[32:33], v[36:37]
    v_pk_mul_f32 v[122:123], v[34:35], v[38:39]
    v_pk_mul_f32 v[124:125], v[40:41], v[44:45]
    v_pk_mul_f32 v[126:127], v[42:43], v[46:47]
    v_pk_fma_f32 v[112:113], v[112:113], v[254:255], v[254:255] op_sel:[0,0,0] op_sel_hi:[1,0,0]
    v_pk_fma_f32 v[114:115], v[114:115], v[254:255], v[254:255] op_sel:[0,0,0] op_sel_hi:[1,0,0]
    v_pk_fma_f32 v[116:117], v[116:117], v[254:255], v[254:255] op_sel:[0,0,0] op_sel_hi:[1,0,0]
    v_pk_fma_f32 v[118:119], v[118:119], v[254:255], v[254:255] op_sel:[0,0,0] op_sel_hi:[1,0,0]
    v_rcp_f32 v112, v112
    v_rcp_f32 v113, v113
    v_rcp_f32 v114, v114
    v_rcp_f32 v115, v115
    v_rcp_f32 v116, v116
    v_rcp_f32 v117, v117
    v_rcp_f32 v118, v118
    v_rcp_f32 v119, v119
    s_nop 0
    v_pk_mul_f32 v[112:113], v[112:113], v[120:121]
    v_pk_mul_f32 v[114:115], v[114:115], v[122:123]
    v_pk_mul_f32 v[116:117], v[116:117], v[124:125]
    v_pk_mul_f32 v[118:119], v[118:119], v[126:127]
    v_cvt_pk_bf16_f32 v128, v112, v113
    v_cvt_pk_bf16_f32 v129, v114, v115
    v_cvt_pk_bf16_f32 v130, v116, v117
    v_cvt_pk_bf16_f32 v131, v118, v119
    v_min_u32 v128, 0xfffffffe, v128
    v_min_u32 v129, 0xfffffffe, v129
    v_min_u32 v130, 0xfffffffe, v130
    v_min_u32 v131, 0xfffffffe, v131
    buffer_store_dwordx4 v[128:131], v4, s[76:79], s29 offen offset:1024 sc1
    v_pk_mul_f32 v[132:133], v[80:81], v[80:81]
    v_pk_mul_f32 v[134:135], v[82:83], v[82:83]
    v_pk_mul_f32 v[136:137], v[88:89], v[88:89]
    v_pk_mul_f32 v[138:139], v[90:91], v[90:91]
    v_pk_fma_f32 v[132:133], v[132:133], v[252:253], v[250:251] op_sel:[0,1,1] op_sel_hi:[1,1,1]
    v_pk_fma_f32 v[134:135], v[134:135], v[252:253], v[250:251] op_sel:[0,1,1] op_sel_hi:[1,1,1]
    v_pk_fma_f32 v[136:137], v[136:137], v[252:253], v[250:251] op_sel:[0,1,1] op_sel_hi:[1,1,1]
    v_pk_fma_f32 v[138:139], v[138:139], v[252:253], v[250:251] op_sel:[0,1,1] op_sel_hi:[1,1,1]
    v_pk_mul_f32 v[132:133], v[132:133], v[80:81]
    v_pk_mul_f32 v[134:135], v[134:135], v[82:83]
    v_pk_mul_f32 v[136:137], v[136:137], v[88:89]
    v_pk_mul_f32 v[138:139], v[138:139], v[90:91]
    v_exp_f32 v132, v132
    v_exp_f32 v133, v133
    v_exp_f32 v134, v134
    v_exp_f32 v135, v135
    v_exp_f32 v136, v136
    v_exp_f32 v137, v137
    v_exp_f32 v138, v138
    v_exp_f32 v139, v139
    v_pk_mul_f32 v[140:141], v[80:81], v[84:85]
    v_pk_mul_f32 v[142:143], v[82:83], v[86:87]
    v_pk_mul_f32 v[144:145], v[88:89], v[92:93]
    v_pk_mul_f32 v[146:147], v[90:91], v[94:95]
    v_pk_fma_f32 v[132:133], v[132:133], v[254:255], v[254:255] op_sel:[0,1,1] op_sel_hi:[1,1,1]
    v_pk_fma_f32 v[134:135], v[134:135], v[254:255], v[254:255] op_sel:[0,1,1] op_sel_hi:[1,1,1]
    v_pk_fma_f32 v[136:137], v[136:137], v[254:255], v[254:255] op_sel:[0,1,1] op_sel_hi:[1,1,1]
    v_pk_fma_f32 v[138:139], v[138:139], v[254:255], v[254:255] op_sel:[0,1,1] op_sel_hi:[1,1,1]
    v_rcp_f32 v132, v132
    v_rcp_f32 v133, v133
    v_rcp_f32 v134, v134
    v_rcp_f32 v135, v135
    v_rcp_f32 v136, v136
    v_rcp_f32 v137, v137
    v_rcp_f32 v138, v138
    v_rcp_f32 v139, v139
    s_nop 0
    v_pk_mul_f32 v[132:133], v[132:133], v[140:141]
    v_pk_mul_f32 v[134:135], v[134:135], v[142:143]
    v_pk_mul_f32 v[136:137], v[136:137], v[144:145]
    v_pk_mul_f32 v[138:139], v[138:139], v[146:147]
    v_cvt_pk_bf16_f32 v148, v132, v133
    v_cvt_pk_bf16_f32 v149, v134, v135
    v_cvt_pk_bf16_f32 v150, v136, v137
    v_cvt_pk_bf16_f32 v151, v138, v139
    v_min_u32 v148, 0xfffffffe, v148
    v_min_u32 v149, 0xfffffffe, v149
    v_min_u32 v150, 0xfffffffe, v150
    v_min_u32 v151, 0xfffffffe, v151
    buffer_store_dwordx4 v[148:151], v4, s[76:79], s33 offen offset:1024 sc1
    v_pk_mul_f32 v[112:113], v[48:49], v[48:49]
    v_pk_mul_f32 v[114:115], v[50:51], v[50:51]
    v_pk_mul_f32 v[116:117], v[56:57], v[56:57]
    v_pk_mul_f32 v[118:119], v[58:59], v[58:59]
    v_pk_fma_f32 v[112:113], v[112:113], v[252:253], v[250:251] op_sel:[0,0,0] op_sel_hi:[1,0,0]
    v_pk_fma_f32 v[114:115], v[114:115], v[252:253], v[250:251] op_sel:[0,0,0] op_sel_hi:[1,0,0]
    v_pk_fma_f32 v[116:117], v[116:117], v[252:253], v[250:251] op_sel:[0,0,0] op_sel_hi:[1,0,0]
    v_pk_fma_f32 v[118:119], v[118:119], v[252:253], v[250:251] op_sel:[0,0,0] op_sel_hi:[1,0,0]
    v_pk_mul_f32 v[112:113], v[112:113], v[48:49]
    v_pk_mul_f32 v[114:115], v[114:115], v[50:51]
    v_pk_mul_f32 v[116:117], v[116:117], v[56:57]
    v_pk_mul_f32 v[118:119], v[118:119], v[58:59]
    v_exp_f32 v112, v112
    v_exp_f32 v113, v113
    v_exp_f32 v114, v114
    v_exp_f32 v115, v115
    v_exp_f32 v116, v116
    v_exp_f32 v117, v117
    v_exp_f32 v118, v118
    v_exp_f32 v119, v119
    v_pk_mul_f32 v[120:121], v[48:49], v[52:53]
    v_pk_mul_f32 v[122:123], v[50:51], v[54:55]
    v_pk_mul_f32 v[124:125], v[56:57], v[60:61]
    v_pk_mul_f32 v[126:127], v[58:59], v[62:63]
    v_pk_fma_f32 v[112:113], v[112:113], v[254:255], v[254:255] op_sel:[0,0,0] op_sel_hi:[1,0,0]
    v_pk_fma_f32 v[114:115], v[114:115], v[254:255], v[254:255] op_sel:[0,0,0] op_sel_hi:[1,0,0]
    v_pk_fma_f32 v[116:117], v[116:117], v[254:255], v[254:255] op_sel:[0,0,0] op_sel_hi:[1,0,0]
    v_pk_fma_f32 v[118:119], v[118:119], v[254:255], v[254:255] op_sel:[0,0,0] op_sel_hi:[1,0,0]
    v_rcp_f32 v112, v112
    v_rcp_f32 v113, v113
    v_rcp_f32 v114, v114
    v_rcp_f32 v115, v115
    v_rcp_f32 v116, v116
    v_rcp_f32 v117, v117
    v_rcp_f32 v118, v118
    v_rcp_f32 v119, v119
    s_nop 0
    v_pk_mul_f32 v[112:113], v[112:113], v[120:121]
    v_pk_mul_f32 v[114:115], v[114:115], v[122:123]
    v_pk_mul_f32 v[116:117], v[116:117], v[124:125]
    v_pk_mul_f32 v[118:119], v[118:119], v[126:127]
    v_cvt_pk_bf16_f32 v128, v112, v113
    v_cvt_pk_bf16_f32 v129, v114, v115
    v_cvt_pk_bf16_f32 v130, v116, v117
    v_cvt_pk_bf16_f32 v131, v118, v119
    v_min_u32 v128, 0xfffffffe, v128
    v_min_u32 v129, 0xfffffffe, v129
    v_min_u32 v130, 0xfffffffe, v130
    v_min_u32 v131, 0xfffffffe, v131
    buffer_store_dwordx4 v[128:131], v4, s[76:79], s29 offen offset:2048 sc1
    v_pk_mul_f32 v[132:133], v[96:97], v[96:97]
    v_pk_mul_f32 v[134:135], v[98:99], v[98:99]
    v_pk_mul_f32 v[136:137], v[104:105], v[104:105]
    v_pk_mul_f32 v[138:139], v[106:107], v[106:107]
    v_pk_fma_f32 v[132:133], v[132:133], v[252:253], v[250:251] op_sel:[0,1,1] op_sel_hi:[1,1,1]
    v_pk_fma_f32 v[134:135], v[134:135], v[252:253], v[250:251] op_sel:[0,1,1] op_sel_hi:[1,1,1]
    v_pk_fma_f32 v[136:137], v[136:137], v[252:253], v[250:251] op_sel:[0,1,1] op_sel_hi:[1,1,1]
    v_pk_fma_f32 v[138:139], v[138:139], v[252:253], v[250:251] op_sel:[0,1,1] op_sel_hi:[1,1,1]
    v_pk_mul_f32 v[132:133], v[132:133], v[96:97]
    v_pk_mul_f32 v[134:135], v[134:135], v[98:99]
    v_pk_mul_f32 v[136:137], v[136:137], v[104:105]
    v_pk_mul_f32 v[138:139], v[138:139], v[106:107]
    v_exp_f32 v132, v132
    v_exp_f32 v133, v133
    v_exp_f32 v134, v134
    v_exp_f32 v135, v135
    v_exp_f32 v136, v136
    v_exp_f32 v137, v137
    v_exp_f32 v138, v138
    v_exp_f32 v139, v139
    v_pk_mul_f32 v[140:141], v[96:97], v[100:101]
    v_pk_mul_f32 v[142:143], v[98:99], v[102:103]
    v_pk_mul_f32 v[144:145], v[104:105], v[108:109]
    v_pk_mul_f32 v[146:147], v[106:107], v[110:111]
    v_pk_fma_f32 v[132:133], v[132:133], v[254:255], v[254:255] op_sel:[0,1,1] op_sel_hi:[1,1,1]
    v_pk_fma_f32 v[134:135], v[134:135], v[254:255], v[254:255] op_sel:[0,1,1] op_sel_hi:[1,1,1]
    v_pk_fma_f32 v[136:137], v[136:137], v[254:255], v[254:255] op_sel:[0,1,1] op_sel_hi:[1,1,1]
    v_pk_fma_f32 v[138:139], v[138:139], v[254:255], v[254:255] op_sel:[0,1,1] op_sel_hi:[1,1,1]
    v_rcp_f32 v132, v132
    v_rcp_f32 v133, v133
    v_rcp_f32 v134, v134
    v_rcp_f32 v135, v135
    v_rcp_f32 v136, v136
    v_rcp_f32 v137, v137
    v_rcp_f32 v138, v138
    v_rcp_f32 v139, v139
    s_nop 0
    v_pk_mul_f32 v[132:133], v[132:133], v[140:141]
    v_pk_mul_f32 v[134:135], v[134:135], v[142:143]
    v_pk_mul_f32 v[136:137], v[136:137], v[144:145]
    v_pk_mul_f32 v[138:139], v[138:139], v[146:147]
    v_cvt_pk_bf16_f32 v148, v132, v133
    v_cvt_pk_bf16_f32 v149, v134, v135
    v_cvt_pk_bf16_f32 v150, v136, v137
    v_cvt_pk_bf16_f32 v151, v138, v139
    v_min_u32 v148, 0xfffffffe, v148
    v_min_u32 v149, 0xfffffffe, v149
    v_min_u32 v150, 0xfffffffe, v150
    v_min_u32 v151, 0xfffffffe, v151
    buffer_store_dwordx4 v[148:151], v4, s[76:79], s33 offen offset:2048 sc1
    v_mov_b32 v5, v4
    v_add_u32 v6, 61440, v4
    v_add_u32 v46, 122880, v4
    s_lshl_b32 s25, s20, 2
    s_add_u32 s25, s25, s24
    s_mul_i32 s25, s25, 49152
    s_add_u32 s25, s25, 13107200
    v_mul_u32_u24 v222, 3072, v0
    s_add_u32 s33, s25, 2048
    v_add_u32 v222, s33, v222
    s_barrier
    s_lshl_b32 s32, s20, 2
    s_add_u32 s32, s32, s24
    v_and_b32 v223, 15, v0
    v_lshrrev_b32 v224, 4, v0
    s_lshl_b32 s33, s32, 4
    v_add_u32 v216, s33, v223
    v_mul_u32_u24 v225, 1280, v216
    s_mul_i32 s33, s21, 160
    v_add_u32 v225, s33, v225
    v_lshl_add_u32 v217, v224, 4, v225
    v_lshl_add_u32 v218, v224, 3, v225
    s_mul_i32 s33, s32, 20480
    s_mul_i32 s34, s21, 2560
    s_add_u32 s33, s33, s34
    s_add_u32 s33, s33, 10485760
    v_lshlrev_b32 v225, 4, v223
    v_add_u32 v225, s33, v225
    v_lshl_add_u32 v219, v224, 8, v225
    v_lshrrev_b32 v220, 1, v224
    v_lshl_add_u32 v220, v220, 8, v225
    v_and_b32 v225, 1, v224
    v_lshl_add_u32 v220, v225, 3, v220
    s_mov_b32 s8, s70
    s_mov_b32 s9, s71
    s_mov_b32 s10, 2621440
    s_mov_b32 s11, 0x20000
    s_mov_b64 exec, 0xffff
    s_mov_b32 s54, 262144
Lpoll_50:
    buffer_load_dword v8, v222, s[76:79], 0 offen sc1
    s_waitcnt vmcnt(0)
    v_cmp_ne_u32 vcc, -1, v8
    s_sub_u32 s54, s54, 1
    s_cbranch_scc1 Lpdone_51
    s_cmp_eq_u64 vcc, exec
    s_cbranch_scc0 Lpoll_50
Lpdone_51:
    s_mov_b64 exec, -1
    ds_read_b128 v[48:51], v5 offset:40960
    ds_read_b128 v[52:55], v5 offset:41984
    ds_read_b128 v[56:59], v5 offset:43008
    ds_read_b128 v[60:63], v5 offset:44032
    ds_read_b128 v[64:67], v5 offset:45056
    ds_read_b128 v[68:71], v5 offset:46080
    ds_read_b128 v[72:75], v5 offset:47104
    ds_read_b128 v[76:79], v5 offset:48128
    ds_read_b128 v[80:83], v6 offset:36864
    ds_read_b128 v[84:87], v6 offset:37888
    s_add_u32 s14, s25, 25600
    buffer_load_dwordx4 v[108:111], v4, s[76:79], s14 offen sc1
    s_add_u32 s14, s25, 28672
    buffer_load_dwordx4 v[112:115], v4, s[76:79], s14 offen sc1
    s_add_u32 s14, s25, 31744
    buffer_load_dwordx4 v[116:119], v4, s[76:79], s14 offen sc1
    s_add_u32 s14, s25, 34816
    buffer_load_dwordx4 v[120:123], v4, s[76:79], s14 offen sc1
    s_add_u32 s14, s25, 37888
    buffer_load_dwordx4 v[124:127], v4, s[76:79], s14 offen sc1
    s_add_u32 s14, s25, 40960
    buffer_load_dwordx4 v[128:131], v4, s[76:79], s14 offen sc1
    s_waitcnt vmcnt(5) lgkmcnt(5)
    v_mfma_f32_16x16x32_bf16 v[16:19], v[48:51], v[108:111], 0
    ds_read_b128 v[88:91], v6 offset:38912
    v_mfma_f32_16x16x32_bf16 v[20:23], v[52:55], v[108:111], 0
    ds_read_b128 v[92:95], v6 offset:39936
    v_mfma_f32_16x16x32_bf16 v[24:27], v[56:59], v[108:111], 0
    ds_read_b128 v[96:99], v6 offset:40960
    v_mfma_f32_16x16x32_bf16 v[28:31], v[60:63], v[108:111], 0
    ds_read_b128 v[100:103], v6 offset:41984
    v_mfma_f32_16x16x32_bf16 v[32:35], v[64:67], v[108:111], 0
    ds_read_b128 v[104:107], v6 offset:43008
    s_add_u32 s14, s25, 44032
    buffer_load_dwordx4 v[132:135], v4, s[76:79], s14 offen sc1
    s_waitcnt vmcnt(5) lgkmcnt(5)
    v_mfma_f32_16x16x32_bf16 v[16:19], v[68:71], v[112:115], v[16:19]
    ds_read_b128 v[48:51], v6 offset:44032
    v_mfma_f32_16x16x32_bf16 v[20:23], v[72:75], v[112:115], v[20:23]
    ds_read_b128 v[52:55], v6 offset:45056
    v_mfma_f32_16x16x32_bf16 v[24:27], v[76:79], v[112:115], v[24:27]
    ds_read_b128 v[56:59], v6 offset:46080
    v_mfma_f32_16x16x32_bf16 v[28:31], v[80:83], v[112:115], v[28:31]
    ds_read_b128 v[60:63], v6 offset:47104
    v_mfma_f32_16x16x32_bf16 v[32:35], v[84:87], v[112:115], v[32:35]
    ds_read_b128 v[64:67], v6 offset:48128
    s_add_u32 s14, s25, 47104
    buffer_load_dwordx4 v[136:139], v4, s[76:79], s14 offen sc1
    s_waitcnt lgkmcnt(0)
    s_barrier
    s_waitcnt vmcnt(5)
    v_mfma_f32_16x16x32_bf16 v[16:19], v[88:91], v[116:119], v[16:19]
    ds_read_b128 v[68:71], v6 offset:49152
    v_mfma_f32_16x16x32_bf16 v[20:23], v[92:95], v[116:119], v[20:23]
    ds_read_b128 v[72:75], v6 offset:50176
    v_mfma_f32_16x16x32_bf16 v[24:27], v[96:99], v[116:119], v[24:27]
    ds_read_b128 v[76:79], v6 offset:51200
    v_mfma_f32_16x16x32_bf16 v[28:31], v[100:103], v[116:119], v[28:31]
    ds_read_b128 v[80:83], v6 offset:52224
    v_mfma_f32_16x16x32_bf16 v[32:35], v[104:107], v[116:119], v[32:35]
    ds_read_b128 v[84:87], v46 offset:8192
    s_add_u32 s14, s25, 2048
    buffer_load_dwordx4 v[140:143], v4, s[76:79], s14 offen sc1
    s_waitcnt vmcnt(5) lgkmcnt(5)
    v_mfma_f32_16x16x32_bf16 v[16:19], v[48:51], v[120:123], v[16:19]
    ds_read_b128 v[88:91], v46 offset:9216
    v_mfma_f32_16x16x32_bf16 v[20:23], v[52:55], v[120:123], v[20:23]
    ds_read_b128 v[92:95], v46 offset:10240
    v_mfma_f32_16x16x32_bf16 v[24:27], v[56:59], v[120:123], v[24:27]
    ds_read_b128 v[96:99], v46 offset:11264
    v_mfma_f32_16x16x32_bf16 v[28:31], v[60:63], v[120:123], v[28:31]
    ds_read_b128 v[100:103], v46 offset:12288
    v_mfma_f32_16x16x32_bf16 v[32:35], v[64:67], v[120:123], v[32:35]
    ds_read_b128 v[104:107], v46 offset:13312
    s_add_u32 s14, s25, 5120
    buffer_load_dwordx4 v[144:147], v4, s[76:79], s14 offen sc1
    s_waitcnt vmcnt(5) lgkmcnt(5)
    v_mfma_f32_16x16x32_bf16 v[16:19], v[68:71], v[124:127], v[16:19]
    ds_read_b128 v[48:51], v46 offset:14336
    v_mfma_f32_16x16x32_bf16 v[20:23], v[72:75], v[124:127], v[20:23]
    ds_read_b128 v[52:55], v46 offset:15360
    v_mfma_f32_16x16x32_bf16 v[24:27], v[76:79], v[124:127], v[24:27]
    ds_read_b128 v[56:59], v46 offset:16384
    v_mfma_f32_16x16x32_bf16 v[28:31], v[80:83], v[124:127], v[28:31]
    ds_read_b128 v[60:63], v46 offset:17408
    v_mfma_f32_16x16x32_bf16 v[32:35], v[84:87], v[124:127], v[32:35]
    ds_read_b128 v[64:67], v46 offset:18432
    s_add_u32 s14, s25, 8192
    buffer_load_dwordx4 v[148:151], v4, s[76:79], s14 offen sc1
    s_waitcnt vmcnt(5) lgkmcnt(5)
    v_mfma_f32_16x16x32_bf16 v[16:19], v[88:91], v[128:131], v[16:19]
    ds_read_b128 v[68:71], v46 offset:19456
    v_mfma_f32_16x16x32_bf16 v[20:23], v[92:95], v[128:131], v[20:23]
    ds_read_b128 v[72:75], v46 offset:20480
    v_mfma_f32_16x16x32_bf16 v[24:27], v[96:99], v[128:131], v[24:27]
    ds_read_b128 v[76:79], v46 offset:21504
    v_mfma_f32_16x16x32_bf16 v[28:31], v[100:103], v[128:131], v[28:31]
    ds_read_b128 v[80:83], v46 offset:22528
    v_mfma_f32_16x16x32_bf16 v[32:35], v[104:107], v[128:131], v[32:35]
    ds_read_b128 v[84:87], v46 offset:23552
    s_add_u32 s14, s25, 11264
    buffer_load_dwordx4 v[152:155], v4, s[76:79], s14 offen sc1
    s_waitcnt lgkmcnt(0)
    s_barrier
    s_waitcnt vmcnt(5)
    v_mfma_f32_16x16x32_bf16 v[16:19], v[48:51], v[132:135], v[16:19]
    ds_read_b128 v[88:91], v5 offset:49152
    v_mfma_f32_16x16x32_bf16 v[20:23], v[52:55], v[132:135], v[20:23]
    ds_read_b128 v[92:95], v5 offset:50176
    v_mfma_f32_16x16x32_bf16 v[24:27], v[56:59], v[132:135], v[24:27]
    ds_read_b128 v[96:99], v5 offset:51200
    v_mfma_f32_16x16x32_bf16 v[28:31], v[60:63], v[132:135], v[28:31]
    ds_read_b128 v[100:103], v5 offset:52224
    v_mfma_f32_16x16x32_bf16 v[32:35], v[64:67], v[132:135], v[32:35]
    ds_read_b128 v[104:107], v5 offset:53248
    s_add_u32 s14, s25, 14336
    buffer_load_dwordx4 v[156:159], v4, s[76:79], s14 offen sc1
    s_waitcnt vmcnt(5) lgkmcnt(5)
    v_mfma_f32_16x16x32_bf16 v[16:19], v[68:71], v[136:139], v[16:19]
    ds_read_b128 v[48:51], v5 offset:54272
    v_mfma_f32_16x16x32_bf16 v[20:23], v[72:75], v[136:139], v[20:23]
    ds_read_b128 v[52:55], v5 offset:55296
    v_mfma_f32_16x16x32_bf16 v[24:27], v[76:79], v[136:139], v[24:27]
    ds_read_b128 v[56:59], v5 offset:56320
    v_mfma_f32_16x16x32_bf16 v[28:31], v[80:83], v[136:139], v[28:31]
    ds_read_b128 v[60:63], v5 offset:57344
    v_mfma_f32_16x16x32_bf16 v[32:35], v[84:87], v[136:139], v[32:35]
    ds_read_b128 v[64:67], v5 offset:58368
    s_add_u32 s14, s25, 17408
    buffer_load_dwordx4 v[160:163], v4, s[76:79], s14 offen sc1
    s_waitcnt vmcnt(5) lgkmcnt(5)
    v_mfma_f32_16x16x32_bf16 v[16:19], v[88:91], v[140:143], v[16:19]
    ds_read_b128 v[68:71], v5 offset:59392
    v_mfma_f32_16x16x32_bf16 v[20:23], v[92:95], v[140:143], v[20:23]
    ds_read_b128 v[72:75], v5 offset:60416
    v_mfma_f32_16x16x32_bf16 v[24:27], v[96:99], v[140:143], v[24:27]
    ds_read_b128 v[76:79], v6 offset:0
    v_mfma_f32_16x16x32_bf16 v[28:31], v[100:103], v[140:143], v[28:31]
    ds_read_b128 v[80:83], v6 offset:1024
    v_mfma_f32_16x16x32_bf16 v[32:35], v[104:107], v[140:143], v[32:35]
    ds_read_b128 v[84:87], v6 offset:2048
    s_add_u32 s14, s25, 20480
    buffer_load_dwordx4 v[164:167], v4, s[76:79], s14 offen sc1
    s_waitcnt vmcnt(5) lgkmcnt(5)
    v_mfma_f32_16x16x32_bf16 v[16:19], v[48:51], v[144:147], v[16:19]
    ds_read_b128 v[88:91], v6 offset:3072
    v_mfma_f32_16x16x32_bf16 v[20:23], v[52:55], v[144:147], v[20:23]
    ds_read_b128 v[92:95], v6 offset:4096
    v_mfma_f32_16x16x32_bf16 v[24:27], v[56:59], v[144:147], v[24:27]
    ds_read_b128 v[96:99], v6 offset:5120
    v_mfma_f32_16x16x32_bf16 v[28:31], v[60:63], v[144:147], v[28:31]
    ds_read_b128 v[100:103], v6 offset:6144
    v_mfma_f32_16x16x32_bf16 v[32:35], v[64:67], v[144:147], v[32:35]
    ds_read_b128 v[104:107], v6 offset:7168
    s_add_u32 s14, s25, 23552
    buffer_load_dwordx4 v[168:171], v4, s[76:79], s14 offen sc1
    s_waitcnt vmcnt(5) lgkmcnt(5)
    v_mfma_f32_16x16x32_bf16 v[16:19], v[68:71], v[148:151], v[16:19]
    ds_read_b128 v[48:51], v6 offset:8192
    v_mfma_f32_16x16x32_bf16 v[20:23], v[72:75], v[148:151], v[20:23]
    ds_read_b128 v[52:55], v6 offset:9216
    v_mfma_f32_16x16x32_bf16 v[24:27], v[76:79], v[148:151], v[24:27]
    ds_read_b128 v[56:59], v6 offset:10240
    v_mfma_f32_16x16x32_bf16 v[28:31], v[80:83], v[148:151], v[28:31]
    ds_read_b128 v[60:63], v6 offset:11264
    v_mfma_f32_16x16x32_bf16 v[32:35], v[84:87], v[148:151], v[32:35]
    ds_read_b128 v[64:67], v6 offset:12288
    s_add_u32 s14, s25, 26624
    buffer_load_dwordx4 v[172:175], v4, s[76:79], s14 offen sc1
    s_waitcnt vmcnt(5) lgkmcnt(5)
    v_mfma_f32_16x16x32_bf16 v[16:19], v[88:91], v[152:155], v[16:19]
    ds_read_b128 v[68:71], v6 offset:13312
    v_mfma_f32_16x16x32_bf16 v[20:23], v[92:95], v[152:155], v[20:23]
    ds_read_b128 v[72:75], v6 offset:14336
    v_mfma_f32_16x16x32_bf16 v[24:27], v[96:99], v[152:155], v[24:27]
    ds_read_b128 v[76:79], v6 offset:15360
    v_mfma_f32_16x16x32_bf16 v[28:31], v[100:103], v[152:155], v[28:31]
    ds_read_b128 v[80:83], v6 offset:16384
    v_mfma_f32_16x16x32_bf16 v[32:35], v[104:107], v[152:155], v[32:35]
    ds_read_b128 v[84:87], v6 offset:17408
    s_add_u32 s14, s25, 29696
    buffer_load_dwordx4 v[176:179], v4, s[76:79], s14 offen sc1
    s_waitcnt vmcnt(5) lgkmcnt(5)
    v_mfma_f32_16x16x32_bf16 v[16:19], v[48:51], v[156:159], v[16:19]
    ds_read_b128 v[88:91], v6 offset:18432
    v_mfma_f32_16x16x32_bf16 v[20:23], v[52:55], v[156:159], v[20:23]
    ds_read_b128 v[92:95], v6 offset:19456
    v_mfma_f32_16x16x32_bf16 v[24:27], v[56:59], v[156:159], v[24:27]
    ds_read_b128 v[96:99], v6 offset:20480
    v_mfma_f32_16x16x32_bf16 v[28:31], v[60:63], v[156:159], v[28:31]
    ds_read_b128 v[100:103], v6 offset:21504
    v_mfma_f32_16x16x32_bf16 v[32:35], v[64:67], v[156:159], v[32:35]
    ds_read_b128 v[104:107], v6 offset:22528
    s_add_u32 s14, s25, 32768
    buffer_load_dwordx4 v[180:183], v4, s[76:79], s14 offen sc1
    s_waitcnt vmcnt(5) lgkmcnt(5)
    v_mfma_f32_16x16x32_bf16 v[16:19], v[68:71], v[160:163], v[16:19]
    ds_read_b128 v[48:51], v6 offset:23552
    v_mfma_f32_16x16x32_bf16 v[20:23], v[72:75], v[160:163], v[20:23]
    ds_read_b128 v[52:55], v6 offset:24576
    v_mfma_f32_16x16x32_bf16 v[24:27], v[76:79], v[160:163], v[24:27]
    ds_read_b128 v[56:59], v6 offset:25600
    v_mfma_f32_16x16x32_bf16 v[28:31], v[80:83], v[160:163], v[28:31]
    ds_read_b128 v[60:63], v6 offset:26624
    v_mfma_f32_16x16x32_bf16 v[32:35], v[84:87], v[160:163], v[32:35]
    ds_read_b128 v[64:67], v6 offset:27648
    s_add_u32 s14, s25, 35840
    buffer_load_dwordx4 v[184:187], v4, s[76:79], s14 offen sc1
    s_waitcnt lgkmcnt(0)
    s_barrier
    s_waitcnt vmcnt(5)
    v_mfma_f32_16x16x32_bf16 v[16:19], v[88:91], v[164:167], v[16:19]
    ds_read_b128 v[68:71], v6 offset:28672
    v_mfma_f32_16x16x32_bf16 v[20:23], v[92:95], v[164:167], v[20:23]
    ds_read_b128 v[72:75], v6 offset:29696
    v_mfma_f32_16x16x32_bf16 v[24:27], v[96:99], v[164:167], v[24:27]
    ds_read_b128 v[76:79], v6 offset:30720
    v_mfma_f32_16x16x32_bf16 v[28:31], v[100:103], v[164:167], v[28:31]
    ds_read_b128 v[80:83], v6 offset:31744
    v_mfma_f32_16x16x32_bf16 v[32:35], v[104:107], v[164:167], v[32:35]
    ds_read_b128 v[84:87], v6 offset:32768
    s_add_u32 s14, s25, 38912
    buffer_load_dwordx4 v[188:191], v4, s[76:79], s14 offen sc1
    s_waitcnt vmcnt(5) lgkmcnt(5)
    v_mfma_f32_16x16x32_bf16 v[16:19], v[48:51], v[168:171], v[16:19]
    ds_read_b128 v[88:91], v6 offset:33792
    v_mfma_f32_16x16x32_bf16 v[20:23], v[52:55], v[168:171], v[20:23]
    ds_read_b128 v[92:95], v6 offset:34816
    v_mfma_f32_16x16x32_bf16 v[24:27], v[56:59], v[168:171], v[24:27]
    ds_read_b128 v[96:99], v6 offset:35840
    v_mfma_f32_16x16x32_bf16 v[28:31], v[60:63], v[168:171], v[28:31]
    ds_read_b128 v[100:103], v6 offset:53248
    v_mfma_f32_16x16x32_bf16 v[32:35], v[64:67], v[168:171], v[32:35]
    ds_read_b128 v[104:107], v6 offset:54272
    s_add_u32 s14, s25, 41984
    buffer_load_dwordx4 v[192:195], v4, s[76:79], s14 offen sc1
    s_waitcnt vmcnt(5) lgkmcnt(5)
    v_mfma_f32_16x16x32_bf16 v[16:19], v[68:71], v[172:175], v[16:19]
    ds_read_b128 v[48:51], v6 offset:55296
    v_mfma_f32_16x16x32_bf16 v[20:23], v[72:75], v[172:175], v[20:23]
    ds_read_b128 v[52:55], v6 offset:56320
    v_mfma_f32_16x16x32_bf16 v[24:27], v[76:79], v[172:175], v[24:27]
    ds_read_b128 v[56:59], v6 offset:57344
    v_mfma_f32_16x16x32_bf16 v[28:31], v[80:83], v[172:175], v[28:31]
    ds_read_b128 v[60:63], v6 offset:58368
    v_mfma_f32_16x16x32_bf16 v[32:35], v[84:87], v[172:175], v[32:35]
    ds_read_b128 v[64:67], v6 offset:59392
    s_add_u32 s14, s25, 45056
    buffer_load_dwordx4 v[196:199], v4, s[76:79], s14 offen sc1
    s_waitcnt vmcnt(5) lgkmcnt(5)
    v_mfma_f32_16x16x32_bf16 v[16:19], v[88:91], v[176:179], v[16:19]
    ds_read_b128 v[68:71], v6 offset:60416
    v_mfma_f32_16x16x32_bf16 v[20:23], v[92:95], v[176:179], v[20:23]
    ds_read_b128 v[72:75], v46 offset:0
    v_mfma_f32_16x16x32_bf16 v[24:27], v[96:99], v[176:179], v[24:27]
    ds_read_b128 v[76:79], v46 offset:1024
    v_mfma_f32_16x16x32_bf16 v[28:31], v[100:103], v[176:179], v[28:31]
    ds_read_b128 v[80:83], v46 offset:2048
    v_mfma_f32_16x16x32_bf16 v[32:35], v[104:107], v[176:179], v[32:35]
    ds_read_b128 v[84:87], v46 offset:3072
    s_add_u32 s14, s25, 48128
    buffer_load_dwordx4 v[200:203], v4, s[76:79], s14 offen sc1
    s_waitcnt vmcnt(5) lgkmcnt(5)
    v_mfma_f32_16x16x32_bf16 v[16:19], v[48:51], v[180:183], v[16:19]
    ds_read_b128 v[88:91], v46 offset:4096
    v_mfma_f32_16x16x32_bf16 v[20:23], v[52:55], v[180:183], v[20:23]
    ds_read_b128 v[92:95], v46 offset:5120
    v_mfma_f32_16x16x32_bf16 v[24:27], v[56:59], v[180:183], v[24:27]
    ds_read_b128 v[96:99], v46 offset:6144
    v_mfma_f32_16x16x32_bf16 v[28:31], v[60:63], v[180:183], v[28:31]
    ds_read_b128 v[100:103], v46 offset:7168
    v_mfma_f32_16x16x32_bf16 v[32:35], v[64:67], v[180:183], v[32:35]
    ds_read_b128 v[104:107], v46 offset:24576
    s_waitcnt vmcnt(4) lgkmcnt(5)
    v_mfma_f32_16x16x32_bf16 v[16:19], v[68:71], v[184:187], v[16:19]
    ds_read_b128 v[48:51], v46 offset:25600
    v_mfma_f32_16x16x32_bf16 v[20:23], v[72:75], v[184:187], v[20:23]
    ds_read_b128 v[52:55], v46 offset:26624
    v_mfma_f32_16x16x32_bf16 v[24:27], v[76:79], v[184:187], v[24:27]
    ds_read_b128 v[56:59], v46 offset:27648
    v_mfma_f32_16x16x32_bf16 v[28:31], v[80:83], v[184:187], v[28:31]
    ds_read_b128 v[60:63], v46 offset:28672
    v_mfma_f32_16x16x32_bf16 v[32:35], v[84:87], v[184:187], v[32:35]
    ds_read_b128 v[64:67], v46 offset:29696
    s_waitcnt vmcnt(3) lgkmcnt(5)
    v_mfma_f32_16x16x32_bf16 v[16:19], v[88:91], v[188:191], v[16:19]
    ds_read_b128 v[68:71], v46 offset:30720
    v_mfma_f32_16x16x32_bf16 v[20:23], v[92:95], v[188:191], v[20:23]
    ds_read_b128 v[72:75], v46 offset:31744
    v_mfma_f32_16x16x32_bf16 v[24:27], v[96:99], v[188:191], v[24:27]
    ds_read_b128 v[76:79], v46 offset:32768
    v_mfma_f32_16x16x32_bf16 v[28:31], v[100:103], v[188:191], v[28:31]
    ds_read_b128 v[80:83], v46 offset:33792
    v_mfma_f32_16x16x32_bf16 v[32:35], v[104:107], v[188:191], v[32:35]
    ds_read_b128 v[84:87], v46 offset:34816
    s_waitcnt vmcnt(2) lgkmcnt(5)
    v_mfma_f32_16x16x32_bf16 v[16:19], v[48:51], v[192:195], v[16:19]
    ds_read_b128 v[88:91], v46 offset:35840
    v_mfma_f32_16x16x32_bf16 v[20:23], v[52:55], v[192:195], v[20:23]
    ds_read_b128 v[92:95], v46 offset:36864
    v_mfma_f32_16x16x32_bf16 v[24:27], v[56:59], v[192:195], v[24:27]
    ds_read_b128 v[96:99], v46 offset:37888
    v_mfma_f32_16x16x32_bf16 v[28:31], v[60:63], v[192:195], v[28:31]
    ds_read_b128 v[100:103], v46 offset:38912
    v_mfma_f32_16x16x32_bf16 v[32:35], v[64:67], v[192:195], v[32:35]
    ds_read_b128 v[104:107], v46 offset:39936
    s_waitcnt vmcnt(1) lgkmcnt(5)
    v_mfma_f32_16x16x32_bf16 v[16:19], v[68:71], v[196:199], v[16:19]
    v_mfma_f32_16x16x32_bf16 v[20:23], v[72:75], v[196:199], v[20:23]
    v_mfma_f32_16x16x32_bf16 v[24:27], v[76:79], v[196:199], v[24:27]
    v_mfma_f32_16x16x32_bf16 v[28:31], v[80:83], v[196:199], v[28:31]
    v_mfma_f32_16x16x32_bf16 v[32:35], v[84:87], v[196:199], v[32:35]
    s_waitcnt vmcnt(0) lgkmcnt(0)
    v_mfma_f32_16x16x32_bf16 v[16:19], v[88:91], v[200:203], v[16:19]
    v_mfma_f32_16x16x32_bf16 v[20:23], v[92:95], v[200:203], v[20:23]
    v_mfma_f32_16x16x32_bf16 v[24:27], v[96:99], v[200:203], v[24:27]
    v_mfma_f32_16x16x32_bf16 v[28:31], v[100:103], v[200:203], v[28:31]
    v_mfma_f32_16x16x32_bf16 v[32:35], v[104:107], v[200:203], v[32:35]
    s_mul_i32 s31, s24, 5120
    v_add_u32 v47, s31, v4
    s_nop 1
    v_cmp_u_f32 vcc, v16, v16
    s_nop 1
    s_cmp_eq_u64 vcc, 0
    s_cbranch_scc0 L5k0_redo
L5k0_back:
    s_barrier
    ds_read_b128 v[48:51], v47 offset:0
    ds_read_b128 v[52:55], v47 offset:1024
    ds_read_b128 v[56:59], v47 offset:2048
    ds_read_b128 v[60:63], v47 offset:3072
    ds_read_b128 v[64:67], v47 offset:4096
    s_waitcnt lgkmcnt(4)
    v_pk_add_f32 v[16:17], v[16:17], v[48:49]
    v_pk_add_f32 v[18:19], v[18:19], v[50:51]
    s_waitcnt lgkmcnt(3)
    v_pk_add_f32 v[20:21], v[20:21], v[52:53]
    v_pk_add_f32 v[22:23], v[22:23], v[54:55]
    s_waitcnt lgkmcnt(2)
    v_pk_add_f32 v[24:25], v[24:25], v[56:57]
    v_pk_add_f32 v[26:27], v[26:27], v[58:59]
    s_waitcnt lgkmcnt(1)
    v_pk_add_f32 v[28:29], v[28:29], v[60:61]
    v_pk_add_f32 v[30:31], v[30:31], v[62:63]
    s_waitcnt lgkmcnt(0)
    v_pk_add_f32 v[32:33], v[32:33], v[64:65]
    v_pk_add_f32 v[34:35], v[34:35], v[66:67]
    v_cvt_pk_bf16_f32 v36, v16, v17
    v_cvt_pk_bf16_f32 v37, v18, v19
    v_cvt_pk_bf16_f32 v38, v20, v21
    v_cvt_pk_bf16_f32 v39, v22, v23
    v_cvt_pk_bf16_f32 v40, v24, v25
    v_cvt_pk_bf16_f32 v41, v26, v27
    v_cvt_pk_bf16_f32 v42, v28, v29
    v_cvt_pk_bf16_f32 v43, v30, v31
    v_cvt_pk_bf16_f32 v44, v32, v33
    v_cvt_pk_bf16_f32 v45, v34, v35
    buffer_store_dwordx4 v[36:39], v217, s[8:11], 0 offen offset:0
    buffer_store_dwordx4 v[40:43], v217, s[8:11], 0 offen offset:64
    buffer_store_dwordx2 v[44:45], v218, s[8:11], 0 offen offset:128
L_fin:
L_end:
    s_endpgm
L2_hook:
    s_cmp_lg_u32 s29, 1
    s_cbranch_scc1 L2_hook2
    s_cmp_lt_u32 s3, 4
    s_cbranch_scc0 L2_hook1y
    s_waitcnt vmcnt(2)
    s_barrier
    s_branch L2_loop
L2_hook1y:
    s_waitcnt vmcnt(0)
    s_barrier
    s_cmp_lt_u32 s44, 640
    s_cbranch_scc0 Lsod_53
    s_add_u32 s36, s45, 0
    buffer_store_dwordx4 v[176:179], v152, s[76:79], s36 offen offset:0 sc1
    buffer_store_dwordx4 v[180:183], v152, s[76:79], s36 offen offset:2048 sc1
    s_add_u32 s36, s45, 4096
    buffer_store_dwordx4 v[184:187], v152, s[76:79], s36 offen offset:0 sc1
    buffer_store_dwordx4 v[188:191], v152, s[76:79], s36 offen offset:2048 sc1
    s_add_u32 s36, s45, 8192
    buffer_store_dwordx4 v[192:195], v152, s[76:79], s36 offen offset:0 sc1
    buffer_store_dwordx4 v[196:199], v152, s[76:79], s36 offen offset:2048 sc1
    s_branch L2_loop
Lsod_53:
    s_cmp_lt_u32 s44, 912
    s_cbranch_scc0 L2_loop
    s_add_u32 s36, s45, 0
    buffer_store_dwordx4 v[176:179], v152, s[76:79], s36 offen offset:0 sc1
    buffer_store_dwordx4 v[180:183], v152, s[76:79], s36 offen offset:1024 sc1
    buffer_store_dwordx4 v[184:187], v152, s[76:79], s36 offen offset:2048 sc1
    buffer_store_dwordx4 v[188:191], v152, s[76:79], s36 offen offset:3072 sc1
    s_add_u32 s36, s45, 4096
    buffer_store_dwordx4 v[192:195], v152, s[76:79], s36 offen offset:0 sc1
    s_add_u32 s36, s52, 0
    buffer_store_dwordx4 v[196:199], v152, s[76:79], s36 offen offset:0 sc1
    buffer_store_dwordx4 v[200:203], v152, s[76:79], s36 offen offset:1024 sc1
    buffer_store_dwordx4 v[204:207], v152, s[76:79], s36 offen offset:2048 sc1
    buffer_store_dwordx4 v[208:211], v152, s[76:79], s36 offen offset:3072 sc1
    s_add_u32 s36, s52, 4096
    buffer_store_dwordx4 v[212:215], v152, s[76:79], s36 offen offset:0 sc1
    s_branch L2_loop
L2_hook2:
    s_cmp_lg_u32 s29, 2
    s_cbranch_scc1 L2_hook3
    s_cmp_lt_u32 s3, 4
    s_cbranch_scc1 L2_loop
    s_mov_b32 s40, s47
    s_and_b32 s36, s2, 31
    s_add_u32 s36, s36, 96
    v_mov_b32 v156, s36
    v_lshlrev_b32 v156, 7, v156
    v_add_u32 v156, 26279936, v156
    s_waitcnt vmcnt(0)
    v_mov_b32 v157, 1
    s_mov_b64 exec, 1
    buffer_atomic_add v157, v156, s[76:79], 0 offen sc1
    s_mov_b64 exec, -1
    s_branch L2_loop
L2_hook3:
    s_cmp_lg_u32 s29, 3
    s_cbranch_scc1 L2_hook4
    s_cmp_lt_u32 s3, 4
    s_cbranch_scc1 L2_loop
    s_mov_b64 exec, s[6:7]
    buffer_load_dword v155, v154, s[76:79], 0 offen sc1
    s_mov_b64 exec, -1
    s_branch L2_loop
L2_hook4:
    s_cmp_lg_u32 s29, 4
    s_cbranch_scc1 L2_hook5
    s_mov_b32 s40, 0x7ff00000
    s_cmp_lt_u32 s3, 4
    s_cbranch_scc1 L2_loop
    v_mov_b32 v158, 32
    v_cmp_eq_u32 s[36:37], 32, v0
    s_nop 1
    v_cndmask_b32 v158, v158, 16, s[36:37]
    s_mov_b64 s[38:39], vcc
    s_waitcnt vmcnt(0)
    s_mov_b64 exec, s[6:7]
    v_cmp_le_u32 vcc, v158, v155
    s_nop 1
    s_cmp_eq_u64 vcc, exec
    s_mov_b64 exec, -1
    s_cbranch_scc1 Lcnt_54
    s_mov_b64 vcc, s[38:39]
    s_mov_b32 s53, 1
    s_branch L2_loop
Lcnt_54:
    s_mov_b64 vcc, s[38:39]
    s_bfe_u32 s33, s2, 0x20003
    s_lshl_b32 s33, s33, 2
    s_add_u32 s33, s33, s24
    s_mul_i32 s33, s33, 15360
    s_mul_i32 s34, s23, 245760
    s_add_u32 s33, s33, s34
    s_add_u32 s33, s33, 22315008
    v_lshlrev_b32 v156, 7, v0
    buffer_load_dword v239, v156, s[76:79], s33 offen sc1
    s_add_u32 s33, s33, 8192
    buffer_load_dword v239, v156, s[76:79], s33 offen sc1
    s_branch L2_loop
L2_hook5:
    s_cmp_lg_u32 s29, 5
    s_cbranch_scc1 L2_hook6
    s_mul_i32 s33, s21, 102400
    s_add_u32 s33, s33, 19529728
    s_add_u32 s48, s74, s33
    s_addc_u32 s49, s75, 0
    s_mov_b32 s50, 102400
    s_mov_b32 s51, 0x20000
    s_lshl_b32 s42, s3, 10
    s_add_u32 s41, s42, 12288
    s_cmp_lt_u32 s3, 2
    s_cselect_b32 s33, 8192, 0
    s_add_u32 s33, s33, 49152
    s_add_u32 s43, s41, s33
    s_add_u32 s46, s43, 30720
    s_cmp_lg_u32 s3, 4
    s_cbranch_scc1 L2_hook5b
    s_cmp_eq_u32 s53, 0
    s_cbranch_scc1 L2_hook5b
    v_mov_b32 v158, 32
    v_cmp_eq_u32 s[36:37], 32, v0
    s_nop 1
    v_cndmask_b32 v158, v158, 16, s[36:37]
    s_mov_b64 s[38:39], vcc
    s_waitcnt vmcnt(0)
    s_mov_b64 exec, s[6:7]
    v_cmp_le_u32 vcc, v158, v155
    s_nop 1
    s_cmp_eq_u64 vcc, exec
    s_mov_b64 exec, -1
    s_cbranch_scc1 Lcnt_55
    s_mov_b64 exec, s[6:7]
    s_mov_b32 s54, 262144
Lpoll_56:
    buffer_load_dword v155, v154, s[76:79], 0 offen sc1
    s_waitcnt vmcnt(0)
    v_cmp_le_u32 vcc, v158, v155
    s_sub_u32 s54, s54, 1
    s_cbranch_scc1 Lpdone_57
    s_cmp_eq_u64 vcc, exec
    s_cbranch_scc0 Lpoll_56
Lpdone_57:
    s_mov_b64 exec, -1
Lcnt_55:
    s_mov_b64 vcc, s[38:39]
L2_hook5b:
    s_cmp_lt_u32 s3, 4
    s_cbranch_scc0 L2_hook5n
    s_waitcnt vmcnt(0)
L2_hook5n:
    s_barrier
    s_cmp_lt_u32 s3, 4
    s_cbranch_scc0 L2_hook5y
    s_mov_b32 m0, s41
    s_add_u32 s41, s41, 8192
    s_cmp_eq_u32 s41, s43
    s_cselect_b32 s41, s46, s41
    buffer_load_dwordx4 v152, s[48:51], s42 offen sc1 lds
    s_add_u32 s42, s42, 8192
    s_branch L2_loop_c
L2_hook5y:
    s_cmp_lg_u32 s3, 5
    s_cbranch_scc1 L2_hook5c
    s_and_b32 s36, s2, 31
    s_add_u32 s36, s36, 129
    v_mov_b32 v156, s36
    v_lshlrev_b32 v156, 7, v156
    v_add_u32 v156, 26279936, v156
    v_mov_b32 v157, 1
    s_mov_b64 exec, 1
    buffer_atomic_add v157, v156, s[76:79], 0 offen sc1
    s_mov_b64 exec, -1
L2_hook5c:
    s_branch L2_loop_c
L2_hook6:
    s_cmp_lg_u32 s3, 4
    s_cbranch_scc1 L2_loop_c
    s_mov_b32 s7, 0
    v_add_u32 v154, 129, v0
    v_lshlrev_b32 v154, 7, v154
    v_add_u32 v154, 26279936, v154
    s_mov_b64 exec, s[6:7]
    buffer_load_dword v155, v154, s[76:79], 0 offen sc1
    s_mov_b64 exec, -1
    s_branch L2_loop_c
L2_clchk:
    v_mov_b32 v158, 8
    s_mov_b64 s[38:39], vcc
    s_waitcnt vmcnt(0)
    s_mov_b64 exec, s[6:7]
    v_cmp_le_u32 vcc, v158, v155
    s_nop 1
    s_cmp_eq_u64 vcc, exec
    s_mov_b64 exec, -1
    s_cbranch_scc1 Lcnt_59
    s_mov_b64 exec, s[6:7]
    s_mov_b32 s54, 262144
Lpoll_60:
    buffer_load_dword v155, v154, s[76:79], 0 offen sc1
    s_waitcnt vmcnt(0)
    v_cmp_le_u32 vcc, v158, v155
    s_sub_u32 s54, s54, 1
    s_cbranch_scc1 Lpdone_61
    s_cmp_eq_u64 vcc, exec
    s_cbranch_scc0 Lpoll_60
Lpdone_61:
    s_mov_b64 exec, -1
Lcnt_59:
    s_mov_b64 vcc, s[38:39]
    s_branch L2_clback
L2_fallback:
    v_and_b32 v1, 31, v0
    v_lshrrev_b32 v2, 5, v0
    v_lshrrev_b32 v6, 4, v1
    v_xor_b32 v6, v6, v2
    v_lshl_add_u32 v6, v1, 1, v6
    v_lshlrev_b32 v6, 4, v6
    v_mov_b32 v121, 0
    v_mov_b32 v168, 0xff800000
    s_mov_b32 s36, 0
    v_mov_b32 v80, 0
    v_mov_b32 v81, 0
    v_mov_b32 v82, 0
    v_mov_b32 v83, 0
    v_mov_b32 v84, 0
    v_mov_b32 v85, 0
    v_mov_b32 v86, 0
    v_mov_b32 v87, 0
    v_mov_b32 v88, 0
    v_mov_b32 v89, 0
    v_mov_b32 v90, 0
    v_mov_b32 v91, 0
    v_mov_b32 v92, 0
    v_mov_b32 v93, 0
    v_mov_b32 v94, 0
    v_mov_b32 v95, 0
L2_fb_loop:
    buffer_load_dwordx4 v[124:127], v152, s[8:11], s36 offen sc1
    buffer_load_dword v132, v153, s[8:11], s36 offen offset:1024 sc1
    s_mov_b64 exec, s[30:31]
    buffer_load_dwordx4 v[136:139], v6, s[8:11], s36 offen offset:1280 sc1
    buffer_load_dwordx4 v[140:143], v6, s[8:11], s36 offen offset:1920 sc1
    s_mov_b64 exec, -1
    s_waitcnt vmcnt(0)
    v_mfma_f32_32x32x16_bf16 v[16:31], v[124:127], v[112:115], 0
    v_mfma_f32_32x32x8_bf16 v[16:31], v[132:133], v[120:121], v[16:31]
    s_nop 15
    v_max3_f32 v169, v16, v17, v18
    v_max3_f32 v169, v169, v19, v20
    v_max3_f32 v169, v169, v21, v22
    v_max3_f32 v169, v169, v23, v24
    v_max3_f32 v169, v169, v25, v26
    v_max3_f32 v169, v169, v27, v28
    v_max3_f32 v169, v169, v29, v30
    v_max_f32 v169, v169, v31
    v_mov_b32 v170, v169
    s_nop 1
    v_permlane32_swap_b32 v169, v170
    v_max_f32 v169, v169, v170
    v_max_f32 v169, v169, v168
    v_sub_f32 v170, v168, v169
    v_exp_f32 v170, v170
    v_mov_b32 v168, v169
    v_mul_f32 v80, v80, v170
    v_mul_f32 v81, v81, v170
    v_mul_f32 v82, v82, v170
    v_mul_f32 v83, v83, v170
    v_mul_f32 v84, v84, v170
    v_mul_f32 v85, v85, v170
    v_mul_f32 v86, v86, v170
    v_mul_f32 v87, v87, v170
    v_mul_f32 v88, v88, v170
    v_mul_f32 v89, v89, v170
    v_mul_f32 v90, v90, v170
    v_mul_f32 v91, v91, v170
    v_mul_f32 v92, v92, v170
    v_mul_f32 v93, v93, v170
    v_mul_f32 v94, v94, v170
    v_mul_f32 v95, v95, v170
    v_sub_f32 v16, v16, v169
    v_sub_f32 v17, v17, v169
    v_sub_f32 v18, v18, v169
    v_sub_f32 v19, v19, v169
    v_sub_f32 v20, v20, v169
    v_sub_f32 v21, v21, v169
    v_sub_f32 v22, v22, v169
    v_sub_f32 v23, v23, v169
    v_sub_f32 v24, v24, v169
    v_sub_f32 v25, v25, v169
    v_sub_f32 v26, v26, v169
    v_sub_f32 v27, v27, v169
    v_sub_f32 v28, v28, v169
    v_sub_f32 v29, v29, v169
    v_sub_f32 v30, v30, v169
    v_sub_f32 v31, v31, v169
    v_exp_f32 v16, v16
    v_exp_f32 v17, v17
    v_exp_f32 v18, v18
    v_exp_f32 v19, v19
    v_exp_f32 v20, v20
    v_exp_f32 v21, v21
    v_exp_f32 v22, v22
    v_exp_f32 v23, v23
    v_exp_f32 v24, v24
    v_exp_f32 v25, v25
    v_exp_f32 v26, v26
    v_exp_f32 v27, v27
    v_exp_f32 v28, v28
    v_exp_f32 v29, v29
    v_exp_f32 v30, v30
    v_exp_f32 v31, v31
    s_nop 1
    v_smfmac_f32_32x32x32_bf16 v[80:95], v[136:139], v[16:23], v7
    v_smfmac_f32_32x32x32_bf16 v[80:95], v[140:143], v[24:31], v7
    s_nop 15
    s_add_u32 s36, s36, 2560
    s_cmp_lt_u32 s36, 163840
    s_cbranch_scc1 L2_fb_loop
    v_mov_b32 v156, v88
    v_mov_b32 v157, v88
    s_nop 1
    v_permlane32_swap_b32 v156, v157
    v_rcp_f32 v156, v157
    s_nop 0
    v_pk_mul_f32 v[80:81], v[80:81], v[156:157] op_sel_hi:[1,0]
    v_pk_mul_f32 v[82:83], v[82:83], v[156:157] op_sel_hi:[1,0]
    v_pk_mul_f32 v[84:85], v[84:85], v[156:157] op_sel_hi:[1,0]
    v_pk_mul_f32 v[86:87], v[86:87], v[156:157] op_sel_hi:[1,0]
    v_pk_mul_f32 v[88:89], v[88:89], v[156:157] op_sel_hi:[1,0]
    v_pk_mul_f32 v[90:91], v[90:91], v[156:157] op_sel_hi:[1,0]
    s_branch L2_store
L5k0_redo:
    s_nop 7
    v_mov_b32 v16, 0
    v_mov_b32 v17, 0
    v_mov_b32 v18, 0
    v_mov_b32 v19, 0
    v_mov_b32 v20, 0
    v_mov_b32 v21, 0
    v_mov_b32 v22, 0
    v_mov_b32 v23, 0
    v_mov_b32 v24, 0
    v_mov_b32 v25, 0
    v_mov_b32 v26, 0
    v_mov_b32 v27, 0
    v_mov_b32 v28, 0
    v_mov_b32 v29, 0
    v_mov_b32 v30, 0
    v_mov_b32 v31, 0
    v_mov_b32 v32, 0
    v_mov_b32 v33, 0
    v_mov_b32 v34, 0
    v_mov_b32 v35, 0
    s_mov_b32 s14, s25
    s_mul_i32 s15, s21, 245760
    s_add_u32 s15, s15, 20471808
    s_add_u32 s16, s15, 4096
    s_add_u32 s14, s25, 25600
    s_mov_b32 s53, 8
Lslow_63:
    s_mov_b32 s54, 32768
    buffer_load_dwordx4 v[48:51], v4, s[76:79], s15 offen offset:0 sc1
    buffer_load_dwordx4 v[52:55], v4, s[76:79], s15 offen offset:1024 sc1
    buffer_load_dwordx4 v[56:59], v4, s[76:79], s15 offen offset:2048 sc1
    buffer_load_dwordx4 v[60:63], v4, s[76:79], s15 offen offset:3072 sc1
    buffer_load_dwordx4 v[64:67], v4, s[76:79], s16 offen offset:0 sc1
Lagain_64:
    buffer_load_dwordx4 v[108:111], v4, s[76:79], s14 offen offset:0 sc1
    s_waitcnt vmcnt(0)
    v_max_u32 v112, v108, v109
    v_max3_u32 v112, v112, v110, v111
    v_cmp_ne_u32 vcc, -1, v112
    s_sub_u32 s54, s54, 1
    s_cbranch_scc1 Lok_65
    s_cmp_eq_u64 vcc, exec
    s_cbranch_scc0 Lagain_64
Lok_65:
    v_mfma_f32_16x16x32_bf16 v[16:19], v[48:51], v[108:111], v[16:19]
    v_mfma_f32_16x16x32_bf16 v[20:23], v[52:55], v[108:111], v[20:23]
    v_mfma_f32_16x16x32_bf16 v[24:27], v[56:59], v[108:111], v[24:27]
    v_mfma_f32_16x16x32_bf16 v[28:31], v[60:63], v[108:111], v[28:31]
    v_mfma_f32_16x16x32_bf16 v[32:35], v[64:67], v[108:111], v[32:35]
    s_add_u32 s14, s14, 3072
    s_add_u32 s15, s15, 5120
    s_add_u32 s16, s16, 5120
    s_nop 7
    s_sub_u32 s53, s53, 1
    s_cmp_lg_u32 s53, 0
    s_cbranch_scc1 Lslow_63
    s_mul_i32 s15, s21, 245760
    s_add_u32 s15, s15, 20512768
    s_add_u32 s16, s15, 4096
    s_add_u32 s14, s25, 2048
    s_mov_b32 s53, 16
Lslow_66:
    s_mov_b32 s54, 32768
    buffer_load_dwordx4 v[48:51], v4, s[76:79], s15 offen offset:0 sc1
    buffer_load_dwordx4 v[52:55], v4, s[76:79], s15 offen offset:1024 sc1
    buffer_load_dwordx4 v[56:59], v4, s[76:79], s15 offen offset:2048 sc1
    buffer_load_dwordx4 v[60:63], v4, s[76:79], s15 offen offset:3072 sc1
    buffer_load_dwordx4 v[64:67], v4, s[76:79], s16 offen offset:0 sc1
Lagain_67:
    buffer_load_dwordx4 v[108:111], v4, s[76:79], s14 offen offset:0 sc1
    s_waitcnt vmcnt(0)
    v_max_u32 v112, v108, v109
    v_max3_u32 v112, v112, v110, v111
    v_cmp_ne_u32 vcc, -1, v112
    s_sub_u32 s54, s54, 1
    s_cbranch_scc1 Lok_68
    s_cmp_eq_u64 vcc, exec
    s_cbranch_scc0 Lagain_67
Lok_68:
    v_mfma_f32_16x16x32_bf16 v[16:19], v[48:51], v[108:111], v[16:19]
    v_mfma_f32_16x16x32_bf16 v[20:23], v[52:55], v[108:111], v[20:23]
    v_mfma_f32_16x16x32_bf16 v[24:27], v[56:59], v[108:111], v[24:27]
    v_mfma_f32_16x16x32_bf16 v[28:31], v[60:63], v[108:111], v[28:31]
    v_mfma_f32_16x16x32_bf16 v[32:35], v[64:67], v[108:111], v[32:35]
    s_add_u32 s14, s14, 3072
    s_add_u32 s15, s15, 5120
    s_add_u32 s16, s16, 5120
    s_nop 7
    s_sub_u32 s53, s53, 1
    s_cmp_lg_u32 s53, 0
    s_cbranch_scc1 Lslow_66
    s_branch L5k0_back
L5k1_redo:
    s_nop 7
    v_lshlrev_b32 v16, 16, v228
    v_and_b32 v17, 0xffff0000, v228
    v_lshlrev_b32 v18, 16, v229
    v_and_b32 v19, 0xffff0000, v229
    v_lshlrev_b32 v20, 16, v230
    v_and_b32 v21, 0xffff0000, v230
    v_lshlrev_b32 v22, 16, v231
    v_and_b32 v23, 0xffff0000, v231
    v_lshlrev_b32 v24, 16, v232
    v_and_b32 v25, 0xffff0000, v232
    v_lshlrev_b32 v26, 16, v233
    v_and_b32 v27, 0xffff0000, v233
    v_lshlrev_b32 v28, 16, v234
    v_and_b32 v29, 0xffff0000, v234
    v_lshlrev_b32 v30, 16, v235
    v_and_b32 v31, 0xffff0000, v235
    v_lshlrev_b32 v32, 16, v236
    v_and_b32 v33, 0xffff0000, v236
    v_lshlrev_b32 v34, 16, v237
    v_and_b32 v35, 0xffff0000, v237
    s_mov_b32 s14, s25
    s_mul_i32 s15, s21, 245760
    s_add_u32 s15, s15, 20348928
    s_add_u32 s16, s15, 4096
    s_add_u32 s14, s25, 0
    s_mov_b32 s53, 16
Lslow_69:
    s_mov_b32 s54, 32768
    buffer_load_dwordx4 v[48:51], v4, s[76:79], s15 offen offset:0 sc1
    buffer_load_dwordx4 v[52:55], v4, s[76:79], s15 offen offset:1024 sc1
    buffer_load_dwordx4 v[56:59], v4, s[76:79], s15 offen offset:2048 sc1
    buffer_load_dwordx4 v[60:63], v4, s[76:79], s15 offen offset:3072 sc1
    buffer_load_dwordx4 v[64:67], v4, s[76:79], s16 offen offset:0 sc1
Lagain_70:
    buffer_load_dwordx4 v[108:111], v4, s[76:79], s14 offen offset:0 sc1
    s_waitcnt vmcnt(0)
    v_max_u32 v112, v108, v109
    v_max3_u32 v112, v112, v110, v111
    v_cmp_ne_u32 vcc, -1, v112
    s_sub_u32 s54, s54, 1
    s_cbranch_scc1 Lok_71
    s_cmp_eq_u64 vcc, exec
    s_cbranch_scc0 Lagain_70
Lok_71:
    v_mfma_f32_16x16x32_bf16 v[16:19], v[48:51], v[108:111], v[16:19]
    v_mfma_f32_16x16x32_bf16 v[20:23], v[52:55], v[108:111], v[20:23]
    v_mfma_f32_16x16x32_bf16 v[24:27], v[56:59], v[108:111], v[24:27]
    v_mfma_f32_16x16x32_bf16 v[28:31], v[60:63], v[108:111], v[28:31]
    v_mfma_f32_16x16x32_bf16 v[32:35], v[64:67], v[108:111], v[32:35]
    s_add_u32 s14, s14, 3072
    s_add_u32 s15, s15, 5120
    s_add_u32 s16, s16, 5120
    s_nop 7
    s_sub_u32 s53, s53, 1
    s_cmp_lg_u32 s53, 0
    s_cbranch_scc1 Lslow_69
    s_mul_i32 s15, s21, 245760
    s_add_u32 s15, s15, 20430848
    s_add_u32 s16, s15, 4096
    s_add_u32 s14, s25, 1024
    s_mov_b32 s53, 8
Lslow_72:
    s_mov_b32 s54, 32768
    buffer_load_dwordx4 v[48:51], v4, s[76:79], s15 offen offset:0 sc1
    buffer_load_dwordx4 v[52:55], v4, s[76:79], s15 offen offset:1024 sc1
    buffer_load_dwordx4 v[56:59], v4, s[76:79], s15 offen offset:2048 sc1
    buffer_load_dwordx4 v[60:63], v4, s[76:79], s15 offen offset:3072 sc1
    buffer_load_dwordx4 v[64:67], v4, s[76:79], s16 offen offset:0 sc1
Lagain_73:
    buffer_load_dwordx4 v[108:111], v4, s[76:79], s14 offen offset:0 sc1
    s_waitcnt vmcnt(0)
    v_max_u32 v112, v108, v109
    v_max3_u32 v112, v112, v110, v111
    v_cmp_ne_u32 vcc, -1, v112
    s_sub_u32 s54, s54, 1
    s_cbranch_scc1 Lok_74
    s_cmp_eq_u64 vcc, exec
    s_cbranch_scc0 Lagain_73
Lok_74:
    v_mfma_f32_16x16x32_bf16 v[16:19], v[48:51], v[108:111], v[16:19]
    v_mfma_f32_16x16x32_bf16 v[20:23], v[52:55], v[108:111], v[20:23]
    v_mfma_f32_16x16x32_bf16 v[24:27], v[56:59], v[108:111], v[24:27]
    v_mfma_f32_16x16x32_bf16 v[28:31], v[60:63], v[108:111], v[28:31]
    v_mfma_f32_16x16x32_bf16 v[32:35], v[64:67], v[108:111], v[32:35]
    s_add_u32 s14, s14, 3072
    s_add_u32 s15, s15, 5120
    s_add_u32 s16, s16, 5120
    s_nop 7
    s_sub_u32 s53, s53, 1
    s_cmp_lg_u32 s53, 0
    s_cbranch_scc1 Lslow_72
    s_branch L5k1_back
L3_redo:
    s_nop 7
    v_lshlrev_b32 v16, 16, v228
    v_and_b32 v17, 0xffff0000, v228
    v_lshlrev_b32 v18, 16, v229
    v_and_b32 v19, 0xffff0000, v229
    v_lshlrev_b32 v20, 16, v230
    v_and_b32 v21, 0xffff0000, v230
    v_lshlrev_b32 v22, 16, v231
    v_and_b32 v23, 0xffff0000, v231
    v_lshlrev_b32 v24, 16, v232
    v_and_b32 v25, 0xffff0000, v232
    v_lshlrev_b32 v26, 16, v233
    v_and_b32 v27, 0xffff0000, v233
    v_lshlrev_b32 v28, 16, v234
    v_and_b32 v29, 0xffff0000, v234
    v_lshlrev_b32 v30, 16, v235
    v_and_b32 v31, 0xffff0000, v235
    v_lshlrev_b32 v32, 16, v236
    v_and_b32 v33, 0xffff0000, v236
    v_lshlrev_b32 v34, 16, v237
    v_and_b32 v35, 0xffff0000, v237
    s_mov_b32 s14, s25
    s_mul_i32 s15, s21, 102400
    s_add_u32 s15, s15, 19529728
    s_add_u32 s16, s15, 4096
    s_mov_b32 s53, 16
Lslow_75:
    s_mov_b32 s54, 32768
    buffer_load_dwordx4 v[48:51], v4, s[76:79], s15 offen offset:0 sc1
    buffer_load_dwordx4 v[52:55], v4, s[76:79], s15 offen offset:1024 sc1
    buffer_load_dwordx4 v[56:59], v4, s[76:79], s15 offen offset:2048 sc1
    buffer_load_dwordx4 v[60:63], v4, s[76:79], s15 offen offset:3072 sc1
    buffer_load_dwordx4 v[64:67], v4, s[76:79], s16 offen offset:0 sc1
Lagain_76:
    buffer_load_dwordx4 v[108:111], v4, s[76:79], s14 offen offset:0 sc1
    s_waitcnt vmcnt(0)
    v_max_u32 v112, v108, v109
    v_max3_u32 v112, v112, v110, v111
    v_cmp_ne_u32 vcc, -1, v112
    s_sub_u32 s54, s54, 1
    s_cbranch_scc1 Lok_77
    s_cmp_eq_u64 vcc, exec
    s_cbranch_scc0 Lagain_76
Lok_77:
    v_mfma_f32_16x16x32_bf16 v[16:19], v[48:51], v[108:111], v[16:19]
    v_mfma_f32_16x16x32_bf16 v[20:23], v[52:55], v[108:111], v[20:23]
    v_mfma_f32_16x16x32_bf16 v[24:27], v[56:59], v[108:111], v[24:27]
    v_mfma_f32_16x16x32_bf16 v[28:31], v[60:63], v[108:111], v[28:31]
    v_mfma_f32_16x16x32_bf16 v[32:35], v[64:67], v[108:111], v[32:35]
    s_add_u32 s14, s14, 1024
    s_add_u32 s15, s15, 5120
    s_add_u32 s16, s16, 5120
    s_nop 7
    s_sub_u32 s53, s53, 1
    s_cmp_lg_u32 s53, 0
    s_cbranch_scc1 Lslow_75
    s_mov_b32 s14, 9961472
    s_add_u32 s18, s14, 16384
    s_mov_b32 s53, 4
Lslow_78:
    s_mov_b32 s54, 32768
    buffer_load_dwordx4 v[48:51], v4, s[76:79], s15 offen offset:0 sc1
    buffer_load_dwordx4 v[52:55], v4, s[76:79], s15 offen offset:1024 sc1
    buffer_load_dwordx4 v[56:59], v4, s[76:79], s15 offen offset:2048 sc1
    buffer_load_dwordx4 v[60:63], v4, s[76:79], s15 offen offset:3072 sc1
    buffer_load_dwordx4 v[64:67], v4, s[76:79], s16 offen offset:0 sc1
Lagain_79:
    buffer_load_dwordx2 v[108:109], v221, s[76:79], s14 offen offset:0 sc1
    buffer_load_dwordx2 v[110:111], v221, s[76:79], s18 offen offset:0 sc1
    s_waitcnt vmcnt(0)
    v_max_u32 v112, v108, v109
    v_max3_u32 v112, v112, v110, v111
    v_cmp_ne_u32 vcc, -1, v112
    s_sub_u32 s54, s54, 1
    s_cbranch_scc1 Lok_80
    s_cmp_eq_u64 vcc, exec
    s_cbranch_scc0 Lagain_79
Lok_80:
    v_mfma_f32_16x16x32_bf16 v[16:19], v[48:51], v[108:111], v[16:19]
    v_mfma_f32_16x16x32_bf16 v[20:23], v[52:55], v[108:111], v[20:23]
    v_mfma_f32_16x16x32_bf16 v[24:27], v[56:59], v[108:111], v[24:27]
    v_mfma_f32_16x16x32_bf16 v[28:31], v[60:63], v[108:111], v[28:31]
    v_mfma_f32_16x16x32_bf16 v[32:35], v[64:67], v[108:111], v[32:35]
    s_add_u32 s14, s14, 131072
    s_add_u32 s18, s18, 131072
    s_add_u32 s15, s15, 5120
    s_add_u32 s16, s16, 5120
    s_nop 7
    s_sub_u32 s53, s53, 1
    s_cmp_lg_u32 s53, 0
    s_cbranch_scc1 Lslow_78
    s_branch L3_back
L4_redo:
    s_nop 7
    v_pk_mul_f32 v[16:17], v[200:201], v[248:249] op_sel:[0,0] op_sel_hi:[1,0]
    v_pk_mul_f32 v[18:19], v[202:203], v[248:249] op_sel:[0,0] op_sel_hi:[1,0]
    v_pk_mul_f32 v[20:21], v[204:205], v[248:249] op_sel:[0,0] op_sel_hi:[1,0]
    v_pk_mul_f32 v[22:23], v[206:207], v[248:249] op_sel:[0,0] op_sel_hi:[1,0]
    v_pk_mul_f32 v[24:25], v[208:209], v[248:249] op_sel:[0,0] op_sel_hi:[1,0]
    v_pk_mul_f32 v[26:27], v[210:211], v[248:249] op_sel:[0,0] op_sel_hi:[1,0]
    v_pk_mul_f32 v[28:29], v[212:213], v[248:249] op_sel:[0,0] op_sel_hi:[1,0]
    v_pk_mul_f32 v[30:31], v[214:215], v[248:249] op_sel:[0,0] op_sel_hi:[1,0]
    v_pk_mul_f32 v[32:33], v[216:217], v[248:249] op_sel:[0,0] op_sel_hi:[1,0]
    v_pk_mul_f32 v[34:35], v[218:219], v[248:249] op_sel:[0,0] op_sel_hi:[1,0]
    v_pk_mul_f32 v[36:37], v[220:221], v[248:249] op_sel:[0,0] op_sel_hi:[1,0]
    v_pk_mul_f32 v[38:39], v[222:223], v[248:249] op_sel:[0,0] op_sel_hi:[1,0]
    v_pk_mul_f32 v[40:41], v[224:225], v[248:249] op_sel:[0,0] op_sel_hi:[1,0]
    v_pk_mul_f32 v[42:43], v[226:227], v[248:249] op_sel:[0,0] op_sel_hi:[1,0]
    v_pk_mul_f32 v[44:45], v[228:229], v[248:249] op_sel:[0,0] op_sel_hi:[1,0]
    v_pk_mul_f32 v[46:47], v[230:231], v[248:249] op_sel:[0,0] op_sel_hi:[1,0]
    v_pk_mul_f32 v[48:49], v[232:233], v[248:249] op_sel:[0,0] op_sel_hi:[1,0]
    v_pk_mul_f32 v[50:51], v[234:235], v[248:249] op_sel:[0,0] op_sel_hi:[1,0]
    v_pk_mul_f32 v[52:53], v[236:237], v[248:249] op_sel:[0,0] op_sel_hi:[1,0]
    v_pk_mul_f32 v[54:55], v[238:239], v[248:249] op_sel:[0,0] op_sel_hi:[1,0]
    v_pk_mul_f32 v[56:57], v[240:241], v[248:249] op_sel:[0,0] op_sel_hi:[1,0]
    v_pk_mul_f32 v[58:59], v[242:243], v[248:249] op_sel:[0,0] op_sel_hi:[1,0]
    v_pk_mul_f32 v[60:61], v[244:245], v[248:249] op_sel:[0,0] op_sel_hi:[1,0]
    v_pk_mul_f32 v[62:63], v[246:247], v[248:249] op_sel:[0,0] op_sel_hi:[1,0]
    v_pk_mul_f32 v[64:65], v[200:201], v[248:249] op_sel:[0,1] op_sel_hi:[1,1]
    v_pk_mul_f32 v[66:67], v[202:203], v[248:249] op_sel:[0,1] op_sel_hi:[1,1]
    v_pk_mul_f32 v[68:69], v[204:205], v[248:249] op_sel:[0,1] op_sel_hi:[1,1]
    v_pk_mul_f32 v[70:71], v[206:207], v[248:249] op_sel:[0,1] op_sel_hi:[1,1]
    v_pk_mul_f32 v[72:73], v[208:209], v[248:249] op_sel:[0,1] op_sel_hi:[1,1]
    v_pk_mul_f32 v[74:75], v[210:211], v[248:249] op_sel:[0,1] op_sel_hi:[1,1]
    v_pk_mul_f32 v[76:77], v[212:213], v[248:249] op_sel:[0,1] op_sel_hi:[1,1]
    v_pk_mul_f32 v[78:79], v[214:215], v[248:249] op_sel:[0,1] op_sel_hi:[1,1]
    v_pk_mul_f32 v[80:81], v[216:217], v[248:249] op_sel:[0,1] op_sel_hi:[1,1]
    v_pk_mul_f32 v[82:83], v[218:219], v[248:249] op_sel:[0,1] op_sel_hi:[1,1]
    v_pk_mul_f32 v[84:85], v[220:221], v[248:249] op_sel:[0,1] op_sel_hi:[1,1]
    v_pk_mul_f32 v[86:87], v[222:223], v[248:249] op_sel:[0,1] op_sel_hi:[1,1]
    v_pk_mul_f32 v[88:89], v[224:225], v[248:249] op_sel:[0,1] op_sel_hi:[1,1]
    v_pk_mul_f32 v[90:91], v[226:227], v[248:249] op_sel:[0,1] op_sel_hi:[1,1]
    v_pk_mul_f32 v[92:93], v[228:229], v[248:249] op_sel:[0,1] op_sel_hi:[1,1]
    v_pk_mul_f32 v[94:95], v[230:231], v[248:249] op_sel:[0,1] op_sel_hi:[1,1]
    v_pk_mul_f32 v[96:97], v[232:233], v[248:249] op_sel:[0,1] op_sel_hi:[1,1]
    v_pk_mul_f32 v[98:99], v[234:235], v[248:249] op_sel:[0,1] op_sel_hi:[1,1]
    v_pk_mul_f32 v[100:101], v[236:237], v[248:249] op_sel:[0,1] op_sel_hi:[1,1]
    v_pk_mul_f32 v[102:103], v[238:239], v[248:249] op_sel:[0,1] op_sel_hi:[1,1]
    v_pk_mul_f32 v[104:105], v[240:241], v[248:249] op_sel:[0,1] op_sel_hi:[1,1]
    v_pk_mul_f32 v[106:107], v[242:243], v[248:249] op_sel:[0,1] op_sel_hi:[1,1]
    v_pk_mul_f32 v[108:109], v[244:245], v[248:249] op_sel:[0,1] op_sel_hi:[1,1]
    v_pk_mul_f32 v[110:111], v[246:247], v[248:249] op_sel:[0,1] op_sel_hi:[1,1]
    s_mul_i32 s14, s28, 40960
    s_add_u32 s14, s14, 10485760
    s_add_u32 s15, s14, 20480
    s_mul_i32 s16, s23, 245760
    s_add_u32 s16, s16, 22315008
    s_add_u32 s17, s16, 4096
    s_add_u32 s18, s16, 8192
    s_mov_b32 s53, 20
Lslow_81:
    s_mov_b32 s54, 32768
    buffer_load_dwordx4 v[112:115], v4, s[76:79], s16 offen offset:0 sc1
    buffer_load_dwordx4 v[116:119], v4, s[76:79], s16 offen offset:1024 sc1
    buffer_load_dwordx4 v[120:123], v4, s[76:79], s16 offen offset:2048 sc1
    buffer_load_dwordx4 v[124:127], v4, s[76:79], s16 offen offset:3072 sc1
    buffer_load_dwordx4 v[128:131], v4, s[76:79], s17 offen offset:0 sc1
    buffer_load_dwordx4 v[132:135], v4, s[76:79], s17 offen offset:1024 sc1
    buffer_load_dwordx4 v[136:139], v4, s[76:79], s17 offen offset:2048 sc1
    buffer_load_dwordx4 v[140:143], v4, s[76:79], s17 offen offset:3072 sc1
    buffer_load_dwordx4 v[144:147], v4, s[76:79], s18 offen offset:0 sc1
    buffer_load_dwordx4 v[148:151], v4, s[76:79], s18 offen offset:1024 sc1
    buffer_load_dwordx4 v[152:155], v4, s[76:79], s18 offen offset:2048 sc1
    buffer_load_dwordx4 v[156:159], v4, s[76:79], s18 offen offset:3072 sc1
Lagain_82:
    buffer_load_dwordx4 v[184:187], v4, s[76:79], s14 offen offset:0 sc1
    buffer_load_dwordx4 v[188:191], v4, s[76:79], s15 offen offset:0 sc1
    s_waitcnt vmcnt(0)
    v_max_u32 v192, v184, v185
    v_max3_u32 v192, v192, v186, v187
    v_max3_u32 v192, v192, v188, v189
    v_max3_u32 v192, v192, v190, v191
    v_cmp_ne_u32 vcc, -1, v192
    s_sub_u32 s54, s54, 1
    s_cbranch_scc1 Lok_83
    s_cmp_eq_u64 vcc, exec
    s_cbranch_scc0 Lagain_82
Lok_83:
    v_mfma_f32_16x16x32_bf16 v[16:19], v[112:115], v[184:187], v[16:19]
    v_mfma_f32_16x16x32_bf16 v[64:67], v[112:115], v[188:191], v[64:67]
    v_mfma_f32_16x16x32_bf16 v[20:23], v[116:119], v[184:187], v[20:23]
    v_mfma_f32_16x16x32_bf16 v[68:71], v[116:119], v[188:191], v[68:71]
    v_mfma_f32_16x16x32_bf16 v[24:27], v[120:123], v[184:187], v[24:27]
    v_mfma_f32_16x16x32_bf16 v[72:75], v[120:123], v[188:191], v[72:75]
    v_mfma_f32_16x16x32_bf16 v[28:31], v[124:127], v[184:187], v[28:31]
    v_mfma_f32_16x16x32_bf16 v[76:79], v[124:127], v[188:191], v[76:79]
    v_mfma_f32_16x16x32_bf16 v[32:35], v[128:131], v[184:187], v[32:35]
    v_mfma_f32_16x16x32_bf16 v[80:83], v[128:131], v[188:191], v[80:83]
    v_mfma_f32_16x16x32_bf16 v[36:39], v[132:135], v[184:187], v[36:39]
    v_mfma_f32_16x16x32_bf16 v[84:87], v[132:135], v[188:191], v[84:87]
    v_mfma_f32_16x16x32_bf16 v[40:43], v[136:139], v[184:187], v[40:43]
    v_mfma_f32_16x16x32_bf16 v[88:91], v[136:139], v[188:191], v[88:91]
    v_mfma_f32_16x16x32_bf16 v[44:47], v[140:143], v[184:187], v[44:47]
    v_mfma_f32_16x16x32_bf16 v[92:95], v[140:143], v[188:191], v[92:95]
    v_mfma_f32_16x16x32_bf16 v[48:51], v[144:147], v[184:187], v[48:51]
    v_mfma_f32_16x16x32_bf16 v[96:99], v[144:147], v[188:191], v[96:99]
    v_mfma_f32_16x16x32_bf16 v[52:55], v[148:151], v[184:187], v[52:55]
    v_mfma_f32_16x16x32_bf16 v[100:103], v[148:151], v[188:191], v[100:103]
    v_mfma_f32_16x16x32_bf16 v[56:59], v[152:155], v[184:187], v[56:59]
    v_mfma_f32_16x16x32_bf16 v[104:107], v[152:155], v[188:191], v[104:107]
    v_mfma_f32_16x16x32_bf16 v[60:63], v[156:159], v[184:187], v[60:63]
    v_mfma_f32_16x16x32_bf16 v[108:111], v[156:159], v[188:191], v[108:111]
    s_add_u32 s14, s14, 1024
    s_add_u32 s15, s15, 1024
    s_add_u32 s16, s16, 12288
    s_add_u32 s17, s17, 12288
    s_add_u32 s18, s18, 12288
    s_nop 7
    s_sub_u32 s53, s53, 1
    s_cmp_lg_u32 s53, 0
    s_cbranch_scc1 Lslow_81
    s_branch L4_back
.p2align 6
qk_table:
.long 0x3010200, 0x8060705, 0x0, 0x100, 0x1, 0x101, 0x0, 0x0
.long 0xd0b0c0a, 0x1210110f, 0x2, 0x102, 0x3, 0x103, 0x0, 0x0
.long 0x17151614, 0x1c1a1b19, 0x4, 0x104, 0x5, 0x105, 0x0, 0x0
.long 0x91f041e, 0x1d13180e, 0x6, 0x10200, 0x30202, 0x50204, 0x0, 0x0
.long 0x4010300, 0x9060805, 0x106, 0x7, 0x107, 0x8, 0x0, 0x0
.long 0xe0b0d0a, 0x1310120f, 0x108, 0x9, 0x109, 0xa, 0x0, 0x0
.long 0x18151714, 0x1d1a1c19, 0x10a, 0xb, 0x10b, 0xc, 0x0, 0x0
.long 0x71f021e, 0x1b11160c, 0x10c, 0x70206, 0x90208, 0xb020a, 0x0, 0x0
.long 0x4020301, 0x9070806, 0xd, 0x10d, 0xe, 0x10e, 0x0, 0x0
.long 0xe0c0d0b, 0x13111210, 0xf, 0x10f, 0x10, 0x110, 0x0, 0x0
.long 0x18161715, 0x1d1b1c1a, 0x11, 0x111, 0x12, 0x112, 0x0, 0x0
.long 0xf050a00, 0x1f191e14, 0xd020c, 0xf020e, 0x110210, 0x130212, 0x0, 0x0
.long 0x3010200, 0x7050604, 0x13, 0x113, 0x14, 0x114, 0x0, 0x0
.long 0xc0a0b09, 0x110f100e, 0x15, 0x115, 0x16, 0x116, 0x0, 0x0
.long 0x16141513, 0x1b191a18, 0x17, 0x117, 0x18, 0x118, 0x0, 0x0
.long 0xd1e081d, 0x1f171c12, 0x19, 0x150214, 0x170216, 0x190218, 0x0, 0x0
.long 0x3010200, 0x8050704, 0x119, 0x1a, 0x11a, 0x1b, 0x0, 0x0
.long 0xd0a0c09, 0x120f110e, 0x11b, 0x1c, 0x11c, 0x1d, 0x0, 0x0
.long 0x17141613, 0x1c191b18, 0x11d, 0x1e, 0x11e, 0x1f, 0x0, 0x0
.long 0xb1e061d, 0x1f151a10, 0x11f, 0x1b021a, 0x1d021c, 0x1f021e, 0x0, 0x0
.section .rodata,"a"
.p2align 6
.amdhsa_kernel sequential_preLN__mha_block__glu_gated_geglu__prompt_kernel
  .amdhsa_next_free_vgpr 256
  .amdhsa_next_free_sgpr 102
  .amdhsa_accum_offset 256
  .amdhsa_group_segment_fixed_size 0
  .amdhsa_kernarg_size 80
  .amdhsa_user_sgpr_count 2
  .amdhsa_user_sgpr_kernarg_segment_ptr 1
  .amdhsa_system_sgpr_workgroup_id_x 1
  .amdhsa_float_denorm_mode_32 3
.end_amdhsa_kernel
```
